```python
import torch

def _softmax(x, axis=-1):
    return torch.softmax(x, dim=axis)
def _gelu(x):
    return torch.nn.functional.gelu(x, approximate="tanh")
def _silu(x):
    return torch.nn.functional.silu(x)
def _sigmoid(x):
    return torch.sigmoid(x)
def _layernorm(x, axis=-1, eps=1e-5):
    m = x.mean(dim=axis, keepdim=True)
    v = x.var(dim=axis, keepdim=True, unbiased=False)
    return (x - m) / torch.sqrt(v + eps)
def _scatter_add(tgt, idx, src, axis=0):
    return tgt.clone().index_add_(axis, idx, src)
def _segment_sum(src, seg, n):
    out = torch.zeros((n,) + src.shape[1:], dtype=src.dtype)
    return out.index_add_(0, seg, src)
def _pad(x, pw):
    flat = tuple(v for pair in reversed(pw) for v in pair)
    return torch.nn.functional.pad(x, flat)

kernel_name = 'sequential_preLN__ssm_conv_s4d__mixer_token_mlp__prompt'

def setup_inputs():

    _w = (lambda a: (lambda t: t.to(torch.bfloat16) if t.is_floating_point() else t)(torch.as_tensor(a)))
    def _A_setup():
        Bsz, L, D, N = 1, 2048, 448, 256
        return {
            "u": _w((lambda *s: torch.randn(*s, dtype=torch.bfloat16) * 0.05)(Bsz, L, D)),
            "log_A_real": _w((lambda *s: torch.randn(*s, dtype=torch.bfloat16) * 6.4)(D, N) * 0.5),
            "A_imag": _w((lambda *s: torch.randn(*s, dtype=torch.bfloat16) * 0.05)(D, N) * 3.14),
            "C_real": _w((lambda *s: torch.randn(*s, dtype=torch.bfloat16) * 0.05)(D, N) / N ** 0.5),
            "C_imag": _w((lambda *s: torch.randn(*s, dtype=torch.bfloat16) * 0.05)(D, N) / N ** 0.5),
            "log_dt": _w((lambda *s: torch.randn(*s, dtype=torch.bfloat16) * 0.05)(D) * 0.5 - 4.0),
            "D_skip": _w((lambda *s: torch.randn(*s, dtype=torch.bfloat16) * 0.05)(D)),
        }
    _A_in = _A_setup()

    def _B_setup():
        B, S, D, F = 1, 2048, 448, 1792
        return {
            "x": _w((lambda *s: torch.randn(*s, dtype=torch.bfloat16) * 0.05)(B, S, D)),
            "w1": _w((lambda *s: torch.randn(*s, dtype=torch.bfloat16) * 0.4)(S, F) * (S ** -0.5)),
            "b1": _w((lambda *s: torch.randn(*s, dtype=torch.bfloat16) * 12.8)(F) * 0.02),
            "w2": _w((lambda *s: torch.randn(*s, dtype=torch.bfloat16) * 0.2)(F, S) * (F ** -0.5)),
            "b2": _w((lambda *s: torch.randn(*s, dtype=torch.bfloat16) * 3.2)(S) * 0.02),
        }
    _B_in = _B_setup()

    return {
        "A_u": _A_in["u"],
        "A_log_A_real": _A_in["log_A_real"],
        "A_A_imag": _A_in["A_imag"],
        "A_C_real": _A_in["C_real"],
        "A_C_imag": _A_in["C_imag"],
        "A_log_dt": _A_in["log_dt"],
        "A_D_skip": _A_in["D_skip"],
        "B_x": _B_in["x"],
        "B_w1": _B_in["w1"],
        "B_b1": _B_in["b1"],
        "B_w2": _B_in["w2"],
        "B_b2": _B_in["b2"],
    }

def reference(A_u, A_log_A_real, A_A_imag, A_C_real, A_C_imag, A_log_dt, A_D_skip, B_x, B_w1, B_b1, B_w2, B_b2):
    def _A_ref(u, log_A_real, A_imag, C_real, C_imag, log_dt, D_skip):
        L = u.shape[1]
        dt = torch.exp(log_dt)
        A = -torch.exp(log_A_real) + 1j * A_imag
        C = (C_real + 1j * C_imag) * dt[:, None]
        pos = (lambda x, dt: x.to(dt))(torch.arange(L), log_dt.dtype)
        P = torch.exp((A * dt[:, None])[:, :, None] * pos[None, None, :])
        K = 2.0 * torch.einsum("dn,dnl->dl", C, P).real
        L2 = 2 * L
        u_t = (lambda x, *d: x.permute(*d))(u, 0, 2, 1)
        Kf = (lambda x, *a, **k: torch.fft.rfft(x.float(), *a, **k))(K, L2)
        Uf = (lambda x, *a, **k: torch.fft.rfft(x.float(), *a, **k))(u_t, L2)
        y = (lambda x, *a, **k: torch.fft.irfft(x, *a, **k).to(torch.bfloat16))(Uf * Kf[None, :, :], L2)[:, :, :L]
        y = (lambda x, *d: x.permute(*d))(y, 0, 2, 1)
        return y + u * D_skip[None, None, :]

    def _B_ref(x, w1, b1, w2, b2):
        B, S, D = x.shape
        h = _layernorm(x, axis=-1)
        u = torch.einsum("bsd,sf->bdf", h, w1) + b1
        u = _gelu(u)
        y = torch.einsum("bdf,fs->bds", u, w2) + b2
        return (lambda x, *d: x.permute(*d))(y, 0, 2, 1)

    x = A_u
    h = x + _A_ref(_layernorm(x, axis=-1), A_log_A_real, A_A_imag, A_C_real, A_C_imag, A_log_dt, A_D_skip)
    h2 = h + _B_ref(_layernorm(h, axis=-1), B_w1, B_b1, B_w2, B_b2)
    return h2
```

```asm
; @launch grid=(256,1,1) block=(256,1,1) lds=163840
.amdgcn_target "amdgcn-amd-amdhsa--gfx950"
.text
.globl sequential_preLN__ssm_conv_s4d__mixer_token_mlp__prompt_kernel
.p2align 8
.type sequential_preLN__ssm_conv_s4d__mixer_token_mlp__prompt_kernel,@function
sequential_preLN__ssm_conv_s4d__mixer_token_mlp__prompt_kernel:
    s_cmp_ge_u32 s2, 256
    s_cbranch_scc1 L_end
    s_nop 0
    s_load_dwordx16 s[16:31], s[0:1], 0
    s_load_dwordx8 s[32:39], s[0:1], 64
    s_load_dwordx4 s[40:43], s[0:1], 96
    s_load_dwordx2 s[44:45], s[0:1], 112
    v_and_b32 v1, 63, v0
    v_lshrrev_b32 v2, 6, v0
    s_nop 0
    v_readfirstlane_b32 s3, v2
    s_and_b32 s4, s2, 7
    s_lshr_b32 s5, s2, 3
    s_lshr_b32 s10, s4, 2
    s_and_b32 s11, s4, 3
    s_mul_i32 s12, s11, 25
    s_mul_i32 s13, s11, 24
    s_add_u32 s13, s13, 100
    s_cmp_eq_u32 s10, 0
    s_cselect_b32 s9, s12, s13
    s_add_u32 s9, s9, s5
    s_mul_i32 s12, s9, 1338
    s_lshr_b32 s12, s12, 16
    s_mul_i32 s12, s12, 15
    s_add_u32 s6, s9, s12
    s_mul_i32 s12, s11, 3
    s_add_u32 s12, s12, s5
    s_sub_u32 s12, s12, 25
    s_lshl_b32 s13, s11, 2
    s_add_u32 s13, s13, s5
    s_sub_u32 s13, s13, 12
    s_cmp_eq_u32 s10, 0
    s_cselect_b32 s64, s12, s13
    s_mul_i32 s12, s64, 9363
    s_lshr_b32 s12, s12, 16
    s_mul_i32 s12, s12, 57
    s_add_u32 s12, s12, s64
    s_add_u32 s12, s12, 49
    s_sub_u32 s13, 25, s10
    s_cmp_ge_u32 s5, s13
    s_cselect_b32 s6, s12, s6
    s_lshl_b32 s9, s4, 2
    s_add_u32 s9, s9, s5
    s_sub_u32 s9, s9, 28
    s_lshr_b32 s10, s9, 3
    s_lshl_b32 s10, s10, 6
    s_and_b32 s9, s9, 7
    s_add_u32 s9, s9, s10
    s_add_u32 s9, s9, 56
    s_cmp_ge_u32 s5, 28
    s_cselect_b32 s6, s9, s6
    s_mul_i32 s7, s4, 28
    s_add_u32 s7, s7, s5
    v_lshlrev_b32 v2, 4, v1
    v_mov_b32 v3, 0x40000000
    v_cmp_gt_u32 vcc, 56, v1
    s_nop 1
    v_cndmask_b32 v2, v3, v2, vcc
    s_lshl_b32 s9, s6, 2
    s_add_u32 s9, s9, s3
    s_mul_i32 s9, s9, 1792
    s_lshr_b32 s10, s3, 1
    s_lshl_b32 s11, s7, 1
    s_add_u32 s11, s11, s10
    s_lshl_b32 s11, s11, 9
    s_and_b32 s12, s3, 1
    s_lshl_b32 s12, s12, 8
    s_add_u32 s11, s11, s12
    v_lshlrev_b32 v3, 2, v1
    s_lshl_b32 s13, s7, 2
    s_min_u32 s13, s13, 892
    s_getpc_b64 s[14:15]
L_pc:
    s_waitcnt lgkmcnt(0)
    s_mov_b32 s48, s16
    s_mov_b32 s49, s17
    s_nop 0
    s_mov_b32 s50, 1835008
    s_mov_b32 s51, 0x20000
    buffer_load_dwordx4 v[12:15], v2, s[48:51], s9 offen
    buffer_load_dwordx4 v[16:19], v2, s[48:51], s9 offen offset:896
    s_mov_b32 s56, s18
    s_mov_b32 s57, s19
    s_mov_b32 s58, 229376
    s_mov_b32 s59, 0x20000
    buffer_load_dword v36, v3, s[56:59], s11 offen
    s_mov_b32 s60, s20
    s_mov_b32 s61, s21
    s_mov_b32 s62, 229376
    s_mov_b32 s63, 0x20000
    buffer_load_dword v37, v3, s[60:63], s11 offen
    s_mov_b32 s64, s22
    s_mov_b32 s65, s23
    s_mov_b32 s66, 229376
    s_mov_b32 s67, 0x20000
    buffer_load_dword v38, v3, s[64:67], s11 offen
    s_mov_b32 s68, s24
    s_mov_b32 s69, s25
    s_mov_b32 s70, 229376
    s_mov_b32 s71, 0x20000
    buffer_load_dword v39, v3, s[68:71], s11 offen
    s_load_dword s46, s[26:27], s13
    s_load_dword s47, s[28:29], s13
    s_load_dword s8, s[44:45], 131072
    s_add_u32 s10, s14, L_table-L_pc
    s_addc_u32 s11, s15, 0
    v_lshlrev_b32 v4, 5, v0
    global_load_dwordx4 v[40:43], v4, s[10:11]
    global_load_dwordx4 v[44:47], v4, s[10:11] offset:16
    v_lshlrev_b32 v4, 7, v0
    v_min_u32 v4, L_table-L_pc, v4
    v_mov_b32 v5, 0
    s_cmp_ge_u32 s5, 28
    s_cbranch_scc1 L_pf
    v_mov_b32 v4, 0
L_pf:
    global_load_dword v249, v4, s[14:15]
    s_mov_b32 s52, s44
    s_mov_b32 s53, s45
    s_nop 0
    s_mov_b32 s54, 16777216
    s_mov_b32 s55, 0x20000
    s_and_b32 s9, s4, 3
    s_lshr_b32 s10, s4, 2
    s_mul_i32 s11, s10, 25
    s_add_u32 s11, s11, s5
    s_mul_i32 s12, s11, 37
    s_lshr_b32 s16, s12, 8
    s_mul_i32 s12, s16, 7
    s_sub_u32 s12, s11, s12
    s_and_b32 s22, s16, 3
    s_mul_i32 s22, s22, 3
    s_mul_i32 s17, s9, 7
    s_add_u32 s17, s17, s12
    s_sub_u32 s12, 25, s10
    s_cmp_lt_u32 s5, s12
    s_cselect_b32 s18, 1, 0
    s_mul_i32 s11, s10, 28
    s_add_u32 s11, s11, s5
    s_lshr_b32 s19, s11, 3
    s_and_b32 s12, s11, 7
    s_and_b32 s23, s19, 3
    s_mul_i32 s23, s23, 3
    s_lshl_b32 s9, s9, 3
    s_add_u32 s20, s9, s12
    s_cmp_lt_u32 s5, 28
    s_cselect_b32 s21, 1, 0
    v_mov_b32 v240, -1
    v_mov_b32 v241, -1
    v_mov_b32 v242, -1
    v_mov_b32 v243, -1
    v_lshlrev_b32 v238, 4, v1
    s_lshl_b32 s9, s7, 1
    s_lshr_b32 s10, s3, 1
    s_add_u32 s9, s9, s10
    s_mul_i32 s9, s9, 4224
    s_and_b32 s10, s3, 1
    s_lshl_b32 s10, s10, 11
    s_add_u32 s9, s9, s10
    s_add_u32 s9, s9, 3145728
    s_cmp_ge_u32 s5, 28
    s_cselect_b32 s66, 16777216, s9
    s_lshl_b32 s9, s16, 1
    s_and_b32 s10, s3, 1
    s_add_u32 s9, s9, s10
    s_mul_i32 s9, s9, 114688
    s_lshl_b32 s10, s17, 12
    s_add_u32 s9, s9, s10
    s_lshr_b32 s10, s3, 1
    s_lshl_b32 s10, s10, 11
    s_add_u32 s9, s9, s10
    s_add_u32 s9, s9, 9437184
    s_cmp_eq_u32 s18, 0
    s_cselect_b32 s67, 16777216, s9
    v_lshrrev_b32 v236, 5, v0
    v_lshlrev_b32 v236, 17, v236
    v_and_b32_e64 v237, 31, v0
    v_lshl_add_u32 v236, v237, 4, v236
    v_add_u32 v237, 0x100000, v236
    v_mov_b32 v239, 0x40000000
    v_cmp_gt_u32 vcc, 192, v0
    s_nop 1
    v_cndmask_b32 v237, v239, v237, vcc
    s_lshl_b32 s9, s6, 9
    s_add_u32 s68, s9, 5242880
    v_mov_b32 v48, 0
    v_mov_b32 v49, 0
    v_mov_b32 v50, 0
    v_mov_b32 v51, 0
    v_lshlrev_b32_e64 v4, 4, v0
    ds_write_b128 v4, v[48:51] offset:0
    ds_write_b128 v4, v[48:51] offset:4096
    ds_write_b128 v4, v[48:51] offset:8192
    ds_write_b128 v4, v[48:51] offset:12288
    ds_write_b128 v4, v[48:51] offset:16384
    v_mov_b32 v225, 0x3fb8aa3b
    v_mov_b32 v228, 0xbfb8aa3b
    v_mov_b32_e64 v230, 0x3e22f983
    v_mov_b32 v203, 0x32a57060
    s_mul_i32 s9, s3, 30208
    s_add_u32 s9, s9, 36864
    v_lshlrev_b32 v200, 3, v1
    v_add_u32 v245, s9, v200
    v_and_b32_e64 v201, 15, v1
    v_mul_u32_u24 v201, 528, v201
    v_bfe_u32 v200, v1, 4, 1
    v_lshl_add_u32 v201, v200, 8, v201
    v_lshrrev_b32 v200, 5, v1
    v_lshl_add_u32 v201, v200, 7, v201
    v_add_u32 v246, s9, v201
    v_mov_b32 v52, 0x3b124925
    v_mov_b32 v53, 0x3727c5ac
    v_mov_b32 v54, 0xffff0000
    s_mul_i32 s9, s3, 2176
    s_add_u32 s9, s9, 36864
    v_lshlrev_b32 v55, 4, v1
    v_add_u32 v55, s9, v55
    v_bfe_u32 v220, v1, 2, 2
    v_mul_u32_u24 v220, 1088, v220
    v_and_b32 v221, 3, v1
    v_lshlrev_b32 v221, 3, v221
    v_add_u32 v220, v220, v221
    v_lshrrev_b32 v221, 4, v1
    v_lshlrev_b32 v221, 5, v221
    v_add_u32 v220, v220, v221
    s_lshl_b32 s9, s3, 7
    s_add_u32 s9, s9, 36864
    v_add_u32 v220, s9, v220
    v_lshlrev_b32 v221, 4, v0
    v_add_u32 v222, 4096, v221
    v_mov_b32 v223, 0x40000000
    v_cmp_gt_u32 vcc, 192, v0
    s_nop 1
    v_cndmask_b32 v222, v223, v222, vcc
    s_mul_i32 s30, s6, 7168
    s_add_u32 s30, s30, 1048576
    s_waitcnt vmcnt(7)
    v_lshlrev_b32 v20, 16, v12
    v_and_b32 v21, v54, v12
    v_lshlrev_b32 v22, 16, v13
    v_and_b32 v23, v54, v13
    v_lshlrev_b32 v24, 16, v14
    v_and_b32 v25, v54, v14
    v_lshlrev_b32 v26, 16, v15
    v_and_b32 v27, v54, v15
    v_lshlrev_b32 v28, 16, v16
    v_and_b32 v29, v54, v16
    v_lshlrev_b32 v30, 16, v17
    v_and_b32 v31, v54, v17
    v_lshlrev_b32 v32, 16, v18
    v_and_b32 v33, v54, v18
    v_lshlrev_b32 v34, 16, v19
    v_and_b32_e64 v35, v54, v19
    ds_write_b128 v55, v[12:15] offset:8704
    ds_write_b128 v55, v[16:19] offset:9792
    v_pk_add_f32 v[56:57], v[20:21], v[22:23]
    v_pk_add_f32 v[58:59], v[24:25], v[26:27]
    v_pk_add_f32 v[60:61], v[28:29], v[30:31]
    v_pk_add_f32 v[62:63], v[32:33], v[34:35]
    v_pk_add_f32 v[56:57], v[56:57], v[58:59]
    v_pk_add_f32 v[60:61], v[60:61], v[62:63]
    v_add_f32 v56, v56, v57
    v_add_f32 v60, v60, v61
    s_nop 0
    s_nop 0
    v_add_f32_dpp v56, v56, v56 row_shr:1 row_mask:0xf bank_mask:0xf bound_ctrl:0
    v_add_f32_dpp v60, v60, v60 row_shr:1 row_mask:0xf bank_mask:0xf bound_ctrl:0
    s_nop 0
    s_nop 0
    v_add_f32_dpp v56, v56, v56 row_shr:2 row_mask:0xf bank_mask:0xf bound_ctrl:0
    v_add_f32_dpp v60, v60, v60 row_shr:2 row_mask:0xf bank_mask:0xf bound_ctrl:0
    s_nop 0
    s_nop 0
    v_add_f32_dpp v56, v56, v56 row_shr:4 row_mask:0xf bank_mask:0xf bound_ctrl:0
    v_add_f32_dpp v60, v60, v60 row_shr:4 row_mask:0xf bank_mask:0xf bound_ctrl:0
    s_nop 0
    s_nop 0
    v_add_f32_dpp v56, v56, v56 row_shr:8 row_mask:0xf bank_mask:0xf bound_ctrl:0
    v_add_f32_dpp v60, v60, v60 row_shr:8 row_mask:0xf bank_mask:0xf bound_ctrl:0
    s_nop 0
    s_nop 0
    v_add_f32_dpp v56, v56, v56 row_bcast:15 row_mask:0xa bank_mask:0xf
    v_add_f32_dpp v60, v60, v60 row_bcast:15 row_mask:0xa bank_mask:0xf
    s_nop 0
    s_nop 0
    v_add_f32_dpp v56, v56, v56 row_bcast:31 row_mask:0xc bank_mask:0xf
    v_add_f32_dpp v60, v60, v60 row_bcast:31 row_mask:0xc bank_mask:0xf
    v_readlane_b32 s9, v56, 63
    v_readlane_b32 s10, v60, 63
    s_nop 0
    v_mul_f32 v58, s9, v52
    v_mul_f32 v62, s10, v52
    v_cvt_pk_bf16_f32 v57, v58, v62
    v_lshlrev_b32 v64, 16, v57
    v_and_b32 v66, v54, v57
    v_sub_f32 v65, v58, v64
    v_sub_f32_e64 v67, v62, v66
    v_pk_add_f32 v[20:21], v[20:21], v[64:65] op_sel_hi:[1,0] neg_lo:[0,1] neg_hi:[0,1]
    v_pk_add_f32 v[22:23], v[22:23], v[64:65] op_sel_hi:[1,0] neg_lo:[0,1] neg_hi:[0,1]
    v_pk_add_f32 v[24:25], v[24:25], v[64:65] op_sel_hi:[1,0] neg_lo:[0,1] neg_hi:[0,1]
    v_pk_add_f32 v[26:27], v[26:27], v[64:65] op_sel_hi:[1,0] neg_lo:[0,1] neg_hi:[0,1]
    v_pk_add_f32 v[28:29], v[28:29], v[66:67] op_sel_hi:[1,0] neg_lo:[0,1] neg_hi:[0,1]
    v_pk_add_f32 v[30:31], v[30:31], v[66:67] op_sel_hi:[1,0] neg_lo:[0,1] neg_hi:[0,1]
    v_pk_add_f32 v[32:33], v[32:33], v[66:67] op_sel_hi:[1,0] neg_lo:[0,1] neg_hi:[0,1]
    v_pk_add_f32 v[34:35], v[34:35], v[66:67] op_sel_hi:[1,0] neg_lo:[0,1] neg_hi:[0,1]
    v_pk_mul_f32 v[56:57], v[20:21], v[20:21]
    v_pk_mul_f32 v[60:61], v[28:29], v[28:29]
    v_pk_fma_f32 v[56:57], v[22:23], v[22:23], v[56:57]
    v_pk_fma_f32 v[60:61], v[30:31], v[30:31], v[60:61]
    v_pk_fma_f32 v[56:57], v[24:25], v[24:25], v[56:57]
    v_pk_fma_f32 v[60:61], v[32:33], v[32:33], v[60:61]
    v_pk_fma_f32 v[56:57], v[26:27], v[26:27], v[56:57]
    v_pk_fma_f32 v[60:61], v[34:35], v[34:35], v[60:61]
    v_cmp_gt_u32 vcc, 56, v1
    v_add_f32 v56, v56, v57
    v_add_f32 v60, v60, v61
    v_cndmask_b32 v56, 0, v56, vcc
    v_cndmask_b32 v60, 0, v60, vcc
    s_nop 0
    v_add_f32_dpp v56, v56, v56 row_shr:1 row_mask:0xf bank_mask:0xf bound_ctrl:0
    v_add_f32_dpp v60, v60, v60 row_shr:1 row_mask:0xf bank_mask:0xf bound_ctrl:0
    s_nop 0
    s_nop 0
    v_add_f32_dpp v56, v56, v56 row_shr:2 row_mask:0xf bank_mask:0xf bound_ctrl:0
    v_add_f32_dpp v60, v60, v60 row_shr:2 row_mask:0xf bank_mask:0xf bound_ctrl:0
    s_nop 0
    s_nop 0
    v_add_f32_dpp v56, v56, v56 row_shr:4 row_mask:0xf bank_mask:0xf bound_ctrl:0
    v_add_f32_dpp v60, v60, v60 row_shr:4 row_mask:0xf bank_mask:0xf bound_ctrl:0
    s_nop 0
    s_nop 0
    v_add_f32_dpp v56, v56, v56 row_shr:8 row_mask:0xf bank_mask:0xf bound_ctrl:0
    v_add_f32_dpp v60, v60, v60 row_shr:8 row_mask:0xf bank_mask:0xf bound_ctrl:0
    s_nop 0
    s_nop 0
    v_add_f32_dpp v56, v56, v56 row_bcast:15 row_mask:0xa bank_mask:0xf
    v_add_f32_dpp v60, v60, v60 row_bcast:15 row_mask:0xa bank_mask:0xf
    s_nop 0
    s_nop 0
    v_add_f32_dpp v56, v56, v56 row_bcast:31 row_mask:0xc bank_mask:0xf
    v_add_f32_dpp v60, v60, v60 row_bcast:31 row_mask:0xc bank_mask:0xf
    v_readlane_b32 s9, v56, 63
    v_readlane_b32 s10, v60, 63
    s_nop 0
    v_mul_f32 v58, s9, v52
    v_mul_f32_e64 v62, s10, v52
    v_fma_f32 v58, -v65, v65, v58
    v_fma_f32 v62, -v67, v67, v62
    v_cvt_pk_bf16_f32 v12, v20, v21
    v_cvt_pk_bf16_f32 v13, v22, v23
    v_cvt_pk_bf16_f32 v14, v24, v25
    v_cvt_pk_bf16_f32 v15, v26, v27
    v_cvt_pk_bf16_f32 v16, v28, v29
    v_cvt_pk_bf16_f32 v17, v30, v31
    v_cvt_pk_bf16_f32 v18, v32, v33
    v_cvt_pk_bf16_f32 v19, v34, v35
    v_cvt_pk_bf16_f32 v57, v58, v62
    v_lshlrev_b32 v58, 16, v57
    v_and_b32 v62, v54, v57
    v_add_f32 v58, v58, v53
    v_add_f32 v62, v62, v53
    v_cvt_pk_bf16_f32 v57, v58, v62
    v_lshlrev_b32 v58, 16, v57
    v_and_b32 v62, v54, v57
    v_sqrt_f32 v58, v58
    v_sqrt_f32 v62, v62
    v_lshlrev_b32 v20, 16, v12
    v_and_b32 v21, v54, v12
    v_lshlrev_b32 v22, 16, v13
    v_and_b32 v23, v54, v13
    v_lshlrev_b32 v24, 16, v14
    v_and_b32 v25, v54, v14
    v_lshlrev_b32 v26, 16, v15
    v_and_b32 v27, v54, v15
    v_cvt_pk_bf16_f32 v57, v58, v62
    v_lshlrev_b32 v58, 16, v57
    v_and_b32 v62, v54, v57
    v_rcp_f32 v58, v58
    v_rcp_f32 v62, v62
    v_lshlrev_b32 v28, 16, v16
    v_and_b32 v29, v54, v16
    v_lshlrev_b32 v30, 16, v17
    v_and_b32 v31, v54, v17
    v_lshlrev_b32 v32, 16, v18
    v_and_b32 v33, v54, v18
    v_lshlrev_b32 v34, 16, v19
    v_and_b32 v35, v54, v19
    v_pk_mul_f32 v[20:21], v[20:21], v[58:59] op_sel_hi:[1,0]
    v_pk_mul_f32 v[22:23], v[22:23], v[58:59] op_sel_hi:[1,0]
    v_pk_mul_f32 v[24:25], v[24:25], v[58:59] op_sel_hi:[1,0]
    v_pk_mul_f32 v[26:27], v[26:27], v[58:59] op_sel_hi:[1,0]
    v_pk_mul_f32 v[28:29], v[28:29], v[62:63] op_sel_hi:[1,0]
    v_pk_mul_f32 v[30:31], v[30:31], v[62:63] op_sel_hi:[1,0]
    v_pk_mul_f32 v[32:33], v[32:33], v[62:63] op_sel_hi:[1,0]
    v_pk_mul_f32 v[34:35], v[34:35], v[62:63] op_sel_hi:[1,0]
    v_cvt_pk_bf16_f32 v12, v20, v21
    v_cvt_pk_bf16_f32 v13, v22, v23
    v_cvt_pk_bf16_f32 v14, v24, v25
    v_cvt_pk_bf16_f32 v15, v26, v27
    v_cvt_pk_bf16_f32 v16, v28, v29
    v_cvt_pk_bf16_f32 v17, v30, v31
    v_cvt_pk_bf16_f32 v18, v32, v33
    v_cvt_pk_bf16_f32 v19, v34, v35
    ds_write_b128 v55, v[12:15]
    ds_write_b128 v55, v[16:19] offset:1088
    s_waitcnt lgkmcnt(0)
    s_barrier
    ds_read_b64_tr_b16 v[60:61], v220 offset:0
    ds_read_b64_tr_b16 v[62:63], v220 offset:4352
    ds_read_b64_tr_b16 v[64:65], v220 offset:512
    ds_read_b64_tr_b16 v[66:67], v220 offset:4864
    ds_read_b64_tr_b16 v[4:5], v220 offset:8704
    ds_read_b64_tr_b16 v[6:7], v220 offset:13056
    ds_read_b64_tr_b16 v[8:9], v220 offset:9216
    ds_read_b64_tr_b16 v[10:11], v220 offset:13568
    s_mul_i32 s8, s8, 0x9E3779B1
    s_add_u32 s8, s8, 0x7F4A7C15
    s_lshr_b32 s9, s3, 1
    s_lshl_b32 s9, s9, 4
    s_lshr_b32 s10, s46, s9
    s_lshl_b32 s10, s10, 16
    s_lshr_b32 s11, s47, s9
    s_lshl_b32 s47, s11, 16
    v_mov_b32 v200, s10
    v_mul_f32 v201, v200, v225
    v_rndne_f32 v201, v201
    v_fma_f32 v202, v200, v225, -v201
    v_fmac_f32 v202, v200, v203
    v_exp_f32 v202, v202
    v_cvt_i32_f32 v201, v201
    v_ldexp_f32 v202, v202, v201
    v_cvt_pk_bf16_f32 v202, v202, v202
    v_lshlrev_b32 v224, 16, v202
    v_add_f32 v226, v224, v224
    s_waitcnt lgkmcnt(4)
    s_nop 0
    buffer_store_dwordx4 v[60:63], v221, s[52:55], s30 offen sc1
    buffer_store_dwordx4 v[64:67], v222, s[52:55], s30 offen sc1
    s_waitcnt lgkmcnt(0)
    s_barrier
    s_cmp_ge_u32 s5, 28
    s_cbranch_scc1 L_noconv_a
    s_waitcnt vmcnt(5)
    v_lshlrev_b32 v20, 16, v36
    v_and_b32 v24, v54, v36
    v_lshlrev_b32 v21, 16, v37
    v_and_b32 v25, v54, v37
    v_lshlrev_b32 v22, 16, v38
    v_and_b32 v26, v54, v38
    v_lshlrev_b32 v23, 16, v39
    v_and_b32 v27, v54, v39
    v_mul_f32 v32, v225, v20
    v_mul_f32 v34, v225, v24
    v_exp_f32 v32, v32
    v_exp_f32 v34, v34
    v_mul_f32 v29, v21, v224
    v_mul_f32_e64 v31, v25, v224
    v_cvt_pk_bf16_f32 v32, v32, v32
    v_cvt_pk_bf16_f32 v34, v34, v34
    v_mul_f32 v29, v29, v230
    v_mul_f32 v31, v31, v230
    v_lshlrev_b32 v32, 16, v32
    v_lshlrev_b32 v34, 16, v34
    v_mul_f32 v32, v32, v224
    v_mul_f32 v34, v34, v224
    v_mul_f32 v28, v32, v228
    v_mul_f32 v30, v34, v228
    v_fract_f32 v33, v29
    v_exp_f32 v32, v28
    v_fract_f32 v35, v31
    v_exp_f32 v34, v30
    v_cos_f32 v64, v33
    v_sin_f32 v65, v33
    v_cos_f32 v96, v35
    v_sin_f32 v97, v35
    v_pk_mul_f32 v[64:65], v[64:65], v[32:33] op_sel_hi:[1,0]
    v_pk_mul_f32 v[96:97], v[96:97], v[34:35] op_sel_hi:[1,0]
    v_mul_f32 v33, 0x41000000, v29
    v_mul_f32 v32, 0x41000000, v28
    v_fract_f32 v33, v33
    v_exp_f32 v32, v32
    v_mul_f32 v35, 0x41000000, v31
    v_mul_f32 v34, 0x41000000, v30
    v_fract_f32 v35, v35
    v_exp_f32 v34, v34
    v_cos_f32 v78, v33
    v_sin_f32 v79, v33
    v_cos_f32 v110, v35
    v_sin_f32 v111, v35
    v_pk_mul_f32 v[78:79], v[78:79], v[32:33] op_sel_hi:[1,0]
    v_pk_mul_f32 v[110:111], v[110:111], v[34:35] op_sel_hi:[1,0]
    v_mul_f32 v33, 0x43000000, v29
    v_mul_f32 v32, 0x43000000, v28
    v_fract_f32 v33, v33
    v_exp_f32 v32, v32
    v_mul_f32 v35, 0x43000000, v31
    v_mul_f32 v34, 0x43000000, v30
    v_fract_f32 v35, v35
    v_exp_f32 v34, v34
    v_cos_f32 v80, v33
    v_sin_f32 v81, v33
    v_cos_f32 v112, v35
    v_sin_f32 v113, v35
    v_pk_mul_f32 v[80:81], v[80:81], v[32:33] op_sel_hi:[1,0]
    v_pk_mul_f32 v[112:113], v[112:113], v[34:35] op_sel_hi:[1,0]
    v_pk_mul_f32 v[82:83], v[22:23], v[226:227] op_sel_hi:[1,0]
    v_pk_mul_f32 v[114:115], v[26:27], v[226:227] op_sel_hi:[1,0]
    v_pk_mul_f32 v[66:67], v[64:65], v[64:65] op_sel:[0,0] op_sel_hi:[0,1]
    v_pk_fma_f32 v[66:67], v[64:65], v[64:65], v[66:67] op_sel:[1,1,0] op_sel_hi:[1,0,1] neg_lo:[0,1,0]
    v_pk_mul_f32 v[98:99], v[96:97], v[96:97] op_sel:[0,0] op_sel_hi:[0,1]
    v_pk_fma_f32 v[98:99], v[96:97], v[96:97], v[98:99] op_sel:[1,1,0] op_sel_hi:[1,0,1] neg_lo:[0,1,0]
    v_cvt_pk_bf16_f32 v36, v82, -v83
    v_cvt_pk_bf16_f32 v37, v114, -v115
    ds_write_b64 v245, v[36:37] offset:0
    v_pk_mul_f32 v[84:85], v[82:83], v[78:79] op_sel:[0,0] op_sel_hi:[0,1]
    v_pk_fma_f32 v[84:85], v[82:83], v[78:79], v[84:85] op_sel:[1,1,0] op_sel_hi:[1,0,1] neg_lo:[0,1,0]
    v_pk_mul_f32 v[116:117], v[114:115], v[110:111] op_sel:[0,0] op_sel_hi:[0,1]
    v_pk_fma_f32 v[116:117], v[114:115], v[110:111], v[116:117] op_sel:[1,1,0] op_sel_hi:[1,0,1] neg_lo:[0,1,0]
    v_pk_mul_f32 v[68:69], v[66:67], v[64:65] op_sel:[0,0] op_sel_hi:[0,1]
    v_pk_fma_f32 v[68:69], v[66:67], v[64:65], v[68:69] op_sel:[1,1,0] op_sel_hi:[1,0,1] neg_lo:[0,1,0]
    v_pk_mul_f32 v[100:101], v[98:99], v[96:97] op_sel:[0,0] op_sel_hi:[0,1]
    v_pk_fma_f32 v[100:101], v[98:99], v[96:97], v[100:101] op_sel:[1,1,0] op_sel_hi:[1,0,1] neg_lo:[0,1,0]
    v_cvt_pk_bf16_f32 v38, v84, -v85
    v_cvt_pk_bf16_f32 v39, v116, -v117
    ds_write_b64 v245, v[38:39] offset:528
    v_pk_mul_f32 v[82:83], v[84:85], v[78:79] op_sel:[0,0] op_sel_hi:[0,1]
    v_pk_fma_f32 v[82:83], v[84:85], v[78:79], v[82:83] op_sel:[1,1,0] op_sel_hi:[1,0,1] neg_lo:[0,1,0]
    v_pk_mul_f32 v[114:115], v[116:117], v[110:111] op_sel:[0,0] op_sel_hi:[0,1]
    v_pk_fma_f32 v[114:115], v[116:117], v[110:111], v[114:115] op_sel:[1,1,0] op_sel_hi:[1,0,1] neg_lo:[0,1,0]
    v_pk_mul_f32 v[70:71], v[66:67], v[66:67] op_sel:[0,0] op_sel_hi:[0,1]
    v_pk_fma_f32 v[70:71], v[66:67], v[66:67], v[70:71] op_sel:[1,1,0] op_sel_hi:[1,0,1] neg_lo:[0,1,0]
    v_pk_mul_f32 v[102:103], v[98:99], v[98:99] op_sel:[0,0] op_sel_hi:[0,1]
    v_pk_fma_f32 v[102:103], v[98:99], v[98:99], v[102:103] op_sel:[1,1,0] op_sel_hi:[1,0,1] neg_lo:[0,1,0]
    v_cvt_pk_bf16_f32 v36, v82, -v83
    v_cvt_pk_bf16_f32 v37, v114, -v115
    ds_write_b64 v245, v[36:37] offset:1056
    v_pk_mul_f32 v[84:85], v[82:83], v[78:79] op_sel:[0,0] op_sel_hi:[0,1]
    v_pk_fma_f32 v[84:85], v[82:83], v[78:79], v[84:85] op_sel:[1,1,0] op_sel_hi:[1,0,1] neg_lo:[0,1,0]
    v_pk_mul_f32 v[116:117], v[114:115], v[110:111] op_sel:[0,0] op_sel_hi:[0,1]
    v_pk_fma_f32 v[116:117], v[114:115], v[110:111], v[116:117] op_sel:[1,1,0] op_sel_hi:[1,0,1] neg_lo:[0,1,0]
    v_pk_mul_f32 v[72:73], v[70:71], v[64:65] op_sel:[0,0] op_sel_hi:[0,1]
    v_pk_fma_f32 v[72:73], v[70:71], v[64:65], v[72:73] op_sel:[1,1,0] op_sel_hi:[1,0,1] neg_lo:[0,1,0]
    v_pk_mul_f32 v[104:105], v[102:103], v[96:97] op_sel:[0,0] op_sel_hi:[0,1]
    v_pk_fma_f32 v[104:105], v[102:103], v[96:97], v[104:105] op_sel:[1,1,0] op_sel_hi:[1,0,1] neg_lo:[0,1,0]
    v_cvt_pk_bf16_f32 v38, v84, -v85
    v_cvt_pk_bf16_f32 v39, v116, -v117
    ds_write_b64 v245, v[38:39] offset:1584
    v_pk_mul_f32 v[82:83], v[84:85], v[78:79] op_sel:[0,0] op_sel_hi:[0,1]
    v_pk_fma_f32 v[82:83], v[84:85], v[78:79], v[82:83] op_sel:[1,1,0] op_sel_hi:[1,0,1] neg_lo:[0,1,0]
    v_pk_mul_f32 v[114:115], v[116:117], v[110:111] op_sel:[0,0] op_sel_hi:[0,1]
    v_pk_fma_f32 v[114:115], v[116:117], v[110:111], v[114:115] op_sel:[1,1,0] op_sel_hi:[1,0,1] neg_lo:[0,1,0]
    v_pk_mul_f32 v[74:75], v[70:71], v[66:67] op_sel:[0,0] op_sel_hi:[0,1]
    v_pk_fma_f32 v[74:75], v[70:71], v[66:67], v[74:75] op_sel:[1,1,0] op_sel_hi:[1,0,1] neg_lo:[0,1,0]
    v_pk_mul_f32 v[106:107], v[102:103], v[98:99] op_sel:[0,0] op_sel_hi:[0,1]
    v_pk_fma_f32 v[106:107], v[102:103], v[98:99], v[106:107] op_sel:[1,1,0] op_sel_hi:[1,0,1] neg_lo:[0,1,0]
    v_cvt_pk_bf16_f32 v36, v82, -v83
    v_cvt_pk_bf16_f32 v37, v114, -v115
    ds_write_b64 v245, v[36:37] offset:2112
    v_pk_mul_f32 v[84:85], v[82:83], v[78:79] op_sel:[0,0] op_sel_hi:[0,1]
    v_pk_fma_f32 v[84:85], v[82:83], v[78:79], v[84:85] op_sel:[1,1,0] op_sel_hi:[1,0,1] neg_lo:[0,1,0]
    v_pk_mul_f32 v[116:117], v[114:115], v[110:111] op_sel:[0,0] op_sel_hi:[0,1]
    v_pk_fma_f32 v[116:117], v[114:115], v[110:111], v[116:117] op_sel:[1,1,0] op_sel_hi:[1,0,1] neg_lo:[0,1,0]
    v_pk_mul_f32 v[76:77], v[70:71], v[68:69] op_sel:[0,0] op_sel_hi:[0,1]
    v_pk_fma_f32 v[76:77], v[70:71], v[68:69], v[76:77] op_sel:[1,1,0] op_sel_hi:[1,0,1] neg_lo:[0,1,0]
    v_pk_mul_f32 v[108:109], v[102:103], v[100:101] op_sel:[0,0] op_sel_hi:[0,1]
    v_pk_fma_f32 v[108:109], v[102:103], v[100:101], v[108:109] op_sel:[1,1,0] op_sel_hi:[1,0,1] neg_lo:[0,1,0]
    v_cvt_pk_bf16_f32 v38, v84, -v85
    v_cvt_pk_bf16_f32 v39, v116, -v117
    ds_write_b64 v245, v[38:39] offset:2640
    v_pk_mul_f32 v[82:83], v[84:85], v[78:79] op_sel:[0,0] op_sel_hi:[0,1]
    v_pk_fma_f32 v[82:83], v[84:85], v[78:79], v[82:83] op_sel:[1,1,0] op_sel_hi:[1,0,1] neg_lo:[0,1,0]
    v_pk_mul_f32 v[114:115], v[116:117], v[110:111] op_sel:[0,0] op_sel_hi:[0,1]
    v_pk_fma_f32 v[114:115], v[116:117], v[110:111], v[114:115] op_sel:[1,1,0] op_sel_hi:[1,0,1] neg_lo:[0,1,0]
    v_cvt_pk_bf16_f32 v36, v82, -v83
    v_cvt_pk_bf16_f32 v37, v114, -v115
    ds_write_b64 v245, v[36:37] offset:3168
    v_pk_mul_f32 v[84:85], v[82:83], v[78:79] op_sel:[0,0] op_sel_hi:[0,1]
    v_pk_fma_f32 v[84:85], v[82:83], v[78:79], v[84:85] op_sel:[1,1,0] op_sel_hi:[1,0,1] neg_lo:[0,1,0]
    v_pk_mul_f32 v[116:117], v[114:115], v[110:111] op_sel:[0,0] op_sel_hi:[0,1]
    v_pk_fma_f32 v[116:117], v[114:115], v[110:111], v[116:117] op_sel:[1,1,0] op_sel_hi:[1,0,1] neg_lo:[0,1,0]
    v_cvt_pk_bf16_f32 v38, v84, -v85
    v_cvt_pk_bf16_f32 v39, v116, -v117
    ds_write_b64 v245, v[38:39] offset:3696
    v_pk_mul_f32 v[82:83], v[84:85], v[78:79] op_sel:[0,0] op_sel_hi:[0,1]
    v_pk_fma_f32 v[82:83], v[84:85], v[78:79], v[82:83] op_sel:[1,1,0] op_sel_hi:[1,0,1] neg_lo:[0,1,0]
    v_pk_mul_f32 v[114:115], v[116:117], v[110:111] op_sel:[0,0] op_sel_hi:[0,1]
    v_pk_fma_f32 v[114:115], v[116:117], v[110:111], v[114:115] op_sel:[1,1,0] op_sel_hi:[1,0,1] neg_lo:[0,1,0]
    v_cvt_pk_bf16_f32 v36, v82, -v83
    v_cvt_pk_bf16_f32 v37, v114, -v115
    ds_write_b64 v245, v[36:37] offset:4224
    v_pk_mul_f32 v[84:85], v[82:83], v[78:79] op_sel:[0,0] op_sel_hi:[0,1]
    v_pk_fma_f32 v[84:85], v[82:83], v[78:79], v[84:85] op_sel:[1,1,0] op_sel_hi:[1,0,1] neg_lo:[0,1,0]
    v_pk_mul_f32 v[116:117], v[114:115], v[110:111] op_sel:[0,0] op_sel_hi:[0,1]
    v_pk_fma_f32 v[116:117], v[114:115], v[110:111], v[116:117] op_sel:[1,1,0] op_sel_hi:[1,0,1] neg_lo:[0,1,0]
    v_cvt_pk_bf16_f32 v38, v84, -v85
    v_cvt_pk_bf16_f32 v39, v116, -v117
    ds_write_b64 v245, v[38:39] offset:4752
    v_pk_mul_f32 v[82:83], v[84:85], v[78:79] op_sel:[0,0] op_sel_hi:[0,1]
    v_pk_fma_f32 v[82:83], v[84:85], v[78:79], v[82:83] op_sel:[1,1,0] op_sel_hi:[1,0,1] neg_lo:[0,1,0]
    v_pk_mul_f32 v[114:115], v[116:117], v[110:111] op_sel:[0,0] op_sel_hi:[0,1]
    v_pk_fma_f32 v[114:115], v[116:117], v[110:111], v[114:115] op_sel:[1,1,0] op_sel_hi:[1,0,1] neg_lo:[0,1,0]
    v_cvt_pk_bf16_f32 v36, v82, -v83
    v_cvt_pk_bf16_f32 v37, v114, -v115
    ds_write_b64 v245, v[36:37] offset:5280
    v_pk_mul_f32 v[84:85], v[82:83], v[78:79] op_sel:[0,0] op_sel_hi:[0,1]
    v_pk_fma_f32 v[84:85], v[82:83], v[78:79], v[84:85] op_sel:[1,1,0] op_sel_hi:[1,0,1] neg_lo:[0,1,0]
    v_pk_mul_f32 v[116:117], v[114:115], v[110:111] op_sel:[0,0] op_sel_hi:[0,1]
    v_pk_fma_f32 v[116:117], v[114:115], v[110:111], v[116:117] op_sel:[1,1,0] op_sel_hi:[1,0,1] neg_lo:[0,1,0]
    v_cvt_pk_bf16_f32 v38, v84, -v85
    v_cvt_pk_bf16_f32 v39, v116, -v117
    ds_write_b64 v245, v[38:39] offset:5808
    v_pk_mul_f32 v[82:83], v[84:85], v[78:79] op_sel:[0,0] op_sel_hi:[0,1]
    v_pk_fma_f32 v[82:83], v[84:85], v[78:79], v[82:83] op_sel:[1,1,0] op_sel_hi:[1,0,1] neg_lo:[0,1,0]
    v_pk_mul_f32 v[114:115], v[116:117], v[110:111] op_sel:[0,0] op_sel_hi:[0,1]
    v_pk_fma_f32 v[114:115], v[116:117], v[110:111], v[114:115] op_sel:[1,1,0] op_sel_hi:[1,0,1] neg_lo:[0,1,0]
    v_cvt_pk_bf16_f32 v36, v82, -v83
    v_cvt_pk_bf16_f32 v37, v114, -v115
    ds_write_b64 v245, v[36:37] offset:6336
    v_pk_mul_f32 v[84:85], v[82:83], v[78:79] op_sel:[0,0] op_sel_hi:[0,1]
    v_pk_fma_f32 v[84:85], v[82:83], v[78:79], v[84:85] op_sel:[1,1,0] op_sel_hi:[1,0,1] neg_lo:[0,1,0]
    v_pk_mul_f32 v[116:117], v[114:115], v[110:111] op_sel:[0,0] op_sel_hi:[0,1]
    v_pk_fma_f32 v[116:117], v[114:115], v[110:111], v[116:117] op_sel:[1,1,0] op_sel_hi:[1,0,1] neg_lo:[0,1,0]
    v_cvt_pk_bf16_f32 v38, v84, -v85
    v_cvt_pk_bf16_f32 v39, v116, -v117
    ds_write_b64 v245, v[38:39] offset:6864
    v_pk_mul_f32 v[82:83], v[84:85], v[78:79] op_sel:[0,0] op_sel_hi:[0,1]
    v_pk_fma_f32 v[82:83], v[84:85], v[78:79], v[82:83] op_sel:[1,1,0] op_sel_hi:[1,0,1] neg_lo:[0,1,0]
    v_pk_mul_f32 v[114:115], v[116:117], v[110:111] op_sel:[0,0] op_sel_hi:[0,1]
    v_pk_fma_f32 v[114:115], v[116:117], v[110:111], v[114:115] op_sel:[1,1,0] op_sel_hi:[1,0,1] neg_lo:[0,1,0]
    v_cvt_pk_bf16_f32 v36, v82, -v83
    v_cvt_pk_bf16_f32 v37, v114, -v115
    ds_write_b64 v245, v[36:37] offset:7392
    v_pk_mul_f32 v[84:85], v[82:83], v[78:79] op_sel:[0,0] op_sel_hi:[0,1]
    v_pk_fma_f32 v[84:85], v[82:83], v[78:79], v[84:85] op_sel:[1,1,0] op_sel_hi:[1,0,1] neg_lo:[0,1,0]
    v_pk_mul_f32 v[116:117], v[114:115], v[110:111] op_sel:[0,0] op_sel_hi:[0,1]
    v_pk_fma_f32 v[116:117], v[114:115], v[110:111], v[116:117] op_sel:[1,1,0] op_sel_hi:[1,0,1] neg_lo:[0,1,0]
    v_cvt_pk_bf16_f32 v38, v84, -v85
    v_cvt_pk_bf16_f32 v39, v116, -v117
    ds_write_b64 v245, v[38:39] offset:7920
    s_waitcnt vmcnt(0)
    s_barrier
    s_cmp_lg_u32 s3, 0
    s_cbranch_scc1 L_arr0
    v_mov_b32 v250, s8
    v_mov_b32 v251, 0
    s_lshl_b32 s9, s2, 7
    s_add_u32 s9, s9, 0
    s_mov_b64 s[10:11], exec
    s_mov_b64 exec, 1
    buffer_store_dword v250, v251, s[52:55], s9 offen sc1
    s_mov_b64 exec, s[10:11]
L_arr0:
    s_nop 0
    v_mov_b32 v60, 0x3f80
    v_mov_b32 v61, 0x3f80
    ds_write_b64 v245, v[60:61] offset:8448
    v_cvt_pk_bf16_f32 v36, v64, v65
    v_cvt_pk_bf16_f32 v37, v96, v97
    ds_write_b64 v245, v[36:37] offset:8976
    v_cvt_pk_bf16_f32 v38, v66, v67
    v_cvt_pk_bf16_f32 v39, v98, v99
    ds_write_b64 v245, v[38:39] offset:9504
    buffer_store_dwordx4 v[240:243], v238, s[52:55], s66 offen sc1
    v_cvt_pk_bf16_f32 v36, v68, v69
    v_cvt_pk_bf16_f32 v37, v100, v101
    ds_write_b64 v245, v[36:37] offset:10032
    v_cvt_pk_bf16_f32 v38, v70, v71
    v_cvt_pk_bf16_f32 v39, v102, v103
    ds_write_b64 v245, v[38:39] offset:10560
    v_cvt_pk_bf16_f32 v36, v72, v73
    v_cvt_pk_bf16_f32 v37, v104, v105
    ds_write_b64 v245, v[36:37] offset:11088
    buffer_store_dwordx4 v[240:243], v238, s[52:55], s66 offen offset:1024 sc1
    v_cvt_pk_bf16_f32 v38, v74, v75
    v_cvt_pk_bf16_f32 v39, v106, v107
    ds_write_b64 v245, v[38:39] offset:11616
    v_cvt_pk_bf16_f32 v36, v76, v77
    v_cvt_pk_bf16_f32 v37, v108, v109
    ds_write_b64 v245, v[36:37] offset:12144
    v_cvt_pk_bf16_f32 v38, v80, v81
    v_cvt_pk_bf16_f32 v39, v112, v113
    ds_write_b64 v245, v[38:39] offset:12672
    buffer_store_dwordx4 v[240:243], v236, s[52:55], s68 offen sc1
    v_pk_mul_f32 v[86:87], v[80:81], v[64:65] op_sel:[0,0] op_sel_hi:[0,1]
    v_pk_fma_f32 v[86:87], v[80:81], v[64:65], v[86:87] op_sel:[1,1,0] op_sel_hi:[1,0,1] neg_lo:[0,1,0]
    v_pk_mul_f32 v[118:119], v[112:113], v[96:97] op_sel:[0,0] op_sel_hi:[0,1]
    v_pk_fma_f32 v[118:119], v[112:113], v[96:97], v[118:119] op_sel:[1,1,0] op_sel_hi:[1,0,1] neg_lo:[0,1,0]
    v_cvt_pk_bf16_f32 v36, v86, v87
    v_cvt_pk_bf16_f32 v37, v118, v119
    ds_write_b64 v245, v[36:37] offset:13200
    v_pk_mul_f32 v[88:89], v[80:81], v[66:67] op_sel:[0,0] op_sel_hi:[0,1]
    v_pk_fma_f32 v[88:89], v[80:81], v[66:67], v[88:89] op_sel:[1,1,0] op_sel_hi:[1,0,1] neg_lo:[0,1,0]
    v_pk_mul_f32 v[120:121], v[112:113], v[98:99] op_sel:[0,0] op_sel_hi:[0,1]
    v_pk_fma_f32 v[120:121], v[112:113], v[98:99], v[120:121] op_sel:[1,1,0] op_sel_hi:[1,0,1] neg_lo:[0,1,0]
    v_cvt_pk_bf16_f32 v38, v88, v89
    v_cvt_pk_bf16_f32 v39, v120, v121
    ds_write_b64 v245, v[38:39] offset:13728
    v_pk_mul_f32 v[86:87], v[80:81], v[68:69] op_sel:[0,0] op_sel_hi:[0,1]
    v_pk_fma_f32 v[86:87], v[80:81], v[68:69], v[86:87] op_sel:[1,1,0] op_sel_hi:[1,0,1] neg_lo:[0,1,0]
    v_pk_mul_f32 v[118:119], v[112:113], v[100:101] op_sel:[0,0] op_sel_hi:[0,1]
    v_pk_fma_f32 v[118:119], v[112:113], v[100:101], v[118:119] op_sel:[1,1,0] op_sel_hi:[1,0,1] neg_lo:[0,1,0]
    v_cvt_pk_bf16_f32 v36, v86, v87
    v_cvt_pk_bf16_f32 v37, v118, v119
    ds_write_b64 v245, v[36:37] offset:14256
    buffer_store_dwordx4 v[240:243], v237, s[52:55], s68 offen sc1
    v_pk_mul_f32 v[88:89], v[80:81], v[70:71] op_sel:[0,0] op_sel_hi:[0,1]
    v_pk_fma_f32 v[88:89], v[80:81], v[70:71], v[88:89] op_sel:[1,1,0] op_sel_hi:[1,0,1] neg_lo:[0,1,0]
    v_pk_mul_f32 v[120:121], v[112:113], v[102:103] op_sel:[0,0] op_sel_hi:[0,1]
    v_pk_fma_f32 v[120:121], v[112:113], v[102:103], v[120:121] op_sel:[1,1,0] op_sel_hi:[1,0,1] neg_lo:[0,1,0]
    v_cvt_pk_bf16_f32 v38, v88, v89
    v_cvt_pk_bf16_f32 v39, v120, v121
    ds_write_b64 v245, v[38:39] offset:14784
    v_pk_mul_f32 v[86:87], v[80:81], v[72:73] op_sel:[0,0] op_sel_hi:[0,1]
    v_pk_fma_f32 v[86:87], v[80:81], v[72:73], v[86:87] op_sel:[1,1,0] op_sel_hi:[1,0,1] neg_lo:[0,1,0]
    v_pk_mul_f32 v[118:119], v[112:113], v[104:105] op_sel:[0,0] op_sel_hi:[0,1]
    v_pk_fma_f32 v[118:119], v[112:113], v[104:105], v[118:119] op_sel:[1,1,0] op_sel_hi:[1,0,1] neg_lo:[0,1,0]
    v_cvt_pk_bf16_f32 v36, v86, v87
    v_cvt_pk_bf16_f32 v37, v118, v119
    ds_write_b64 v245, v[36:37] offset:15312
    v_pk_mul_f32 v[88:89], v[80:81], v[74:75] op_sel:[0,0] op_sel_hi:[0,1]
    v_pk_fma_f32 v[88:89], v[80:81], v[74:75], v[88:89] op_sel:[1,1,0] op_sel_hi:[1,0,1] neg_lo:[0,1,0]
    v_pk_mul_f32 v[120:121], v[112:113], v[106:107] op_sel:[0,0] op_sel_hi:[0,1]
    v_pk_fma_f32 v[120:121], v[112:113], v[106:107], v[120:121] op_sel:[1,1,0] op_sel_hi:[1,0,1] neg_lo:[0,1,0]
    v_cvt_pk_bf16_f32 v38, v88, v89
    v_cvt_pk_bf16_f32 v39, v120, v121
    ds_write_b64 v245, v[38:39] offset:15840
    buffer_store_dwordx4 v[240:243], v238, s[52:55], s67 offen sc1
    v_pk_mul_f32 v[86:87], v[80:81], v[76:77] op_sel:[0,0] op_sel_hi:[0,1]
    v_pk_fma_f32 v[86:87], v[80:81], v[76:77], v[86:87] op_sel:[1,1,0] op_sel_hi:[1,0,1] neg_lo:[0,1,0]
    v_pk_mul_f32 v[118:119], v[112:113], v[108:109] op_sel:[0,0] op_sel_hi:[0,1]
    v_pk_fma_f32 v[118:119], v[112:113], v[108:109], v[118:119] op_sel:[1,1,0] op_sel_hi:[1,0,1] neg_lo:[0,1,0]
    v_cvt_pk_bf16_f32 v36, v86, v87
    v_cvt_pk_bf16_f32 v37, v118, v119
    ds_write_b64 v245, v[36:37] offset:16368
    ds_read_b128 v[144:147], v246 offset:0
    ds_read_b128 v[148:151], v246 offset:16
    ds_read_b128 v[152:155], v246 offset:32
    ds_read_b128 v[156:159], v246 offset:48
    ds_read_b128 v[160:163], v246 offset:64
    ds_read_b128 v[164:167], v246 offset:80
    ds_read_b128 v[168:171], v246 offset:96
    ds_read_b128 v[172:175], v246 offset:112
    ds_read_b128 v[176:179], v246 offset:8448
    ds_read_b128 v[180:183], v246 offset:8464
    ds_read_b128 v[184:187], v246 offset:8480
    ds_read_b128 v[188:191], v246 offset:8496
    ds_read_b128 v[192:195], v246 offset:8512
    ds_read_b128 v[196:199], v246 offset:8528
    ds_read_b128 v[200:203], v246 offset:8544
    ds_read_b128 v[204:207], v246 offset:8560
    v_pk_mul_f32 v[90:91], v[80:81], v[80:81] op_sel:[0,0] op_sel_hi:[0,1]
    v_pk_fma_f32 v[90:91], v[80:81], v[80:81], v[90:91] op_sel:[1,1,0] op_sel_hi:[1,0,1] neg_lo:[0,1,0]
    v_pk_mul_f32 v[122:123], v[112:113], v[112:113] op_sel:[0,0] op_sel_hi:[0,1]
    v_pk_fma_f32 v[122:123], v[112:113], v[112:113], v[122:123] op_sel:[1,1,0] op_sel_hi:[1,0,1] neg_lo:[0,1,0]
    v_cvt_pk_bf16_f32 v38, v90, v91
    v_cvt_pk_bf16_f32 v39, v122, v123
    ds_write_b64 v245, v[38:39] offset:16896
    v_pk_mul_f32 v[88:89], v[90:91], v[66:67] op_sel:[0,0] op_sel_hi:[0,1]
    v_pk_fma_f32 v[88:89], v[90:91], v[66:67], v[88:89] op_sel:[1,1,0] op_sel_hi:[1,0,1] neg_lo:[0,1,0]
    v_pk_mul_f32 v[120:121], v[122:123], v[98:99] op_sel:[0,0] op_sel_hi:[0,1]
    v_pk_fma_f32 v[120:121], v[122:123], v[98:99], v[120:121] op_sel:[1,1,0] op_sel_hi:[1,0,1] neg_lo:[0,1,0]
    v_cvt_pk_bf16_f32 v36, v88, v89
    v_cvt_pk_bf16_f32 v37, v120, v121
    ds_write_b64 v245, v[36:37] offset:17424
    buffer_store_dwordx4 v[240:243], v238, s[52:55], s67 offen offset:1024 sc1
    v_pk_mul_f32 v[86:87], v[90:91], v[70:71] op_sel:[0,0] op_sel_hi:[0,1]
    v_pk_fma_f32 v[86:87], v[90:91], v[70:71], v[86:87] op_sel:[1,1,0] op_sel_hi:[1,0,1] neg_lo:[0,1,0]
    v_pk_mul_f32 v[118:119], v[122:123], v[102:103] op_sel:[0,0] op_sel_hi:[0,1]
    v_pk_fma_f32 v[118:119], v[122:123], v[102:103], v[118:119] op_sel:[1,1,0] op_sel_hi:[1,0,1] neg_lo:[0,1,0]
    v_cvt_pk_bf16_f32 v38, v86, v87
    v_cvt_pk_bf16_f32 v39, v118, v119
    ds_write_b64 v245, v[38:39] offset:17952
    s_waitcnt lgkmcnt(3)
    s_nop 0
    v_pk_mul_f32 v[88:89], v[90:91], v[74:75] op_sel:[0,0] op_sel_hi:[0,1]
    v_pk_fma_f32 v[88:89], v[90:91], v[74:75], v[88:89] op_sel:[1,1,0] op_sel_hi:[1,0,1] neg_lo:[0,1,0]
    v_pk_mul_f32 v[120:121], v[122:123], v[106:107] op_sel:[0,0] op_sel_hi:[0,1]
    v_pk_fma_f32 v[120:121], v[122:123], v[106:107], v[120:121] op_sel:[1,1,0] op_sel_hi:[1,0,1] neg_lo:[0,1,0]
    v_cvt_pk_bf16_f32 v36, v88, v89
    v_cvt_pk_bf16_f32 v37, v120, v121
    ds_write_b64 v245, v[36:37] offset:18480
    v_mfma_f32_16x16x32_bf16 v[128:131], v[144:147], v[176:179], 0
    v_pk_mul_f32 v[92:93], v[90:91], v[80:81] op_sel:[0,0] op_sel_hi:[0,1]
    v_pk_fma_f32 v[92:93], v[90:91], v[80:81], v[92:93] op_sel:[1,1,0] op_sel_hi:[1,0,1] neg_lo:[0,1,0]
    v_pk_mul_f32 v[124:125], v[122:123], v[112:113] op_sel:[0,0] op_sel_hi:[0,1]
    v_pk_fma_f32 v[124:125], v[122:123], v[112:113], v[124:125] op_sel:[1,1,0] op_sel_hi:[1,0,1] neg_lo:[0,1,0]
    v_cvt_pk_bf16_f32 v38, v92, v93
    v_cvt_pk_bf16_f32 v39, v124, v125
    ds_write_b64 v245, v[38:39] offset:19008
    v_mfma_f32_16x16x32_bf16 v[128:131], v[148:151], v[180:183], v[128:131]
    v_pk_mul_f32 v[86:87], v[92:93], v[66:67] op_sel:[0,0] op_sel_hi:[0,1]
    v_pk_fma_f32 v[86:87], v[92:93], v[66:67], v[86:87] op_sel:[1,1,0] op_sel_hi:[1,0,1] neg_lo:[0,1,0]
    v_pk_mul_f32 v[118:119], v[124:125], v[98:99] op_sel:[0,0] op_sel_hi:[0,1]
    v_pk_fma_f32 v[118:119], v[124:125], v[98:99], v[118:119] op_sel:[1,1,0] op_sel_hi:[1,0,1] neg_lo:[0,1,0]
    v_cvt_pk_bf16_f32 v36, v86, v87
    v_cvt_pk_bf16_f32 v37, v118, v119
    ds_write_b64 v245, v[36:37] offset:19536
    v_mfma_f32_16x16x32_bf16 v[128:131], v[152:155], v[184:187], v[128:131]
    v_pk_mul_f32 v[88:89], v[92:93], v[70:71] op_sel:[0,0] op_sel_hi:[0,1]
    v_pk_fma_f32 v[88:89], v[92:93], v[70:71], v[88:89] op_sel:[1,1,0] op_sel_hi:[1,0,1] neg_lo:[0,1,0]
    v_pk_mul_f32 v[120:121], v[124:125], v[102:103] op_sel:[0,0] op_sel_hi:[0,1]
    v_pk_fma_f32 v[120:121], v[124:125], v[102:103], v[120:121] op_sel:[1,1,0] op_sel_hi:[1,0,1] neg_lo:[0,1,0]
    v_cvt_pk_bf16_f32 v38, v88, v89
    v_cvt_pk_bf16_f32 v39, v120, v121
    ds_write_b64 v245, v[38:39] offset:20064
    v_mfma_f32_16x16x32_bf16 v[128:131], v[156:159], v[188:191], v[128:131]
    v_pk_mul_f32 v[86:87], v[92:93], v[74:75] op_sel:[0,0] op_sel_hi:[0,1]
    v_pk_fma_f32 v[86:87], v[92:93], v[74:75], v[86:87] op_sel:[1,1,0] op_sel_hi:[1,0,1] neg_lo:[0,1,0]
    v_pk_mul_f32 v[118:119], v[124:125], v[106:107] op_sel:[0,0] op_sel_hi:[0,1]
    v_pk_fma_f32 v[118:119], v[124:125], v[106:107], v[118:119] op_sel:[1,1,0] op_sel_hi:[1,0,1] neg_lo:[0,1,0]
    v_cvt_pk_bf16_f32 v36, v86, v87
    v_cvt_pk_bf16_f32 v37, v118, v119
    ds_write_b64 v245, v[36:37] offset:20592
    v_mfma_f32_16x16x32_bf16 v[128:131], v[160:163], v[192:195], v[128:131]
    v_pk_mul_f32 v[90:91], v[92:93], v[80:81] op_sel:[0,0] op_sel_hi:[0,1]
    v_pk_fma_f32 v[90:91], v[92:93], v[80:81], v[90:91] op_sel:[1,1,0] op_sel_hi:[1,0,1] neg_lo:[0,1,0]
    v_pk_mul_f32 v[122:123], v[124:125], v[112:113] op_sel:[0,0] op_sel_hi:[0,1]
    v_pk_fma_f32 v[122:123], v[124:125], v[112:113], v[122:123] op_sel:[1,1,0] op_sel_hi:[1,0,1] neg_lo:[0,1,0]
    v_cvt_pk_bf16_f32 v38, v90, v91
    v_cvt_pk_bf16_f32 v39, v122, v123
    ds_write_b64 v245, v[38:39] offset:21120
    v_mfma_f32_16x16x32_bf16 v[128:131], v[164:167], v[196:199], v[128:131]
    v_pk_mul_f32 v[88:89], v[90:91], v[70:71] op_sel:[0,0] op_sel_hi:[0,1]
    v_pk_fma_f32 v[88:89], v[90:91], v[70:71], v[88:89] op_sel:[1,1,0] op_sel_hi:[1,0,1] neg_lo:[0,1,0]
    v_pk_mul_f32 v[120:121], v[122:123], v[102:103] op_sel:[0,0] op_sel_hi:[0,1]
    v_pk_fma_f32 v[120:121], v[122:123], v[102:103], v[120:121] op_sel:[1,1,0] op_sel_hi:[1,0,1] neg_lo:[0,1,0]
    v_cvt_pk_bf16_f32 v36, v88, v89
    v_cvt_pk_bf16_f32 v37, v120, v121
    ds_write_b64 v245, v[36:37] offset:21648
    v_mfma_f32_16x16x32_bf16 v[128:131], v[168:171], v[200:203], v[128:131]
    v_pk_mul_f32 v[92:93], v[90:91], v[80:81] op_sel:[0,0] op_sel_hi:[0,1]
    v_pk_fma_f32 v[92:93], v[90:91], v[80:81], v[92:93] op_sel:[1,1,0] op_sel_hi:[1,0,1] neg_lo:[0,1,0]
    v_pk_mul_f32 v[124:125], v[122:123], v[112:113] op_sel:[0,0] op_sel_hi:[0,1]
    v_pk_fma_f32 v[124:125], v[122:123], v[112:113], v[124:125] op_sel:[1,1,0] op_sel_hi:[1,0,1] neg_lo:[0,1,0]
    v_cvt_pk_bf16_f32 v38, v92, v93
    v_cvt_pk_bf16_f32 v39, v124, v125
    ds_write_b64 v245, v[38:39] offset:22176
    v_mfma_f32_16x16x32_bf16 v[128:131], v[172:175], v[204:207], v[128:131]
    v_pk_mul_f32 v[86:87], v[92:93], v[70:71] op_sel:[0,0] op_sel_hi:[0,1]
    v_pk_fma_f32 v[86:87], v[92:93], v[70:71], v[86:87] op_sel:[1,1,0] op_sel_hi:[1,0,1] neg_lo:[0,1,0]
    v_pk_mul_f32 v[118:119], v[124:125], v[102:103] op_sel:[0,0] op_sel_hi:[0,1]
    v_pk_fma_f32 v[118:119], v[124:125], v[102:103], v[118:119] op_sel:[1,1,0] op_sel_hi:[1,0,1] neg_lo:[0,1,0]
    v_cvt_pk_bf16_f32 v36, v86, v87
    v_cvt_pk_bf16_f32 v37, v118, v119
    ds_write_b64 v245, v[36:37] offset:22704
    v_pk_mul_f32 v[90:91], v[92:93], v[80:81] op_sel:[0,0] op_sel_hi:[0,1]
    v_pk_fma_f32 v[90:91], v[92:93], v[80:81], v[90:91] op_sel:[1,1,0] op_sel_hi:[1,0,1] neg_lo:[0,1,0]
    v_pk_mul_f32 v[122:123], v[124:125], v[112:113] op_sel:[0,0] op_sel_hi:[0,1]
    v_pk_fma_f32 v[122:123], v[124:125], v[112:113], v[122:123] op_sel:[1,1,0] op_sel_hi:[1,0,1] neg_lo:[0,1,0]
    v_cvt_pk_bf16_f32 v38, v90, v91
    v_cvt_pk_bf16_f32 v39, v122, v123
    ds_write_b64 v245, v[38:39] offset:23232
    v_pk_mul_f32 v[88:89], v[90:91], v[70:71] op_sel:[0,0] op_sel_hi:[0,1]
    v_pk_fma_f32 v[88:89], v[90:91], v[70:71], v[88:89] op_sel:[1,1,0] op_sel_hi:[1,0,1] neg_lo:[0,1,0]
    v_pk_mul_f32 v[120:121], v[122:123], v[102:103] op_sel:[0,0] op_sel_hi:[0,1]
    v_pk_fma_f32 v[120:121], v[122:123], v[102:103], v[120:121] op_sel:[1,1,0] op_sel_hi:[1,0,1] neg_lo:[0,1,0]
    v_cvt_pk_bf16_f32 v36, v88, v89
    v_cvt_pk_bf16_f32 v37, v120, v121
    ds_write_b64 v245, v[36:37] offset:23760
    v_pk_mul_f32 v[92:93], v[90:91], v[80:81] op_sel:[0,0] op_sel_hi:[0,1]
    v_pk_fma_f32 v[92:93], v[90:91], v[80:81], v[92:93] op_sel:[1,1,0] op_sel_hi:[1,0,1] neg_lo:[0,1,0]
    v_pk_mul_f32 v[124:125], v[122:123], v[112:113] op_sel:[0,0] op_sel_hi:[0,1]
    v_pk_fma_f32 v[124:125], v[122:123], v[112:113], v[124:125] op_sel:[1,1,0] op_sel_hi:[1,0,1] neg_lo:[0,1,0]
    v_cvt_pk_bf16_f32 v38, v92, v93
    v_cvt_pk_bf16_f32 v39, v124, v125
    ds_write_b64 v245, v[38:39] offset:24288
    v_pk_mul_f32 v[86:87], v[92:93], v[70:71] op_sel:[0,0] op_sel_hi:[0,1]
    v_pk_fma_f32 v[86:87], v[92:93], v[70:71], v[86:87] op_sel:[1,1,0] op_sel_hi:[1,0,1] neg_lo:[0,1,0]
    v_pk_mul_f32 v[118:119], v[124:125], v[102:103] op_sel:[0,0] op_sel_hi:[0,1]
    v_pk_fma_f32 v[118:119], v[124:125], v[102:103], v[118:119] op_sel:[1,1,0] op_sel_hi:[1,0,1] neg_lo:[0,1,0]
    v_cvt_pk_bf16_f32 v36, v86, v87
    v_cvt_pk_bf16_f32 v37, v118, v119
    ds_write_b64 v245, v[36:37] offset:24816
    ds_read_b128 v[176:179], v246 offset:16896
    ds_read_b128 v[180:183], v246 offset:16912
    ds_read_b128 v[184:187], v246 offset:16928
    ds_read_b128 v[188:191], v246 offset:16944
    ds_read_b128 v[192:195], v246 offset:16960
    ds_read_b128 v[196:199], v246 offset:16976
    ds_read_b128 v[200:203], v246 offset:16992
    ds_read_b128 v[204:207], v246 offset:17008
    v_pk_mul_f32 v[90:91], v[92:93], v[80:81] op_sel:[0,0] op_sel_hi:[0,1]
    v_pk_fma_f32 v[90:91], v[92:93], v[80:81], v[90:91] op_sel:[1,1,0] op_sel_hi:[1,0,1] neg_lo:[0,1,0]
    v_pk_mul_f32 v[122:123], v[124:125], v[112:113] op_sel:[0,0] op_sel_hi:[0,1]
    v_pk_fma_f32 v[122:123], v[124:125], v[112:113], v[122:123] op_sel:[1,1,0] op_sel_hi:[1,0,1] neg_lo:[0,1,0]
    v_cvt_pk_bf16_f32 v38, v90, v91
    v_cvt_pk_bf16_f32 v39, v122, v123
    ds_write_b64 v245, v[38:39] offset:25344
    v_pk_mul_f32 v[92:93], v[90:91], v[80:81] op_sel:[0,0] op_sel_hi:[0,1]
    v_pk_fma_f32 v[92:93], v[90:91], v[80:81], v[92:93] op_sel:[1,1,0] op_sel_hi:[1,0,1] neg_lo:[0,1,0]
    v_pk_mul_f32 v[124:125], v[122:123], v[112:113] op_sel:[0,0] op_sel_hi:[0,1]
    v_pk_fma_f32 v[124:125], v[122:123], v[112:113], v[124:125] op_sel:[1,1,0] op_sel_hi:[1,0,1] neg_lo:[0,1,0]
    v_cvt_pk_bf16_f32 v36, v92, v93
    v_cvt_pk_bf16_f32 v37, v124, v125
    ds_write_b64 v245, v[36:37] offset:25872
    s_waitcnt lgkmcnt(2)
    s_nop 0
    v_pk_mul_f32 v[90:91], v[92:93], v[80:81] op_sel:[0,0] op_sel_hi:[0,1]
    v_pk_fma_f32 v[90:91], v[92:93], v[80:81], v[90:91] op_sel:[1,1,0] op_sel_hi:[1,0,1] neg_lo:[0,1,0]
    v_pk_mul_f32 v[122:123], v[124:125], v[112:113] op_sel:[0,0] op_sel_hi:[0,1]
    v_pk_fma_f32 v[122:123], v[124:125], v[112:113], v[122:123] op_sel:[1,1,0] op_sel_hi:[1,0,1] neg_lo:[0,1,0]
    v_cvt_pk_bf16_f32 v38, v90, v91
    v_cvt_pk_bf16_f32 v39, v122, v123
    ds_write_b64 v245, v[38:39] offset:26400
    v_mfma_f32_16x16x32_bf16 v[132:135], v[144:147], v[176:179], 0
    v_pk_mul_f32 v[92:93], v[90:91], v[80:81] op_sel:[0,0] op_sel_hi:[0,1]
    v_pk_fma_f32 v[92:93], v[90:91], v[80:81], v[92:93] op_sel:[1,1,0] op_sel_hi:[1,0,1] neg_lo:[0,1,0]
    v_pk_mul_f32 v[124:125], v[122:123], v[112:113] op_sel:[0,0] op_sel_hi:[0,1]
    v_pk_fma_f32 v[124:125], v[122:123], v[112:113], v[124:125] op_sel:[1,1,0] op_sel_hi:[1,0,1] neg_lo:[0,1,0]
    v_cvt_pk_bf16_f32 v36, v92, v93
    v_cvt_pk_bf16_f32 v37, v124, v125
    ds_write_b64 v245, v[36:37] offset:26928
    v_mfma_f32_16x16x32_bf16 v[132:135], v[148:151], v[180:183], v[132:135]
    v_pk_mul_f32 v[90:91], v[92:93], v[80:81] op_sel:[0,0] op_sel_hi:[0,1]
    v_pk_fma_f32 v[90:91], v[92:93], v[80:81], v[90:91] op_sel:[1,1,0] op_sel_hi:[1,0,1] neg_lo:[0,1,0]
    v_pk_mul_f32 v[122:123], v[124:125], v[112:113] op_sel:[0,0] op_sel_hi:[0,1]
    v_pk_fma_f32 v[122:123], v[124:125], v[112:113], v[122:123] op_sel:[1,1,0] op_sel_hi:[1,0,1] neg_lo:[0,1,0]
    v_cvt_pk_bf16_f32 v38, v90, v91
    v_cvt_pk_bf16_f32 v39, v122, v123
    ds_write_b64 v245, v[38:39] offset:27456
    v_mfma_f32_16x16x32_bf16 v[132:135], v[152:155], v[184:187], v[132:135]
    v_pk_mul_f32 v[92:93], v[90:91], v[80:81] op_sel:[0,0] op_sel_hi:[0,1]
    v_pk_fma_f32 v[92:93], v[90:91], v[80:81], v[92:93] op_sel:[1,1,0] op_sel_hi:[1,0,1] neg_lo:[0,1,0]
    v_pk_mul_f32 v[124:125], v[122:123], v[112:113] op_sel:[0,0] op_sel_hi:[0,1]
    v_pk_fma_f32 v[124:125], v[122:123], v[112:113], v[124:125] op_sel:[1,1,0] op_sel_hi:[1,0,1] neg_lo:[0,1,0]
    v_cvt_pk_bf16_f32 v36, v92, v93
    v_cvt_pk_bf16_f32 v37, v124, v125
    ds_write_b64 v245, v[36:37] offset:27984
    v_mfma_f32_16x16x32_bf16 v[132:135], v[156:159], v[188:191], v[132:135]
    v_pk_mul_f32 v[90:91], v[92:93], v[80:81] op_sel:[0,0] op_sel_hi:[0,1]
    v_pk_fma_f32 v[90:91], v[92:93], v[80:81], v[90:91] op_sel:[1,1,0] op_sel_hi:[1,0,1] neg_lo:[0,1,0]
    v_pk_mul_f32 v[122:123], v[124:125], v[112:113] op_sel:[0,0] op_sel_hi:[0,1]
    v_pk_fma_f32 v[122:123], v[124:125], v[112:113], v[122:123] op_sel:[1,1,0] op_sel_hi:[1,0,1] neg_lo:[0,1,0]
    v_cvt_pk_bf16_f32 v38, v90, v91
    v_cvt_pk_bf16_f32 v39, v122, v123
    ds_write_b64 v245, v[38:39] offset:28512
    v_mfma_f32_16x16x32_bf16 v[132:135], v[160:163], v[192:195], v[132:135]
    v_pk_mul_f32 v[92:93], v[90:91], v[80:81] op_sel:[0,0] op_sel_hi:[0,1]
    v_pk_fma_f32 v[92:93], v[90:91], v[80:81], v[92:93] op_sel:[1,1,0] op_sel_hi:[1,0,1] neg_lo:[0,1,0]
    v_pk_mul_f32 v[124:125], v[122:123], v[112:113] op_sel:[0,0] op_sel_hi:[0,1]
    v_pk_fma_f32 v[124:125], v[122:123], v[112:113], v[124:125] op_sel:[1,1,0] op_sel_hi:[1,0,1] neg_lo:[0,1,0]
    v_cvt_pk_bf16_f32 v36, v92, v93
    v_cvt_pk_bf16_f32 v37, v124, v125
    ds_write_b64 v245, v[36:37] offset:29040
    v_mfma_f32_16x16x32_bf16 v[132:135], v[164:167], v[196:199], v[132:135]
    v_pk_mul_f32 v[90:91], v[92:93], v[80:81] op_sel:[0,0] op_sel_hi:[0,1]
    v_pk_fma_f32 v[90:91], v[92:93], v[80:81], v[90:91] op_sel:[1,1,0] op_sel_hi:[1,0,1] neg_lo:[0,1,0]
    v_pk_mul_f32 v[122:123], v[124:125], v[112:113] op_sel:[0,0] op_sel_hi:[0,1]
    v_pk_fma_f32 v[122:123], v[124:125], v[112:113], v[122:123] op_sel:[1,1,0] op_sel_hi:[1,0,1] neg_lo:[0,1,0]
    v_cvt_pk_bf16_f32 v38, v90, v91
    v_cvt_pk_bf16_f32 v39, v122, v123
    ds_write_b64 v245, v[38:39] offset:29568
    v_mfma_f32_16x16x32_bf16 v[132:135], v[168:171], v[200:203], v[132:135]
    v_mfma_f32_16x16x32_bf16 v[132:135], v[172:175], v[204:207], v[132:135]
    ds_read_b128 v[176:179], v246 offset:25344
    ds_read_b128 v[180:183], v246 offset:25360
    ds_read_b128 v[184:187], v246 offset:25376
    ds_read_b128 v[188:191], v246 offset:25392
    ds_read_b128 v[192:195], v246 offset:25408
    ds_read_b128 v[196:199], v246 offset:25424
    ds_read_b128 v[200:203], v246 offset:25440
    ds_read_b128 v[204:207], v246 offset:25456
    v_lshlrev_b32 v251, 7, v0
    s_mov_b32 s9, 0
    buffer_load_dword v250, v251, s[52:55], s9 offen sc1
    s_waitcnt lgkmcnt(0)
    s_nop 0
    v_mfma_f32_16x16x32_bf16 v[136:139], v[144:147], v[176:179], 0
    v_mfma_f32_16x16x32_bf16 v[136:139], v[148:151], v[180:183], v[136:139]
    v_mfma_f32_16x16x32_bf16 v[136:139], v[152:155], v[184:187], v[136:139]
    v_mfma_f32_16x16x32_bf16 v[136:139], v[156:159], v[188:191], v[136:139]
    v_mfma_f32_16x16x32_bf16 v[136:139], v[160:163], v[192:195], v[136:139]
    v_mfma_f32_16x16x32_bf16 v[136:139], v[164:167], v[196:199], v[136:139]
    v_mfma_f32_16x16x32_bf16 v[136:139], v[168:171], v[200:203], v[136:139]
    v_mfma_f32_16x16x32_bf16 v[136:139], v[172:175], v[204:207], v[136:139]
    s_lshr_b32 s9, s3, 1
    s_lshl_b32 s10, s9, 12
    s_add_u32 s10, s10, 20480
    v_lshlrev_b32 v28, 4, v1
    v_add_u32 v28, s10, v28
    s_and_b32 s12, s3, 1
    s_cmp_eq_u32 s12, 0
    s_cbranch_scc1 L_k_even1
    s_nop 0
    ds_write_b128 v28, v[128:131] offset:0
    ds_write_b128 v28, v[132:135] offset:1024
    ds_write_b128 v28, v[136:139] offset:2048
L_k_even1:
    s_mul_i32 s9, s9, 3584
    s_add_u32 s9, s9, 0
    v_and_b32 v29, 15, v1
    v_mul_u32_u24 v29, 72, v29
    v_lshrrev_b32 v30, 4, v1
    v_lshl_add_u32 v29, v30, 4, v29
    v_add_u32 v29, s9, v29
    v_mov_b32 v30, s47
    v_cmp_eq_u32 vcc, 0, v1
    s_nop 1
    v_cndmask_b32 v30, 0, v30, vcc
    s_waitcnt lgkmcnt(0)
    s_barrier
    s_cmp_lg_u32 s12, 0
    s_cbranch_scc1 L_k_odd2
    ds_read_b128 v[96:99], v28 offset:0
    ds_read_b128 v[100:103], v28 offset:1024
    ds_read_b128 v[104:107], v28 offset:2048
    v_add_f32 v128, v128, v30
    s_waitcnt lgkmcnt(0)
    v_pk_add_f32 v[128:129], v[128:129], v[96:97]
    v_pk_add_f32 v[130:131], v[130:131], v[98:99]
    v_pk_add_f32 v[132:133], v[132:133], v[100:101]
    v_pk_add_f32 v[134:135], v[134:135], v[102:103]
    v_pk_add_f32 v[136:137], v[136:137], v[104:105]
    v_pk_add_f32 v[138:139], v[138:139], v[106:107]
    ds_write_b64 v29, v[128:129] offset:0
    ds_write_b64 v29, v[130:131] offset:8
    ds_write_b64 v29, v[132:133] offset:1152
    ds_write_b64 v29, v[134:135] offset:1160
    ds_write_b64 v29, v[136:137] offset:2304
    ds_write_b64 v29, v[138:139] offset:2312
L_k_odd2:
    s_waitcnt lgkmcnt(0)
    s_barrier
    s_branch L_b1
L_noconv_a:
    s_waitcnt vmcnt(0)
    s_barrier
    s_cmp_lg_u32 s3, 0
    s_cbranch_scc1 L_arr0b
    v_mov_b32 v250, s8
    v_mov_b32 v251, 0
    s_lshl_b32 s9, s2, 7
    s_add_u32 s9, s9, 0
    s_mov_b64 s[10:11], exec
    s_mov_b64 exec, 1
    buffer_store_dword v250, v251, s[52:55], s9 offen sc1
    s_mov_b64 exec, s[10:11]
L_arr0b:
    v_lshlrev_b32_e64 v232, 7, v0
    v_add_u32 v232, 0x8000, v232
    v_min_u32 v232, L_table-L_pc, v232
    global_load_dword v249, v232, s[14:15]
    buffer_store_dwordx4 v[240:243], v238, s[52:55], s66 offen sc1
    buffer_store_dwordx4 v[240:243], v238, s[52:55], s66 offen offset:1024 sc1
    buffer_store_dwordx4 v[240:243], v236, s[52:55], s68 offen sc1
    buffer_store_dwordx4 v[240:243], v237, s[52:55], s68 offen sc1
    buffer_store_dwordx4 v[240:243], v238, s[52:55], s67 offen sc1
    buffer_store_dwordx4 v[240:243], v238, s[52:55], s67 offen offset:1024 sc1
    s_waitcnt vmcnt(0)
    s_barrier
    s_cmp_lg_u32 s3, 0
    s_cbranch_scc1 L_arr1b
    v_mov_b32 v250, s8
    v_mov_b32 v251, 0
    s_lshl_b32 s9, s2, 7
    s_add_u32 s9, s9, 32768
    s_mov_b64 s[10:11], exec
    s_mov_b64 exec, 1
    buffer_store_dword v250, v251, s[52:55], s9 offen sc1
    s_mov_b64 exec, s[10:11]
L_arr1b:
    s_mov_b32 s72, s32
    s_mov_b32 s73, s33
    s_mov_b32 s74, 7340032
    s_mov_b32 s75, 0x20000
    v_lshlrev_b32 v234, 4, v1
    v_mov_b32 v233, 0x40000000
    v_cmp_gt_u32 vcc, 56, v1
    s_nop 1
    v_cndmask_b32 v234, v233, v234, vcc
    s_sub_u32 s9, s5, 28
    s_lshr_b32 s10, s4, 2
    s_lshl_b32 s10, s10, 2
    s_add_u32 s9, s9, s10
    s_lshl_b32 s9, s9, 2
    s_add_u32 s9, s9, s3
    s_and_b32 s62, s9, 7
    s_lshr_b32 s9, s9, 3
    s_mul_i32 s9, s9, 1835008
    s_and_b32 s10, s4, 3
    s_mul_i32 s10, s10, 896
    s_add_u32 s63, s9, s10
    s_mul_i32 s61, s62, 78848
    s_add_u32 s61, s61, s63
    buffer_load_dwordx4 v[244:247], v234, s[72:75], s61 offen
    s_add_u32 s61, s61, 3584
    buffer_load_dwordx4 v[244:247], v234, s[72:75], s61 offen
    s_add_u32 s61, s61, 3584
    buffer_load_dwordx4 v[244:247], v234, s[72:75], s61 offen
    s_add_u32 s61, s61, 3584
    buffer_load_dwordx4 v[244:247], v234, s[72:75], s61 offen
    s_add_u32 s61, s61, 3584
    buffer_load_dwordx4 v[244:247], v234, s[72:75], s61 offen
    s_add_u32 s61, s61, 3584
    buffer_load_dwordx4 v[244:247], v234, s[72:75], s61 offen
    s_add_u32 s61, s61, 3584
    buffer_load_dwordx4 v[244:247], v234, s[72:75], s61 offen
    s_add_u32 s61, s61, 3584
    buffer_load_dwordx4 v[244:247], v234, s[72:75], s61 offen
    s_add_u32 s61, s61, 3584
    buffer_load_dwordx4 v[244:247], v234, s[72:75], s61 offen
    s_add_u32 s61, s61, 3584
    buffer_load_dwordx4 v[244:247], v234, s[72:75], s61 offen
    s_add_u32 s61, s61, 3584
    buffer_load_dwordx4 v[244:247], v234, s[72:75], s61 offen
    s_add_u32 s61, s61, 3584
    buffer_load_dwordx4 v[244:247], v234, s[72:75], s61 offen
    s_add_u32 s61, s61, 3584
    buffer_load_dwordx4 v[244:247], v234, s[72:75], s61 offen
    s_add_u32 s61, s61, 3584
    buffer_load_dwordx4 v[244:247], v234, s[72:75], s61 offen
    s_add_u32 s61, s61, 3584
    buffer_load_dwordx4 v[244:247], v234, s[72:75], s61 offen
    s_add_u32 s61, s61, 3584
    buffer_load_dwordx4 v[244:247], v234, s[72:75], s61 offen
    s_add_u32 s61, s61, 3584
    buffer_load_dwordx4 v[244:247], v234, s[72:75], s61 offen
    s_add_u32 s61, s61, 3584
    buffer_load_dwordx4 v[244:247], v234, s[72:75], s61 offen
    s_add_u32 s61, s61, 3584
    buffer_load_dwordx4 v[244:247], v234, s[72:75], s61 offen
    s_add_u32 s61, s61, 3584
    buffer_load_dwordx4 v[244:247], v234, s[72:75], s61 offen
    s_add_u32 s61, s61, 3584
    buffer_load_dwordx4 v[244:247], v234, s[72:75], s61 offen
    s_add_u32 s61, s61, 3584
    buffer_load_dwordx4 v[244:247], v234, s[72:75], s61 offen
    s_mul_i32 s61, s62, 78848
    s_add_u32 s61, s61, s63
    s_nop 0
    s_add_u32 s61, s61, 630784
    buffer_load_dwordx4 v[244:247], v234, s[72:75], s61 offen
    s_add_u32 s61, s61, 3584
    buffer_load_dwordx4 v[244:247], v234, s[72:75], s61 offen
    s_add_u32 s61, s61, 3584
    buffer_load_dwordx4 v[244:247], v234, s[72:75], s61 offen
    s_add_u32 s61, s61, 3584
    buffer_load_dwordx4 v[244:247], v234, s[72:75], s61 offen
    s_add_u32 s61, s61, 3584
    buffer_load_dwordx4 v[244:247], v234, s[72:75], s61 offen
    s_add_u32 s61, s61, 3584
    buffer_load_dwordx4 v[244:247], v234, s[72:75], s61 offen
    s_add_u32 s61, s61, 3584
    buffer_load_dwordx4 v[244:247], v234, s[72:75], s61 offen
    s_add_u32 s61, s61, 3584
    buffer_load_dwordx4 v[244:247], v234, s[72:75], s61 offen
    s_add_u32 s61, s61, 3584
    buffer_load_dwordx4 v[244:247], v234, s[72:75], s61 offen
    s_add_u32 s61, s61, 3584
    buffer_load_dwordx4 v[244:247], v234, s[72:75], s61 offen
    s_add_u32 s61, s61, 3584
    buffer_load_dwordx4 v[244:247], v234, s[72:75], s61 offen
    s_add_u32 s61, s61, 3584
    buffer_load_dwordx4 v[244:247], v234, s[72:75], s61 offen
    s_add_u32 s61, s61, 3584
    buffer_load_dwordx4 v[244:247], v234, s[72:75], s61 offen
    s_add_u32 s61, s61, 3584
    buffer_load_dwordx4 v[244:247], v234, s[72:75], s61 offen
    s_add_u32 s61, s61, 3584
    buffer_load_dwordx4 v[244:247], v234, s[72:75], s61 offen
    s_add_u32 s61, s61, 3584
    buffer_load_dwordx4 v[244:247], v234, s[72:75], s61 offen
    s_add_u32 s61, s61, 3584
    buffer_load_dwordx4 v[244:247], v234, s[72:75], s61 offen
    s_add_u32 s61, s61, 3584
    buffer_load_dwordx4 v[244:247], v234, s[72:75], s61 offen
    s_add_u32 s61, s61, 3584
    buffer_load_dwordx4 v[244:247], v234, s[72:75], s61 offen
    s_add_u32 s61, s61, 3584
    s_waitcnt vmcnt(20)
    s_nop 0
    buffer_load_dwordx4 v[244:247], v234, s[72:75], s61 offen
    s_add_u32 s61, s61, 3584
    buffer_load_dwordx4 v[244:247], v234, s[72:75], s61 offen
    s_add_u32 s61, s61, 3584
    buffer_load_dwordx4 v[244:247], v234, s[72:75], s61 offen
    s_mul_i32 s61, s62, 71680
    s_add_u32 s61, s61, s63
    s_nop 0
    s_add_u32 s61, s61, 1261568
    buffer_load_dwordx4 v[244:247], v234, s[72:75], s61 offen
    s_add_u32 s61, s61, 3584
    buffer_load_dwordx4 v[244:247], v234, s[72:75], s61 offen
    s_add_u32 s61, s61, 3584
    buffer_load_dwordx4 v[244:247], v234, s[72:75], s61 offen
    s_add_u32 s61, s61, 3584
    buffer_load_dwordx4 v[244:247], v234, s[72:75], s61 offen
    s_add_u32 s61, s61, 3584
    buffer_load_dwordx4 v[244:247], v234, s[72:75], s61 offen
    s_add_u32 s61, s61, 3584
    buffer_load_dwordx4 v[244:247], v234, s[72:75], s61 offen
    s_add_u32 s61, s61, 3584
    buffer_load_dwordx4 v[244:247], v234, s[72:75], s61 offen
    s_add_u32 s61, s61, 3584
    buffer_load_dwordx4 v[244:247], v234, s[72:75], s61 offen
    s_add_u32 s61, s61, 3584
    buffer_load_dwordx4 v[244:247], v234, s[72:75], s61 offen
    s_add_u32 s61, s61, 3584
    buffer_load_dwordx4 v[244:247], v234, s[72:75], s61 offen
    s_add_u32 s61, s61, 3584
    buffer_load_dwordx4 v[244:247], v234, s[72:75], s61 offen
    s_add_u32 s61, s61, 3584
    buffer_load_dwordx4 v[244:247], v234, s[72:75], s61 offen
    s_add_u32 s61, s61, 3584
    buffer_load_dwordx4 v[244:247], v234, s[72:75], s61 offen
    s_add_u32 s61, s61, 3584
    buffer_load_dwordx4 v[244:247], v234, s[72:75], s61 offen
    s_add_u32 s61, s61, 3584
    buffer_load_dwordx4 v[244:247], v234, s[72:75], s61 offen
    s_add_u32 s61, s61, 3584
    buffer_load_dwordx4 v[244:247], v234, s[72:75], s61 offen
    s_add_u32 s61, s61, 3584
    buffer_load_dwordx4 v[244:247], v234, s[72:75], s61 offen
    s_add_u32 s61, s61, 3584
    buffer_load_dwordx4 v[244:247], v234, s[72:75], s61 offen
    s_add_u32 s61, s61, 3584
    buffer_load_dwordx4 v[244:247], v234, s[72:75], s61 offen
    s_add_u32 s61, s61, 3584
    buffer_load_dwordx4 v[244:247], v234, s[72:75], s61 offen
    s_mov_b32 s72, s32
    s_mov_b32 s73, s33
    s_mov_b32 s74, 7340032
    s_mov_b32 s75, 0x20000
    v_lshrrev_b32_e64 v2, 3, v1
    v_mul_u32_u24 v2, 3584, v2
    v_bfe_u32 v3, v1, 4, 1
    v_lshlrev_b32 v3, 2, v3
    v_and_b32 v16, 7, v1
    v_xor_b32_e64 v16, v16, v3
    v_lshl_add_u32 v16, v16, 4, v2
    v_bfe_u32 v2, v1, 2, 2
    v_lshrrev_b32 v3, 5, v1
    v_lshl_add_u32 v3, v3, 3, v2
    v_lshlrev_b32 v3, 7, v3
    v_lshrrev_b32_e64 v2, 1, v2
    v_lshl_add_u32 v3, v2, 6, v3
    v_bfe_u32 v2, v1, 4, 1
    v_lshl_add_u32 v3, v2, 5, v3
    v_and_b32_e64 v2, 3, v1
    v_lshl_add_u32 v3, v2, 3, v3
    s_mul_i32 s9, s3, 22528
    s_add_u32 s9, s9, 73728
    v_add_u32 v14, s9, v3
    v_xor_b32 v15, 64, v14
    v_mov_b32 v2, 0x40000000
    s_cmp_eq_u32 s18, 0
    s_cselect_b64 vcc, -1, 0
    v_cndmask_b32 v16, v16, v2, vcc
    s_mov_b32 s24, 0
    s_mov_b32 s25, 0
    s_mul_i32 s9, s3, 22528
    s_add_u32 m0, s9, 73728
    s_mov_b32 s71, 0
    s_mov_b32 s64, 0
    s_mov_b32 s65, 0
    s_mov_b32 s9, 32768
    s_mov_b32 s12, 0
    v_lshlrev_b32 v251, 7, v0
L_poll1b:
    buffer_load_dword v250, v251, s[52:55], s9 offen sc1
    s_add_u32 s12, s12, 1
    s_cmp_gt_u32 s12, 131072
    s_cbranch_scc1 L_poll1b_out
    s_waitcnt vmcnt(0)
    v_cmp_ne_u32 vcc, s8, v250
    s_cbranch_vccnz L_poll1b
L_poll1b_out:
    s_waitcnt vmcnt(0)
L_poll1b_ok:
    s_barrier
    s_branch L_ln2
L_b1:
    s_waitcnt lgkmcnt(0)
    s_mov_b32 s9, 0
    s_mov_b32 s12, 0
    s_waitcnt vmcnt(0)
    v_cmp_ne_u32 vcc, s8, v250
    s_cbranch_vccz L_poll0_ok
L_poll0:
    buffer_load_dword v250, v251, s[52:55], s9 offen sc1
    s_add_u32 s12, s12, 1
    s_cmp_gt_u32 s12, 131072
    s_cbranch_scc1 L_poll0_out
    s_waitcnt vmcnt(0)
    v_cmp_ne_u32 vcc, s8, v250
    s_cbranch_vccnz L_poll0
L_poll0_out:
    s_waitcnt vmcnt(0)
L_poll0_ok:
    s_barrier
    s_cmp_lg_u32 s3, 0
    s_cbranch_scc1 L_arr1
    v_mov_b32 v250, s8
    v_mov_b32 v251, 0
    s_lshl_b32 s9, s2, 7
    s_add_u32 s9, s9, 32768
    s_mov_b64 s[10:11], exec
    s_mov_b64 exec, 1
    buffer_store_dword v250, v251, s[52:55], s9 offen sc1
    s_mov_b64 exec, s[10:11]
L_arr1:
    s_cmp_lg_u32 s2, 0
    s_cbranch_scc1 L_nononce
    s_cmp_lg_u32 s3, 0
    s_cbranch_scc1 L_nononce
    v_mov_b32 v250, s8
    v_mov_b32 v251, 0
    s_mov_b32 s9, 131072
    s_mov_b64 s[10:11], exec
    s_mov_b64 exec, 1
    buffer_store_dword v250, v251, s[52:55], s9 offen sc1
    s_mov_b64 exec, s[10:11]
L_nononce:
    v_lshrrev_b32 v20, 1, v0
    v_mul_u32_u24 v21, 7168, v20
    v_and_b32 v22, 1, v0
    v_lshl_add_u32 v21, v22, 4, v21
    s_lshl_b32 s9, s7, 5
    s_add_u32 s9, s9, 1048576
    s_add_u32 s10, s9, 917504
    buffer_load_dwordx4 v[32:35], v21, s[52:55], s9 offen sc1
    buffer_load_dwordx4 v[36:39], v21, s[52:55], s10 offen sc1
    v_mul_u32_u24 v22, 4640, v22
    v_lshl_add_u32 v19, v20, 4, v22
    s_mov_b32 s72, s32
    s_mov_b32 s73, s33
    s_mov_b32 s74, 7340032
    s_mov_b32 s75, 0x20000
    v_lshrrev_b32_e64 v2, 3, v1
    v_mul_u32_u24 v2, 3584, v2
    v_bfe_u32 v3, v1, 4, 1
    v_lshlrev_b32 v3, 2, v3
    v_and_b32 v16, 7, v1
    v_xor_b32_e64 v16, v16, v3
    v_lshl_add_u32 v16, v16, 4, v2
    v_bfe_u32 v2, v1, 2, 2
    v_lshrrev_b32 v3, 5, v1
    v_lshl_add_u32 v3, v3, 3, v2
    v_lshlrev_b32 v3, 7, v3
    v_lshrrev_b32_e64 v2, 1, v2
    v_lshl_add_u32 v3, v2, 6, v3
    v_bfe_u32 v2, v1, 4, 1
    v_lshl_add_u32 v3, v2, 5, v3
    v_and_b32_e64 v2, 3, v1
    v_lshl_add_u32 v3, v2, 3, v3
    s_mul_i32 s9, s3, 22528
    s_add_u32 s9, s9, 73728
    v_add_u32 v14, s9, v3
    v_xor_b32 v15, 64, v14
    v_mov_b32 v2, 0x40000000
    s_cmp_eq_u32 s18, 0
    s_cselect_b64 vcc, -1, 0
    v_cndmask_b32 v16, v16, v2, vcc
    v_and_b32 v64, 0xffff, v40
    v_lshrrev_b32 v65, 16, v40
    v_and_b32 v66, 0xffff, v41
    v_lshrrev_b32 v67, 16, v41
    v_and_b32 v68, 0xffff, v42
    v_lshrrev_b32 v69, 16, v42
    v_and_b32 v70, 0xffff, v43
    v_lshrrev_b32 v71, 16, v43
    v_and_b32 v72, 0xffff, v44
    v_lshrrev_b32_e64 v73, 16, v44
    v_and_b32 v74, 0xffff, v45
    ds_read_b32 v80, v64 offset:0
    ds_read_b32 v81, v65 offset:0
    ds_read_b32 v82, v66 offset:0
    ds_read_b32 v83, v67 offset:0
    ds_read_b32 v84, v68 offset:0
    ds_read_b32 v85, v69 offset:0
    ds_read_b32 v86, v70 offset:0
    ds_read_b32 v87, v71 offset:0
    ds_read_b32 v88, v72 offset:0
    ds_read_b32 v89, v73 offset:0
    ds_read_b32 v90, v74 offset:0
    ds_read_b32 v96, v64 offset:3584
    ds_read_b32 v97, v65 offset:3584
    ds_read_b32 v98, v66 offset:3584
    ds_read_b32 v99, v67 offset:3584
    ds_read_b32 v100, v68 offset:3584
    ds_read_b32 v101, v69 offset:3584
    ds_read_b32 v102, v70 offset:3584
    ds_read_b32 v103, v71 offset:3584
    ds_read_b32 v104, v72 offset:3584
    ds_read_b32 v105, v73 offset:3584
    ds_read_b32 v106, v74 offset:3584
    v_and_b32_e64 v28, 7, v1
    v_add_u32 v29, 256, v28
    v_min_u32 v29, 261, v29
    v_cmp_gt_u32 vcc, 2, v28
    s_nop 1
    v_cndmask_b32 v29, v29, v28, vcc
    v_lshrrev_b32 v28, 3, v1
    v_mul_u32_u24 v28, 4416, v28
    v_lshl_add_u32 v28, v29, 4, v28
    v_add_u32 v28, 36864, v28
    ds_write_b128 v28, v[48:51]
    v_lshlrev_b32 v29, 4, v0
    v_sub_u32 v29, 40976, v29
    s_waitcnt lgkmcnt(12)
    v_cvt_pk_bf16_f32 v112, v80, v81
    v_cvt_pk_bf16_f32 v113, v82, v83
    v_cvt_pk_bf16_f32 v114, v84, v85
    v_cvt_pk_bf16_f32 v115, v86, v87
    v_cvt_pk_bf16_f32 v116, v81, v82
    v_cvt_pk_bf16_f32 v117, v83, v84
    v_cvt_pk_bf16_f32 v118, v85, v86
    v_cvt_pk_bf16_f32 v119, v87, v88
    v_cvt_pk_bf16_f32 v120, v82, v83
    v_cvt_pk_bf16_f32 v121, v84, v85
    v_cvt_pk_bf16_f32 v122, v86, v87
    v_cvt_pk_bf16_f32 v123, v88, v89
    v_cvt_pk_bf16_f32 v124, v83, v84
    v_cvt_pk_bf16_f32 v125, v85, v86
    v_cvt_pk_bf16_f32 v126, v87, v88
    v_cvt_pk_bf16_f32 v127, v89, v90
    ds_write_b128 v29, v[124:127] offset:0
    ds_write_b128 v29, v[120:123] offset:4416
    ds_write_b128 v29, v[116:119] offset:8832
    ds_write_b128 v29, v[112:115] offset:13248
    s_waitcnt lgkmcnt(5)
    s_nop 0
    v_cvt_pk_bf16_f32 v128, v96, v97
    v_cvt_pk_bf16_f32 v129, v98, v99
    v_cvt_pk_bf16_f32 v130, v100, v101
    v_cvt_pk_bf16_f32 v131, v102, v103
    v_cvt_pk_bf16_f32 v132, v97, v98
    v_cvt_pk_bf16_f32 v133, v99, v100
    v_cvt_pk_bf16_f32 v134, v101, v102
    v_cvt_pk_bf16_f32 v135, v103, v104
    v_cvt_pk_bf16_f32 v136, v98, v99
    v_cvt_pk_bf16_f32 v137, v100, v101
    v_cvt_pk_bf16_f32 v138, v102, v103
    v_cvt_pk_bf16_f32 v139, v104, v105
    v_cvt_pk_bf16_f32 v140, v99, v100
    v_cvt_pk_bf16_f32 v141, v101, v102
    v_cvt_pk_bf16_f32 v142, v103, v104
    v_cvt_pk_bf16_f32 v143, v105, v106
    ds_write_b128 v29, v[140:143] offset:17664
    ds_write_b128 v29, v[136:139] offset:22080
    ds_write_b128 v29, v[132:135] offset:26496
    ds_write_b128 v29, v[128:131] offset:30912
    s_lshr_b32 s10, s3, 1
    s_and_b32 s11, s3, 1
    s_lshl_b32 s11, s11, 8
    s_mul_i32 s12, s10, 17664
    s_sub_u32 s12, s12, s11
    s_add_u32 s12, s12, 36888
    v_and_b32 v22, 3, v1
    v_mul_u32_u24 v22, 4416, v22
    v_lshrrev_b32 v23, 4, v1
    v_lshl_add_u32 v22, v23, 4, v22
    v_bfe_u32 v24, v1, 3, 1
    v_lshlrev_b32 v24, 4, v24
    v_sub_u32 v22, v22, v24
    v_bfe_u32 v24, v1, 2, 1
    v_lshlrev_b32 v24, 3, v24
    v_sub_u32 v22, v22, v24
    v_add_u32 v20, s12, v22
    s_mul_i32 s12, s10, 4640
    s_sub_u32 s12, s12, s11
    s_add_u32 s12, s12, 7488
    v_and_b32 v22, 15, v1
    v_lshlrev_b32 v22, 5, v22
    v_lshl_add_u32 v22, v23, 4, v22
    v_add_u32 v21, s12, v22
    s_lshl_b32 s12, s3, 12
    s_add_u32 s12, s12, 20480
    v_lshlrev_b32 v22, 4, v1
    v_add_u32 v26, s12, v22
    s_xor_b32 s13, s3, 1
    s_lshl_b32 s13, s13, 12
    s_add_u32 s12, s13, 20480
    v_add_u32 v27, s12, v22
    v_and_b32 v25, 15, v1
    v_lshlrev_b32_e64 v25, 5, v25
    v_bfe_u32 v23, v1, 4, 1
    v_lshl_add_u32 v25, v23, 9, v25
    v_lshrrev_b32 v23, 5, v1
    v_lshl_add_u32 v25, v23, 4, v25
    s_lshl_b32 s12, s7, 1
    s_add_u32 s12, s12, s10
    s_mul_i32 s12, s12, 4224
    s_lshl_b32 s13, s11, 3
    s_add_u32 s12, s12, s13
    s_add_u32 s31, s12, 3145728
    s_waitcnt vmcnt(0)
    ds_write_b128 v19, v[32:35] offset:7680
    ds_write_b128 v19, v[36:39] offset:9728
    s_waitcnt lgkmcnt(0)
    s_barrier
    v_lshlrev_b32_e64 v247, 7, v0
    s_mov_b32 s9, 32768
    buffer_load_dword v248, v247, s[52:55], s9 offen sc1
    ds_read_b64 v[64:65], v20 offset:4096
    ds_read_b64 v[66:67], v20 offset:4104
    ds_read_b128 v[96:99], v21 offset:192
    ds_read_b64 v[68:69], v20 offset:3584
    ds_read_b64 v[70:71], v20 offset:3592
    ds_read_b128 v[100:103], v21 offset:704
    ds_read_b64 v[72:73], v20 offset:3072
    ds_read_b64 v[74:75], v20 offset:3080
    ds_read_b128 v[104:107], v21 offset:1216
    ds_read_b64 v[76:77], v20 offset:2560
    ds_read_b64 v[78:79], v20 offset:2568
    ds_read_b128 v[108:111], v21 offset:1728
    ds_read_b64 v[80:81], v20 offset:2048
    ds_read_b64 v[82:83], v20 offset:2056
    ds_read_b128 v[112:115], v21 offset:2240
    ds_read_b64 v[84:85], v20 offset:1536
    ds_read_b64 v[86:87], v20 offset:1544
    ds_read_b128 v[116:119], v21 offset:2752
    ds_read_b64 v[88:89], v20 offset:1024
    ds_read_b64 v[90:91], v20 offset:1032
    ds_read_b128 v[120:123], v21 offset:3264
    ds_read_b64 v[92:93], v20 offset:512
    ds_read_b64 v[94:95], v20 offset:520
    ds_read_b128 v[124:127], v21 offset:3776
    v_subrev_u32 v22, 320, v21
    ds_read_b64 v[192:193], v20
    ds_read_b64 v[194:195], v20 offset:8
    ds_read_b128 v[196:199], v22
    s_waitcnt lgkmcnt(0)
    s_nop 0
    v_mfma_f32_16x16x32_bf16 v[32:35], v[64:67], v[96:99], 0
    ds_read_b64 v[128:129], v20 offset:4032
    s_mul_i32 s24, s3, 1835008
    v_mfma_f32_16x16x32_bf16 v[36:39], v[68:71], v[96:99], 0
    ds_read_b64 v[130:131], v20 offset:4040
    s_lshl_b32 s27, s17, 7
    s_nop 0
    v_mfma_f32_16x16x32_bf16 v[36:39], v[64:67], v[100:103], v[36:39]
    ds_read_b128 v[160:163], v21 offset:128
    s_add_u32 s24, s24, s27
    s_nop 0
    v_mfma_f32_16x16x32_bf16 v[40:43], v[68:71], v[100:103], 0
    ds_read_b64 v[132:133], v20 offset:3520
    s_mul_i32 s27, s3, 22528
    v_mfma_f32_16x16x32_bf16 v[40:43], v[72:75], v[96:99], v[40:43]
    ds_read_b64 v[134:135], v20 offset:3528
    v_mfma_f32_16x16x32_bf16 v[40:43], v[64:67], v[104:107], v[40:43]
    ds_read_b128 v[164:167], v21 offset:640
    s_add_u32 s27, s27, 73728
    v_mfma_f32_16x16x32_bf16 v[44:47], v[72:75], v[100:103], 0
    ds_read_b64 v[136:137], v20 offset:3008
    s_add_u32 s25, s27, 22528
    v_mfma_f32_16x16x32_bf16 v[44:47], v[68:71], v[104:107], v[44:47]
    ds_read_b64 v[138:139], v20 offset:3016
    s_mul_i32 s71, s22, 57344
    v_mfma_f32_16x16x32_bf16 v[48:51], v[72:75], v[104:107], 0
    ds_read_b128 v[168:171], v21 offset:1152
    v_mfma_f32_16x16x32_bf16 v[44:47], v[76:79], v[96:99], v[44:47]
    ds_read_b64 v[140:141], v20 offset:2496
    s_add_u32 s24, s24, s71
    s_nop 0
    v_mfma_f32_16x16x32_bf16 v[44:47], v[64:67], v[108:111], v[44:47]
    ds_read_b64 v[142:143], v20 offset:2504
    s_lshl_b32 s71, s22, 11
    s_nop 0
    v_mfma_f32_16x16x32_bf16 v[48:51], v[76:79], v[100:103], v[48:51]
    ds_read_b128 v[172:175], v21 offset:1664
    s_add_u32 m0, s27, s71
    s_nop 0
    v_mfma_f32_16x16x32_bf16 v[48:51], v[68:71], v[108:111], v[48:51]
    ds_read_b64 v[144:145], v20 offset:1984
    s_nop 0
    s_nop 0
    v_mfma_f32_16x16x32_bf16 v[52:55], v[76:79], v[104:107], 0
    ds_read_b64 v[146:147], v20 offset:1992
    v_mfma_f32_16x16x32_bf16 v[52:55], v[72:75], v[108:111], v[52:55]
    ds_read_b128 v[176:179], v21 offset:2176
    buffer_load_dwordx4 v16, s[72:75], s24 offen lds
    v_mfma_f32_16x16x32_bf16 v[56:59], v[76:79], v[108:111], 0
    ds_read_b64 v[148:149], v20 offset:1472
    s_add_u32 m0, m0, 1024
    v_mfma_f32_16x16x32_bf16 v[48:51], v[80:83], v[96:99], v[48:51]
    ds_read_b64 v[150:151], v20 offset:1480
    s_add_u32 s24, s24, 28672
    v_mfma_f32_16x16x32_bf16 v[48:51], v[64:67], v[112:115], v[48:51]
    ds_read_b128 v[180:183], v21 offset:2688
    v_mfma_f32_16x16x32_bf16 v[52:55], v[80:83], v[100:103], v[52:55]
    ds_read_b64 v[152:153], v20 offset:960
    buffer_load_dwordx4 v16, s[72:75], s24 offen lds
    v_mfma_f32_16x16x32_bf16 v[52:55], v[68:71], v[112:115], v[52:55]
    ds_read_b64 v[154:155], v20 offset:968
    s_add_u32 m0, m0, 1024
    v_mfma_f32_16x16x32_bf16 v[56:59], v[80:83], v[104:107], v[56:59]
    ds_read_b128 v[184:187], v21 offset:3200
    s_add_u32 s24, s24, 28672
    v_mfma_f32_16x16x32_bf16 v[56:59], v[72:75], v[112:115], v[56:59]
    ds_read_b64 v[156:157], v20 offset:448
    v_mfma_f32_16x16x32_bf16 v[60:63], v[80:83], v[108:111], 0
    ds_read_b64 v[158:159], v20 offset:456
    s_cmp_eq_u32 m0, s25
    s_nop 0
    s_cselect_b32 s71, 22528, 0
    s_cselect_b32 s27, 630784, 0
    v_mfma_f32_16x16x32_bf16 v[60:63], v[76:79], v[112:115], v[60:63]
    ds_read_b128 v[188:191], v21 offset:3712
    s_sub_u32 m0, m0, s71
    v_mfma_f32_16x16x32_bf16 v[52:55], v[84:87], v[96:99], v[52:55]
    s_sub_u32 s24, s24, s27
    v_mfma_f32_16x16x32_bf16 v[52:55], v[64:67], v[116:119], v[52:55]
    buffer_load_dwordx4 v16, s[72:75], s24 offen lds
    v_mfma_f32_16x16x32_bf16 v[56:59], v[84:87], v[100:103], v[56:59]
    v_mfma_f32_16x16x32_bf16 v[56:59], v[68:71], v[116:119], v[56:59]
    s_add_u32 m0, m0, 1024
    v_mfma_f32_16x16x32_bf16 v[60:63], v[84:87], v[104:107], v[60:63]
    s_add_u32 s24, s24, 28672
    v_mfma_f32_16x16x32_bf16 v[60:63], v[72:75], v[116:119], v[60:63]
    buffer_load_dwordx4 v16, s[72:75], s24 offen lds
    v_mfma_f32_16x16x32_bf16 v[56:59], v[88:91], v[96:99], v[56:59]
    v_mfma_f32_16x16x32_bf16 v[56:59], v[64:67], v[120:123], v[56:59]
    s_add_u32 m0, m0, 1024
    v_mfma_f32_16x16x32_bf16 v[60:63], v[88:91], v[100:103], v[60:63]
    s_add_u32 s24, s24, 28672
    v_mfma_f32_16x16x32_bf16 v[60:63], v[68:71], v[120:123], v[60:63]
    s_cmp_eq_u32 m0, s25
    s_nop 0
    s_cselect_b32 s71, 22528, 0
    s_cselect_b32 s27, 630784, 0
    v_mfma_f32_16x16x32_bf16 v[60:63], v[92:95], v[96:99], v[60:63]
    s_sub_u32 m0, m0, s71
    v_mfma_f32_16x16x32_bf16 v[60:63], v[64:67], v[124:127], v[60:63]
    s_cmp_lg_u32 s11, 0
    s_cbranch_scc1 L_c_nox
    s_nop 0
    v_mfma_f32_16x16x32_bf16 v[32:35], v[68:71], v[196:199], v[32:35]
    v_mfma_f32_16x16x32_bf16 v[36:39], v[72:75], v[196:199], v[36:39]
    v_mfma_f32_16x16x32_bf16 v[40:43], v[76:79], v[196:199], v[40:43]
    v_mfma_f32_16x16x32_bf16 v[44:47], v[80:83], v[196:199], v[44:47]
    v_mfma_f32_16x16x32_bf16 v[48:51], v[84:87], v[196:199], v[48:51]
    v_mfma_f32_16x16x32_bf16 v[52:55], v[88:91], v[196:199], v[52:55]
    v_mfma_f32_16x16x32_bf16 v[56:59], v[92:95], v[196:199], v[56:59]
    v_mfma_f32_16x16x32_bf16 v[60:63], v[192:195], v[196:199], v[60:63]
L_c_nox:
    s_waitcnt lgkmcnt(0)
    s_nop 0
    v_mfma_f32_16x16x32_bf16 v[32:35], v[128:131], v[160:163], v[32:35]
    ds_read_b64 v[64:65], v20 offset:3968
    s_sub_u32 s24, s24, s27
    s_nop 0
    v_mfma_f32_16x16x32_bf16 v[36:39], v[132:135], v[160:163], v[36:39]
    ds_read_b64 v[66:67], v20 offset:3976
    buffer_load_dwordx4 v16, s[72:75], s24 offen lds
    v_mfma_f32_16x16x32_bf16 v[36:39], v[128:131], v[164:167], v[36:39]
    ds_read_b128 v[96:99], v21 offset:64
    s_add_u32 m0, m0, 1024
    v_mfma_f32_16x16x32_bf16 v[40:43], v[132:135], v[164:167], v[40:43]
    ds_read_b64 v[68:69], v20 offset:3456
    v_mfma_f32_16x16x32_bf16 v[40:43], v[136:139], v[160:163], v[40:43]
    ds_read_b64 v[70:71], v20 offset:3464
    s_add_u32 s24, s24, 28672
    v_mfma_f32_16x16x32_bf16 v[40:43], v[128:131], v[168:171], v[40:43]
    ds_read_b128 v[100:103], v21 offset:576
    buffer_load_dwordx4 v16, s[72:75], s24 offen lds
    v_mfma_f32_16x16x32_bf16 v[44:47], v[136:139], v[164:167], v[44:47]
    ds_read_b64 v[72:73], v20 offset:2944
    s_add_u32 m0, m0, 1024
    v_mfma_f32_16x16x32_bf16 v[44:47], v[132:135], v[168:171], v[44:47]
    ds_read_b64 v[74:75], v20 offset:2952
    v_mfma_f32_16x16x32_bf16 v[48:51], v[136:139], v[168:171], v[48:51]
    ds_read_b128 v[104:107], v21 offset:1088
    s_add_u32 s24, s24, 28672
    v_mfma_f32_16x16x32_bf16 v[44:47], v[140:143], v[160:163], v[44:47]
    ds_read_b64 v[76:77], v20 offset:2432
    s_cmp_eq_u32 m0, s25
    s_nop 0
    s_cselect_b32 s71, 22528, 0
    s_cselect_b32 s27, 630784, 0
    v_mfma_f32_16x16x32_bf16 v[44:47], v[128:131], v[172:175], v[44:47]
    ds_read_b64 v[78:79], v20 offset:2440
    s_sub_u32 m0, m0, s71
    s_nop 0
    v_mfma_f32_16x16x32_bf16 v[48:51], v[140:143], v[164:167], v[48:51]
    ds_read_b128 v[108:111], v21 offset:1600
    s_sub_u32 s24, s24, s27
    s_nop 0
    v_mfma_f32_16x16x32_bf16 v[48:51], v[132:135], v[172:175], v[48:51]
    ds_read_b64 v[80:81], v20 offset:1920
    v_mfma_f32_16x16x32_bf16 v[52:55], v[140:143], v[168:171], v[52:55]
    ds_read_b64 v[82:83], v20 offset:1928
    buffer_load_dwordx4 v16, s[72:75], s24 offen lds
    v_mfma_f32_16x16x32_bf16 v[52:55], v[136:139], v[172:175], v[52:55]
    ds_read_b128 v[112:115], v21 offset:2112
    s_add_u32 m0, m0, 1024
    v_mfma_f32_16x16x32_bf16 v[56:59], v[140:143], v[172:175], v[56:59]
    ds_read_b64 v[84:85], v20 offset:1408
    s_add_u32 s24, s24, 28672
    v_mfma_f32_16x16x32_bf16 v[48:51], v[144:147], v[160:163], v[48:51]
    ds_read_b64 v[86:87], v20 offset:1416
    v_mfma_f32_16x16x32_bf16 v[48:51], v[128:131], v[176:179], v[48:51]
    ds_read_b128 v[116:119], v21 offset:2624
    buffer_load_dwordx4 v16, s[72:75], s24 offen lds
    v_mfma_f32_16x16x32_bf16 v[52:55], v[144:147], v[164:167], v[52:55]
    ds_read_b64 v[88:89], v20 offset:896
    s_add_u32 m0, m0, 1024
    v_mfma_f32_16x16x32_bf16 v[52:55], v[132:135], v[176:179], v[52:55]
    ds_read_b64 v[90:91], v20 offset:904
    s_add_u32 s24, s24, 28672
    v_mfma_f32_16x16x32_bf16 v[56:59], v[144:147], v[168:171], v[56:59]
    ds_read_b128 v[120:123], v21 offset:3136
    s_cmp_eq_u32 m0, s25
    s_nop 0
    s_cselect_b32 s71, 22528, 0
    s_cselect_b32 s27, 630784, 0
    v_mfma_f32_16x16x32_bf16 v[56:59], v[136:139], v[176:179], v[56:59]
    ds_read_b64 v[92:93], v20 offset:384
    v_mfma_f32_16x16x32_bf16 v[60:63], v[144:147], v[172:175], v[60:63]
    ds_read_b64 v[94:95], v20 offset:392
    s_sub_u32 m0, m0, s71
    s_nop 0
    v_mfma_f32_16x16x32_bf16 v[60:63], v[140:143], v[176:179], v[60:63]
    ds_read_b128 v[124:127], v21 offset:3648
    s_sub_u32 s24, s24, s27
    s_nop 0
    v_mfma_f32_16x16x32_bf16 v[52:55], v[148:151], v[160:163], v[52:55]
    buffer_load_dwordx4 v16, s[72:75], s24 offen lds
    v_mfma_f32_16x16x32_bf16 v[52:55], v[128:131], v[180:183], v[52:55]
    v_mfma_f32_16x16x32_bf16 v[56:59], v[148:151], v[164:167], v[56:59]
    s_add_u32 m0, m0, 1024
    v_mfma_f32_16x16x32_bf16 v[56:59], v[132:135], v[180:183], v[56:59]
    s_add_u32 s24, s24, 28672
    v_mfma_f32_16x16x32_bf16 v[60:63], v[148:151], v[168:171], v[60:63]
    buffer_load_dwordx4 v16, s[72:75], s24 offen lds
    v_mfma_f32_16x16x32_bf16 v[60:63], v[136:139], v[180:183], v[60:63]
    v_mfma_f32_16x16x32_bf16 v[56:59], v[152:155], v[160:163], v[56:59]
    s_add_u32 m0, m0, 1024
    v_mfma_f32_16x16x32_bf16 v[56:59], v[128:131], v[184:187], v[56:59]
    s_add_u32 s24, s24, 28672
    v_mfma_f32_16x16x32_bf16 v[60:63], v[152:155], v[164:167], v[60:63]
    s_cmp_eq_u32 m0, s25
    s_nop 0
    s_cselect_b32 s71, 22528, 0
    s_cselect_b32 s27, 630784, 0
    v_mfma_f32_16x16x32_bf16 v[60:63], v[132:135], v[184:187], v[60:63]
    s_sub_u32 m0, m0, s71
    s_nop 0
    v_mfma_f32_16x16x32_bf16 v[60:63], v[156:159], v[160:163], v[60:63]
    v_mfma_f32_16x16x32_bf16 v[60:63], v[128:131], v[188:191], v[60:63]
    s_sub_u32 s24, s24, s27
    s_waitcnt lgkmcnt(0)
    v_mfma_f32_16x16x32_bf16 v[32:35], v[64:67], v[96:99], v[32:35]
    ds_read_b64 v[128:129], v20 offset:3904
    buffer_load_dwordx4 v16, s[72:75], s24 offen lds
    v_mfma_f32_16x16x32_bf16 v[36:39], v[68:71], v[96:99], v[36:39]
    ds_read_b64 v[130:131], v20 offset:3912
    s_add_u32 m0, m0, 1024
    v_mfma_f32_16x16x32_bf16 v[36:39], v[64:67], v[100:103], v[36:39]
    ds_read_b128 v[160:163], v21 offset:0
    v_mfma_f32_16x16x32_bf16 v[40:43], v[68:71], v[100:103], v[40:43]
    ds_read_b64 v[132:133], v20 offset:3392
    s_add_u32 s24, s24, 28672
    v_mfma_f32_16x16x32_bf16 v[40:43], v[72:75], v[96:99], v[40:43]
    ds_read_b64 v[134:135], v20 offset:3400
    buffer_load_dwordx4 v16, s[72:75], s24 offen lds
    v_mfma_f32_16x16x32_bf16 v[40:43], v[64:67], v[104:107], v[40:43]
    ds_read_b128 v[164:167], v21 offset:512
    s_add_u32 m0, m0, 1024
    v_mfma_f32_16x16x32_bf16 v[44:47], v[72:75], v[100:103], v[44:47]
    ds_read_b64 v[136:137], v20 offset:2880
    v_mfma_f32_16x16x32_bf16 v[44:47], v[68:71], v[104:107], v[44:47]
    ds_read_b64 v[138:139], v20 offset:2888
    s_add_u32 s24, s24, 28672
    v_mfma_f32_16x16x32_bf16 v[48:51], v[72:75], v[104:107], v[48:51]
    ds_read_b128 v[168:171], v21 offset:1024
    s_cmp_eq_u32 m0, s25
    s_nop 0
    s_cselect_b32 s71, 22528, 0
    s_cselect_b32 s27, 630784, 0
    v_mfma_f32_16x16x32_bf16 v[44:47], v[76:79], v[96:99], v[44:47]
    ds_read_b64 v[140:141], v20 offset:2368
    s_sub_u32 m0, m0, s71
    s_nop 0
    v_mfma_f32_16x16x32_bf16 v[44:47], v[64:67], v[108:111], v[44:47]
    ds_read_b64 v[142:143], v20 offset:2376
    s_sub_u32 s24, s24, s27
    s_nop 0
    v_mfma_f32_16x16x32_bf16 v[48:51], v[76:79], v[100:103], v[48:51]
    ds_read_b128 v[172:175], v21 offset:1536
    v_mfma_f32_16x16x32_bf16 v[48:51], v[68:71], v[108:111], v[48:51]
    ds_read_b64 v[144:145], v20 offset:1856
    buffer_load_dwordx4 v16, s[72:75], s24 offen lds
    v_mfma_f32_16x16x32_bf16 v[52:55], v[76:79], v[104:107], v[52:55]
    ds_read_b64 v[146:147], v20 offset:1864
    s_add_u32 m0, m0, 1024
    v_mfma_f32_16x16x32_bf16 v[52:55], v[72:75], v[108:111], v[52:55]
    ds_read_b128 v[176:179], v21 offset:2048
    s_add_u32 s24, s24, 28672
    v_mfma_f32_16x16x32_bf16 v[56:59], v[76:79], v[108:111], v[56:59]
    ds_read_b64 v[148:149], v20 offset:1344
    v_mfma_f32_16x16x32_bf16 v[48:51], v[80:83], v[96:99], v[48:51]
    ds_read_b64 v[150:151], v20 offset:1352
    buffer_load_dwordx4 v16, s[72:75], s24 offen lds
    v_mfma_f32_16x16x32_bf16 v[48:51], v[64:67], v[112:115], v[48:51]
    ds_read_b128 v[180:183], v21 offset:2560
    s_add_u32 m0, m0, 1024
    v_mfma_f32_16x16x32_bf16 v[52:55], v[80:83], v[100:103], v[52:55]
    ds_read_b64 v[152:153], v20 offset:832
    s_add_u32 s24, s24, 28672
    v_mfma_f32_16x16x32_bf16 v[52:55], v[68:71], v[112:115], v[52:55]
    ds_read_b64 v[154:155], v20 offset:840
    s_cmp_eq_u32 m0, s25
    s_nop 0
    s_cselect_b32 s71, 22528, 0
    s_cselect_b32 s27, 630784, 0
    v_mfma_f32_16x16x32_bf16 v[56:59], v[80:83], v[104:107], v[56:59]
    ds_read_b128 v[184:187], v21 offset:3072
    v_mfma_f32_16x16x32_bf16 v[56:59], v[72:75], v[112:115], v[56:59]
    ds_read_b64 v[156:157], v20 offset:320
    s_sub_u32 m0, m0, s71
    s_nop 0
    v_mfma_f32_16x16x32_bf16 v[60:63], v[80:83], v[108:111], v[60:63]
    ds_read_b64 v[158:159], v20 offset:328
    s_sub_u32 s24, s24, s27
    s_nop 0
    v_mfma_f32_16x16x32_bf16 v[60:63], v[76:79], v[112:115], v[60:63]
    ds_read_b128 v[188:191], v21 offset:3584
    buffer_load_dwordx4 v16, s[72:75], s24 offen lds
    v_mfma_f32_16x16x32_bf16 v[52:55], v[84:87], v[96:99], v[52:55]
    v_mfma_f32_16x16x32_bf16 v[52:55], v[64:67], v[116:119], v[52:55]
    s_add_u32 m0, m0, 1024
    v_mfma_f32_16x16x32_bf16 v[56:59], v[84:87], v[100:103], v[56:59]
    s_add_u32 s24, s24, 28672
    v_mfma_f32_16x16x32_bf16 v[56:59], v[68:71], v[116:119], v[56:59]
    buffer_load_dwordx4 v16, s[72:75], s24 offen lds
    v_mfma_f32_16x16x32_bf16 v[60:63], v[84:87], v[104:107], v[60:63]
    v_mfma_f32_16x16x32_bf16 v[60:63], v[72:75], v[116:119], v[60:63]
    s_add_u32 m0, m0, 1024
    v_mfma_f32_16x16x32_bf16 v[56:59], v[88:91], v[96:99], v[56:59]
    s_add_u32 s24, s24, 28672
    v_mfma_f32_16x16x32_bf16 v[56:59], v[64:67], v[120:123], v[56:59]
    s_cmp_eq_u32 m0, s25
    s_nop 0
    s_cselect_b32 s71, 22528, 0
    s_cselect_b32 s27, 630784, 0
    v_mfma_f32_16x16x32_bf16 v[60:63], v[88:91], v[100:103], v[60:63]
    s_sub_u32 m0, m0, s71
    s_nop 0
    v_mfma_f32_16x16x32_bf16 v[60:63], v[68:71], v[120:123], v[60:63]
    v_mfma_f32_16x16x32_bf16 v[60:63], v[92:95], v[96:99], v[60:63]
    s_sub_u32 s24, s24, s27
    s_nop 0
    v_mfma_f32_16x16x32_bf16 v[60:63], v[64:67], v[124:127], v[60:63]
    buffer_load_dwordx4 v16, s[72:75], s24 offen lds
    s_waitcnt lgkmcnt(0)
    s_nop 0
    v_mfma_f32_16x16x32_bf16 v[32:35], v[128:131], v[160:163], v[32:35]
    s_add_u32 m0, m0, 1024
    v_mfma_f32_16x16x32_bf16 v[36:39], v[132:135], v[160:163], v[36:39]
    v_mfma_f32_16x16x32_bf16 v[36:39], v[128:131], v[164:167], v[36:39]
    s_add_u32 s24, s24, 28672
    v_mfma_f32_16x16x32_bf16 v[40:43], v[132:135], v[164:167], v[40:43]
    buffer_load_dwordx4 v16, s[72:75], s24 offen lds
    v_mfma_f32_16x16x32_bf16 v[40:43], v[136:139], v[160:163], v[40:43]
    s_add_u32 m0, m0, 1024
    v_mfma_f32_16x16x32_bf16 v[40:43], v[128:131], v[168:171], v[40:43]
    s_add_u32 s24, s24, 28672
    v_mfma_f32_16x16x32_bf16 v[44:47], v[136:139], v[164:167], v[44:47]
    v_mfma_f32_16x16x32_bf16 v[44:47], v[132:135], v[168:171], v[44:47]
    s_cmp_eq_u32 m0, s25
    s_nop 0
    s_cselect_b32 s71, 22528, 0
    s_cselect_b32 s27, 630784, 0
    v_mfma_f32_16x16x32_bf16 v[48:51], v[136:139], v[168:171], v[48:51]
    s_sub_u32 m0, m0, s71
    v_mfma_f32_16x16x32_bf16 v[44:47], v[140:143], v[160:163], v[44:47]
    s_sub_u32 s24, s24, s27
    v_mfma_f32_16x16x32_bf16 v[44:47], v[128:131], v[172:175], v[44:47]
    v_mfma_f32_16x16x32_bf16 v[48:51], v[140:143], v[164:167], v[48:51]
    buffer_load_dwordx4 v16, s[72:75], s24 offen lds
    v_mfma_f32_16x16x32_bf16 v[48:51], v[132:135], v[172:175], v[48:51]
    s_add_u32 m0, m0, 1024
    v_mfma_f32_16x16x32_bf16 v[52:55], v[140:143], v[168:171], v[52:55]
    s_add_u32 s24, s24, 28672
    v_mfma_f32_16x16x32_bf16 v[52:55], v[136:139], v[172:175], v[52:55]
    v_mfma_f32_16x16x32_bf16 v[56:59], v[140:143], v[172:175], v[56:59]
    buffer_load_dwordx4 v16, s[72:75], s24 offen lds
    v_mfma_f32_16x16x32_bf16 v[48:51], v[144:147], v[160:163], v[48:51]
    s_add_u32 m0, m0, 1024
    v_mfma_f32_16x16x32_bf16 v[48:51], v[128:131], v[176:179], v[48:51]
    s_add_u32 s24, s24, 28672
    v_mfma_f32_16x16x32_bf16 v[52:55], v[144:147], v[164:167], v[52:55]
    s_cmp_eq_u32 m0, s25
    s_nop 0
    s_cselect_b32 s71, 22528, 0
    s_cselect_b32 s27, 630784, 0
    v_mfma_f32_16x16x32_bf16 v[52:55], v[132:135], v[176:179], v[52:55]
    v_mfma_f32_16x16x32_bf16 v[56:59], v[144:147], v[168:171], v[56:59]
    s_sub_u32 m0, m0, s71
    v_mfma_f32_16x16x32_bf16 v[56:59], v[136:139], v[176:179], v[56:59]
    s_sub_u32 s24, s24, s27
    v_mfma_f32_16x16x32_bf16 v[60:63], v[144:147], v[172:175], v[60:63]
    buffer_load_dwordx4 v16, s[72:75], s24 offen lds
    v_mfma_f32_16x16x32_bf16 v[60:63], v[140:143], v[176:179], v[60:63]
    v_mfma_f32_16x16x32_bf16 v[52:55], v[148:151], v[160:163], v[52:55]
    s_add_u32 m0, m0, 1024
    v_mfma_f32_16x16x32_bf16 v[52:55], v[128:131], v[180:183], v[52:55]
    s_add_u32 s24, s24, 28672
    v_mfma_f32_16x16x32_bf16 v[56:59], v[148:151], v[164:167], v[56:59]
    buffer_load_dwordx4 v16, s[72:75], s24 offen lds
    v_mfma_f32_16x16x32_bf16 v[56:59], v[132:135], v[180:183], v[56:59]
    v_mfma_f32_16x16x32_bf16 v[60:63], v[148:151], v[168:171], v[60:63]
    v_mfma_f32_16x16x32_bf16 v[60:63], v[136:139], v[180:183], v[60:63]
    v_mfma_f32_16x16x32_bf16 v[56:59], v[152:155], v[160:163], v[56:59]
    v_mfma_f32_16x16x32_bf16 v[56:59], v[128:131], v[184:187], v[56:59]
    v_mfma_f32_16x16x32_bf16 v[60:63], v[152:155], v[164:167], v[60:63]
    v_mfma_f32_16x16x32_bf16 v[60:63], v[132:135], v[184:187], v[60:63]
    v_mfma_f32_16x16x32_bf16 v[60:63], v[156:159], v[160:163], v[60:63]
    v_mfma_f32_16x16x32_bf16 v[60:63], v[128:131], v[188:191], v[60:63]
    s_waitcnt vmcnt(22)
    v_cmp_ne_u32 vcc, s8, v248
    s_cbranch_vccz L_marks_ok
    s_mov_b32 s9, 32768
    s_mov_b32 s12, 0
L_marks:
    buffer_load_dword v248, v247, s[52:55], s9 offen sc1
    s_add_u32 s12, s12, 1
    s_cmp_gt_u32 s12, 131072
    s_cbranch_scc1 L_marks_ok
    s_waitcnt vmcnt(0)
    v_cmp_ne_u32 vcc, s8, v248
    s_cbranch_vccnz L_marks
L_marks_ok:
    s_cmp_lg_u32 s11, 0
    s_cbranch_scc1 L_c_hi
    s_nop 0
    ds_write_b128 v26, v[48:51] offset:0
    ds_write_b128 v26, v[52:55] offset:1024
    ds_write_b128 v26, v[56:59] offset:2048
    ds_write_b128 v26, v[60:63] offset:3072
    s_branch L_c_wr
L_c_hi:
    s_nop 0
    ds_write_b128 v26, v[32:35] offset:0
    ds_write_b128 v26, v[36:39] offset:1024
    ds_write_b128 v26, v[40:43] offset:2048
    ds_write_b128 v26, v[44:47] offset:3072
    v_mov_b32 v32, v48
    v_mov_b32 v33, v49
    v_mov_b32 v34, v50
    v_mov_b32 v35, v51
    v_mov_b32 v36, v52
    v_mov_b32 v37, v53
    v_mov_b32 v38, v54
    v_mov_b32 v39, v55
    v_mov_b32 v40, v56
    v_mov_b32 v41, v57
    v_mov_b32 v42, v58
    v_mov_b32 v43, v59
    v_mov_b32 v44, v60
    v_mov_b32 v45, v61
    v_mov_b32 v46, v62
    v_mov_b32 v47, v63
L_c_wr:
    s_waitcnt lgkmcnt(0)
    s_barrier
    ds_read_b128 v[64:67], v27 offset:0
    ds_read_b128 v[68:71], v27 offset:1024
    ds_read_b128 v[72:75], v27 offset:2048
    ds_read_b128 v[76:79], v27 offset:3072
    s_waitcnt lgkmcnt(0)
    s_nop 0
    v_pk_add_f32 v[32:33], v[32:33], v[64:65]
    v_pk_add_f32 v[34:35], v[34:35], v[66:67]
    v_pk_add_f32 v[36:37], v[36:37], v[68:69]
    v_pk_add_f32 v[38:39], v[38:39], v[70:71]
    v_pk_add_f32 v[40:41], v[40:41], v[72:73]
    v_pk_add_f32 v[42:43], v[42:43], v[74:75]
    v_pk_add_f32 v[44:45], v[44:45], v[76:77]
    v_pk_add_f32 v[46:47], v[46:47], v[78:79]
    v_cvt_pk_bf16_f32 v80, v32, v33
    v_cvt_pk_bf16_f32 v81, v34, v35
    v_cvt_pk_bf16_f32 v82, v36, v37
    v_cvt_pk_bf16_f32 v83, v38, v39
    v_cvt_pk_bf16_f32 v84, v40, v41
    v_cvt_pk_bf16_f32 v85, v42, v43
    v_cvt_pk_bf16_f32 v86, v44, v45
    v_cvt_pk_bf16_f32 v87, v46, v47
    v_permlane16_swap_b32 v80, v82
    v_permlane16_swap_b32 v81, v83
    v_permlane16_swap_b32 v84, v86
    v_permlane16_swap_b32 v85, v87
    buffer_store_dwordx4 v[80:83], v25, s[52:55], s31 offen offset:0 sc1
    buffer_store_dwordx4 v[84:87], v25, s[52:55], s31 offen offset:1024 sc1
    s_waitcnt vmcnt(2)
    s_nop 0
    ds_read_b64_tr_b16 a[0:1], v14 offset:0
    ds_read_b64_tr_b16 a[2:3], v14 offset:512
    ds_read_b64_tr_b16 a[4:5], v15 offset:0
    ds_read_b64_tr_b16 a[6:7], v15 offset:512
    ds_read_b64_tr_b16 a[8:9], v14 offset:2048
    ds_read_b64_tr_b16 a[10:11], v14 offset:2560
    ds_read_b64_tr_b16 a[12:13], v15 offset:2048
    ds_read_b64_tr_b16 a[14:15], v15 offset:2560
    ds_read_b64_tr_b16 a[16:17], v14 offset:4096
    ds_read_b64_tr_b16 a[18:19], v14 offset:4608
    ds_read_b64_tr_b16 a[20:21], v15 offset:4096
    ds_read_b64_tr_b16 a[22:23], v15 offset:4608
    ds_read_b64_tr_b16 a[24:25], v14 offset:6144
    ds_read_b64_tr_b16 a[26:27], v14 offset:6656
    ds_read_b64_tr_b16 a[28:29], v15 offset:6144
    ds_read_b64_tr_b16 a[30:31], v15 offset:6656
    ds_read_b64_tr_b16 a[32:33], v14 offset:8192
    ds_read_b64_tr_b16 a[34:35], v14 offset:8704
    ds_read_b64_tr_b16 a[36:37], v15 offset:8192
    ds_read_b64_tr_b16 a[38:39], v15 offset:8704
    ds_read_b64_tr_b16 a[40:41], v14 offset:10240
    ds_read_b64_tr_b16 a[42:43], v14 offset:10752
    ds_read_b64_tr_b16 a[44:45], v15 offset:10240
    ds_read_b64_tr_b16 a[46:47], v15 offset:10752
    ds_read_b64_tr_b16 a[48:49], v14 offset:12288
    ds_read_b64_tr_b16 a[50:51], v14 offset:12800
    ds_read_b64_tr_b16 a[52:53], v15 offset:12288
    ds_read_b64_tr_b16 a[54:55], v15 offset:12800
    ds_read_b64_tr_b16 a[56:57], v14 offset:14336
    ds_read_b64_tr_b16 a[58:59], v14 offset:14848
    ds_read_b64_tr_b16 a[60:61], v15 offset:14336
    ds_read_b64_tr_b16 a[62:63], v15 offset:14848
    ds_read_b64_tr_b16 a[64:65], v14 offset:16384
    ds_read_b64_tr_b16 a[66:67], v14 offset:16896
    ds_read_b64_tr_b16 a[68:69], v15 offset:16384
    ds_read_b64_tr_b16 a[70:71], v15 offset:16896
    ds_read_b64_tr_b16 a[72:73], v14 offset:18432
    ds_read_b64_tr_b16 a[74:75], v14 offset:18944
    ds_read_b64_tr_b16 a[76:77], v15 offset:18432
    ds_read_b64_tr_b16 a[78:79], v15 offset:18944
    ds_read_b64_tr_b16 a[80:81], v14 offset:20480
    ds_read_b64_tr_b16 a[82:83], v14 offset:20992
    ds_read_b64_tr_b16 a[84:85], v15 offset:20480
    ds_read_b64_tr_b16 a[86:87], v15 offset:20992
    s_waitcnt lgkmcnt(0)
    s_mul_i32 s24, s3, 1835008
    s_lshl_b32 s27, s17, 7
    s_add_u32 s24, s24, s27
    s_nop 0
    s_add_u32 s24, s24, 630784
    s_mul_i32 s27, s3, 22528
    s_add_u32 s27, s27, 73728
    s_add_u32 s25, s27, 22528
    s_mul_i32 s71, s22, 57344
    s_add_u32 s24, s24, s71
    s_lshl_b32 s71, s22, 11
    s_add_u32 m0, s27, s71
    s_nop 0
    buffer_load_dwordx4 v16, s[72:75], s24 offen lds
    s_add_u32 m0, m0, 1024
    s_add_u32 s24, s24, 28672
    buffer_load_dwordx4 v16, s[72:75], s24 offen lds
    s_add_u32 m0, m0, 1024
    s_add_u32 s24, s24, 28672
    s_cmp_eq_u32 m0, s25
    s_nop 0
    s_cselect_b32 s71, 22528, 0
    s_cselect_b32 s27, 630784, 0
    s_sub_u32 m0, m0, s71
    s_sub_u32 s24, s24, s27
    buffer_load_dwordx4 v16, s[72:75], s24 offen lds
    s_add_u32 m0, m0, 1024
    s_add_u32 s24, s24, 28672
    buffer_load_dwordx4 v16, s[72:75], s24 offen lds
    s_add_u32 m0, m0, 1024
    s_add_u32 s24, s24, 28672
    s_cmp_eq_u32 m0, s25
    s_nop 0
    s_cselect_b32 s71, 22528, 0
    s_cselect_b32 s27, 630784, 0
    s_sub_u32 m0, m0, s71
    s_sub_u32 s24, s24, s27
    buffer_load_dwordx4 v16, s[72:75], s24 offen lds
    s_add_u32 m0, m0, 1024
    s_add_u32 s24, s24, 28672
    buffer_load_dwordx4 v16, s[72:75], s24 offen lds
    s_add_u32 m0, m0, 1024
    s_add_u32 s24, s24, 28672
    s_cmp_eq_u32 m0, s25
    s_nop 0
    s_cselect_b32 s71, 22528, 0
    s_cselect_b32 s27, 630784, 0
    s_sub_u32 m0, m0, s71
    s_sub_u32 s24, s24, s27
    buffer_load_dwordx4 v16, s[72:75], s24 offen lds
    s_add_u32 m0, m0, 1024
    s_add_u32 s24, s24, 28672
    buffer_load_dwordx4 v16, s[72:75], s24 offen lds
    s_add_u32 m0, m0, 1024
    s_add_u32 s24, s24, 28672
    s_cmp_eq_u32 m0, s25
    s_nop 0
    s_cselect_b32 s71, 22528, 0
    s_cselect_b32 s27, 630784, 0
    s_sub_u32 m0, m0, s71
    s_sub_u32 s24, s24, s27
    buffer_load_dwordx4 v16, s[72:75], s24 offen lds
    s_add_u32 m0, m0, 1024
    s_add_u32 s24, s24, 28672
    buffer_load_dwordx4 v16, s[72:75], s24 offen lds
    s_add_u32 m0, m0, 1024
    s_add_u32 s24, s24, 28672
    s_cmp_eq_u32 m0, s25
    s_nop 0
    s_cselect_b32 s71, 22528, 0
    s_cselect_b32 s27, 630784, 0
    s_sub_u32 m0, m0, s71
    s_sub_u32 s24, s24, s27
    buffer_load_dwordx4 v16, s[72:75], s24 offen lds
    s_add_u32 m0, m0, 1024
    s_add_u32 s24, s24, 28672
    buffer_load_dwordx4 v16, s[72:75], s24 offen lds
    s_add_u32 m0, m0, 1024
    s_add_u32 s24, s24, 28672
    s_cmp_eq_u32 m0, s25
    s_nop 0
    s_cselect_b32 s71, 22528, 0
    s_cselect_b32 s27, 630784, 0
    s_sub_u32 m0, m0, s71
    s_sub_u32 s24, s24, s27
    buffer_load_dwordx4 v16, s[72:75], s24 offen lds
    s_add_u32 m0, m0, 1024
    s_add_u32 s24, s24, 28672
    buffer_load_dwordx4 v16, s[72:75], s24 offen lds
    s_add_u32 m0, m0, 1024
    s_add_u32 s24, s24, 28672
    s_cmp_eq_u32 m0, s25
    s_nop 0
    s_cselect_b32 s71, 22528, 0
    s_cselect_b32 s27, 630784, 0
    s_sub_u32 m0, m0, s71
    s_sub_u32 s24, s24, s27
    buffer_load_dwordx4 v16, s[72:75], s24 offen lds
    s_add_u32 m0, m0, 1024
    s_add_u32 s24, s24, 28672
    buffer_load_dwordx4 v16, s[72:75], s24 offen lds
    s_add_u32 m0, m0, 1024
    s_add_u32 s24, s24, 28672
    s_cmp_eq_u32 m0, s25
    s_nop 0
    s_cselect_b32 s71, 22528, 0
    s_cselect_b32 s27, 630784, 0
    s_sub_u32 m0, m0, s71
    s_sub_u32 s24, s24, s27
L_ln2:
    s_mov_b32 s76, s36
    s_mov_b32 s77, s37
    s_mov_b32 s78, 7340032
    s_mov_b32 s79, 0x20000
    v_mul_u32_u24 v24, 4224, v0
    v_add_u32 v25, 1081344, v24
    v_mov_b32 v28, 0x40000000
    v_cmp_gt_u32 vcc, 192, v0
    s_nop 1
    v_cndmask_b32 v25, v28, v25, vcc
    s_lshl_b32 s9, s6, 4
    s_add_u32 s9, s9, 3145728
    buffer_load_dwordx4 v[32:35], v24, s[52:55], s9 offen sc1
    buffer_load_dwordx4 v[36:39], v25, s[52:55], s9 offen sc1
    s_waitcnt vmcnt(2)
    s_mov_b32 s12, 0
L_ypoll:
    s_waitcnt vmcnt(0)
    s_nop 0
    v_max3_u32 v26, v32, v33, v34
    v_max3_u32 v26, v26, v35, v36
    v_max3_u32 v26, v26, v37, v38
    v_max_u32 v26, v26, v39
    v_cmp_eq_u32 vcc, -1, v26
    s_cbranch_vccz L_yok
    s_add_u32 s12, s12, 1
    s_cmp_gt_u32 s12, 131072
    s_cbranch_scc1 L_yok
    s_nop 0
    buffer_load_dwordx4 v[32:35], v24, s[52:55], s9 offen sc1
    buffer_load_dwordx4 v[36:39], v25, s[52:55], s9 offen sc1
    s_branch L_ypoll
L_yok:
    v_cmp_gt_u32 vcc, 192, v0
    v_lshrrev_b32 v2, 5, v0
    v_lshlrev_b32 v2, 17, v2
    v_and_b32 v3, 31, v0
    v_lshl_add_u32 v20, v3, 4, v2
    v_add_u32 v21, 0x100000, v20
    v_cndmask_b32 v21, v28, v21, vcc
    v_lshlrev_b32 v22, 4, v0
    v_mov_b32 v29, 0xffff0000
    v_lshlrev_b32 v40, 16, v4
    v_and_b32 v41, v29, v4
    v_lshlrev_b32 v48, 16, v32
    v_and_b32 v49, v29, v32
    v_lshlrev_b32_e64 v42, 16, v5
    buffer_load_dwordx4 v16, s[72:75], s24 offen lds
    s_add_u32 m0, m0, 1024
    s_add_u32 s24, s24, 28672
    v_and_b32 v43, v29, v5
    v_lshlrev_b32 v50, 16, v33
    v_and_b32 v51, v29, v33
    v_lshlrev_b32 v44, 16, v6
    v_and_b32 v45, v29, v6
    v_lshlrev_b32 v52, 16, v34
    buffer_load_dwordx4 v16, s[72:75], s24 offen lds
    s_add_u32 m0, m0, 1024
    s_add_u32 s24, s24, 28672
    s_cmp_eq_u32 m0, s25
    s_nop 0
    s_cselect_b32 s71, 22528, 0
    s_cselect_b32 s27, 630784, 0
    s_sub_u32 m0, m0, s71
    s_sub_u32 s24, s24, s27
    v_and_b32 v53, v29, v34
    v_lshlrev_b32 v46, 16, v7
    v_and_b32 v47, v29, v7
    v_lshlrev_b32 v54, 16, v35
    v_and_b32_e64 v55, v29, v35
    v_pk_add_f32 v[40:41], v[40:41], v[48:49]
    buffer_load_dwordx4 v16, s[72:75], s24 offen lds
    s_add_u32 m0, m0, 1024
    s_add_u32 s24, s24, 28672
    v_pk_add_f32 v[42:43], v[42:43], v[50:51]
    v_pk_add_f32 v[44:45], v[44:45], v[52:53]
    v_pk_add_f32 v[46:47], v[46:47], v[54:55]
    v_cvt_pk_bf16_f32 v80, v40, v41
    v_cvt_pk_bf16_f32 v81, v42, v43
    v_cvt_pk_bf16_f32 v82, v44, v45
    buffer_load_dwordx4 v16, s[72:75], s24 offen lds
    s_add_u32 m0, m0, 1024
    s_add_u32 s24, s24, 28672
    s_cmp_eq_u32 m0, s25
    s_nop 0
    s_cselect_b32 s71, 22528, 0
    s_cselect_b32 s27, 630784, 0
    s_sub_u32 m0, m0, s71
    s_sub_u32 s24, s24, s27
    v_cvt_pk_bf16_f32 v83, v46, v47
    ds_write_b128 v22, v[80:83] offset:0
    v_lshlrev_b32 v40, 16, v8
    v_and_b32 v41, v29, v8
    v_lshlrev_b32 v48, 16, v36
    v_and_b32 v49, v29, v36
    buffer_load_dwordx4 v16, s[72:75], s24 offen lds
    s_add_u32 m0, m0, 1024
    s_add_u32 s24, s24, 28672
    v_lshlrev_b32 v42, 16, v9
    v_and_b32 v43, v29, v9
    v_lshlrev_b32 v50, 16, v37
    v_and_b32 v51, v29, v37
    v_lshlrev_b32 v44, 16, v10
    v_and_b32 v45, v29, v10
    buffer_load_dwordx4 v16, s[72:75], s24 offen lds
    v_lshlrev_b32 v52, 16, v38
    v_and_b32 v53, v29, v38
    v_lshlrev_b32 v46, 16, v11
    v_and_b32 v47, v29, v11
    v_lshlrev_b32 v54, 16, v39
    v_and_b32 v55, v29, v39
    v_pk_add_f32 v[40:41], v[40:41], v[48:49]
    v_pk_add_f32 v[42:43], v[42:43], v[50:51]
    v_pk_add_f32 v[44:45], v[44:45], v[52:53]
    v_pk_add_f32 v[46:47], v[46:47], v[54:55]
    v_cvt_pk_bf16_f32 v84, v40, v41
    v_cvt_pk_bf16_f32 v85, v42, v43
    v_cvt_pk_bf16_f32 v86, v44, v45
    v_cvt_pk_bf16_f32 v87, v46, v47
    ds_write_b128 v22, v[84:87] offset:4096
    v_lshlrev_b32 v64, 16, v80
    v_and_b32 v65, v29, v80
    v_lshlrev_b32 v66, 16, v81
    v_and_b32 v67, v29, v81
    v_lshlrev_b32 v68, 16, v82
    v_and_b32 v69, v29, v82
    v_lshlrev_b32 v70, 16, v83
    v_and_b32 v71, v29, v83
    v_lshlrev_b32 v72, 16, v84
    v_and_b32 v73, v29, v84
    v_lshlrev_b32 v74, 16, v85
    v_and_b32 v75, v29, v85
    v_lshlrev_b32 v76, 16, v86
    v_and_b32 v77, v29, v86
    v_lshlrev_b32 v78, 16, v87
    v_and_b32 v79, v29, v87
    v_lshlrev_b32 v2, 4, v1
    s_lshl_b32 s9, s3, 2
    v_add_u32_e64 v2, s9, v2
    v_mov_b32 v30, 0x3b124925
    v_mov_b32 v31, 0x3727c5ac
    s_waitcnt lgkmcnt(0)
    s_barrier
    ds_read_b32 v40, v2 offset:0
    ds_read_b32 v41, v2 offset:1024
    ds_read_b32 v42, v2 offset:2048
    ds_read_b32 v43, v2 offset:3072
    ds_read_b32 v44, v2 offset:4096
    ds_read_b32 v45, v2 offset:5120
    ds_read_b32 v46, v2 offset:6144
    s_waitcnt lgkmcnt(6)
    v_lshlrev_b32 v88, 16, v40
    v_and_b32 v89, v29, v40
    s_waitcnt lgkmcnt(5)
    v_lshlrev_b32 v90, 16, v41
    v_and_b32 v91, v29, v41
    s_waitcnt lgkmcnt(4)
    v_lshlrev_b32 v92, 16, v42
    v_and_b32 v93, v29, v42
    s_waitcnt lgkmcnt(3)
    v_lshlrev_b32 v94, 16, v43
    v_and_b32 v95, v29, v43
    s_waitcnt lgkmcnt(2)
    v_lshlrev_b32 v96, 16, v44
    v_and_b32 v97, v29, v44
    s_waitcnt lgkmcnt(1)
    v_lshlrev_b32 v98, 16, v45
    v_and_b32 v99, v29, v45
    s_waitcnt lgkmcnt(0)
    v_lshlrev_b32 v100, 16, v46
    v_and_b32_e64 v101, v29, v46
    v_pk_add_f32 v[102:103], v[88:89], v[90:91]
    v_pk_add_f32 v[104:105], v[92:93], v[94:95]
    v_pk_add_f32 v[106:107], v[96:97], v[98:99]
    v_pk_add_f32 v[102:103], v[102:103], v[100:101]
    v_pk_add_f32 v[104:105], v[104:105], v[106:107]
    v_pk_add_f32 v[102:103], v[102:103], v[104:105]
    s_nop 1
    s_nop 0
    v_add_f32_dpp v102, v102, v102 row_shr:1 row_mask:0xf bank_mask:0xf bound_ctrl:0
    v_add_f32_dpp v103, v103, v103 row_shr:1 row_mask:0xf bank_mask:0xf bound_ctrl:0
    s_nop 0
    s_nop 0
    v_add_f32_dpp v102, v102, v102 row_shr:2 row_mask:0xf bank_mask:0xf bound_ctrl:0
    v_add_f32_dpp v103, v103, v103 row_shr:2 row_mask:0xf bank_mask:0xf bound_ctrl:0
    s_nop 0
    s_nop 0
    v_add_f32_dpp v102, v102, v102 row_shr:4 row_mask:0xf bank_mask:0xf bound_ctrl:0
    v_add_f32_dpp v103, v103, v103 row_shr:4 row_mask:0xf bank_mask:0xf bound_ctrl:0
    s_nop 0
    s_nop 0
    v_add_f32_dpp v102, v102, v102 row_shr:8 row_mask:0xf bank_mask:0xf bound_ctrl:0
    v_add_f32_dpp v103, v103, v103 row_shr:8 row_mask:0xf bank_mask:0xf bound_ctrl:0
    s_nop 0
    s_nop 0
    v_add_f32_dpp v102, v102, v102 row_bcast:15 row_mask:0xa bank_mask:0xf
    v_add_f32_dpp v103, v103, v103 row_bcast:15 row_mask:0xa bank_mask:0xf
    s_nop 0
    s_nop 0
    v_add_f32_dpp v102, v102, v102 row_bcast:31 row_mask:0xc bank_mask:0xf
    v_add_f32_dpp v103, v103, v103 row_bcast:31 row_mask:0xc bank_mask:0xf
    v_readlane_b32 s9, v102, 63
    v_readlane_b32 s10, v103, 63
    s_nop 0
    v_mul_f32 v108, s9, v30
    v_mul_f32_e64 v109, s10, v30
    v_pk_add_f32 v[88:89], v[88:89], v[108:109] neg_lo:[0,1] neg_hi:[0,1]
    v_pk_add_f32 v[90:91], v[90:91], v[108:109] neg_lo:[0,1] neg_hi:[0,1]
    v_pk_add_f32 v[92:93], v[92:93], v[108:109] neg_lo:[0,1] neg_hi:[0,1]
    v_pk_add_f32 v[94:95], v[94:95], v[108:109] neg_lo:[0,1] neg_hi:[0,1]
    v_pk_add_f32 v[96:97], v[96:97], v[108:109] neg_lo:[0,1] neg_hi:[0,1]
    v_pk_add_f32 v[98:99], v[98:99], v[108:109] neg_lo:[0,1] neg_hi:[0,1]
    v_pk_add_f32 v[100:101], v[100:101], v[108:109] neg_lo:[0,1] neg_hi:[0,1]
    v_pk_mul_f32 v[102:103], v[88:89], v[88:89]
    v_pk_mul_f32 v[104:105], v[90:91], v[90:91]
    v_pk_fma_f32 v[102:103], v[92:93], v[92:93], v[102:103]
    v_pk_fma_f32 v[104:105], v[94:95], v[94:95], v[104:105]
    v_pk_fma_f32 v[102:103], v[96:97], v[96:97], v[102:103]
    v_pk_fma_f32 v[104:105], v[98:99], v[98:99], v[104:105]
    v_pk_fma_f32 v[102:103], v[100:101], v[100:101], v[102:103]
    v_pk_add_f32 v[102:103], v[102:103], v[104:105]
    s_nop 1
    s_nop 0
    v_add_f32_dpp v102, v102, v102 row_shr:1 row_mask:0xf bank_mask:0xf bound_ctrl:0
    v_add_f32_dpp v103, v103, v103 row_shr:1 row_mask:0xf bank_mask:0xf bound_ctrl:0
    s_nop 0
    s_nop 0
    v_add_f32_dpp v102, v102, v102 row_shr:2 row_mask:0xf bank_mask:0xf bound_ctrl:0
    v_add_f32_dpp v103, v103, v103 row_shr:2 row_mask:0xf bank_mask:0xf bound_ctrl:0
    s_nop 0
    s_nop 0
    v_add_f32_dpp v102, v102, v102 row_shr:4 row_mask:0xf bank_mask:0xf bound_ctrl:0
    v_add_f32_dpp v103, v103, v103 row_shr:4 row_mask:0xf bank_mask:0xf bound_ctrl:0
    s_nop 0
    s_nop 0
    v_add_f32_dpp v102, v102, v102 row_shr:8 row_mask:0xf bank_mask:0xf bound_ctrl:0
    v_add_f32_dpp v103, v103, v103 row_shr:8 row_mask:0xf bank_mask:0xf bound_ctrl:0
    s_nop 0
    s_nop 0
    v_add_f32_dpp v102, v102, v102 row_bcast:15 row_mask:0xa bank_mask:0xf
    v_add_f32_dpp v103, v103, v103 row_bcast:15 row_mask:0xa bank_mask:0xf
    s_nop 0
    s_nop 0
    v_add_f32_dpp v102, v102, v102 row_bcast:31 row_mask:0xc bank_mask:0xf
    v_add_f32_dpp v103, v103, v103 row_bcast:31 row_mask:0xc bank_mask:0xf
    v_readlane_b32 s9, v102, 63
    v_readlane_b32 s10, v103, 63
    s_nop 0
    v_mul_f32 v110, s9, v30
    v_mul_f32 v111, s10, v30
    v_add_f32 v112, v110, v31
    v_add_f32 v113, v111, v31
    v_rsq_f32 v112, v112
    v_rsq_f32 v113, v113
    s_nop 0
    v_pk_mul_f32 v[110:111], v[110:111], v[112:113]
    v_pk_mul_f32 v[110:111], v[110:111], v[112:113]
    v_add_f32 v114, v110, v31
    v_add_f32 v115, v111, v31
    v_rsq_f32 v114, v114
    v_rsq_f32 v115, v115
    s_nop 0
    s_nop 0
    v_pk_mul_f32 v[112:113], v[112:113], v[114:115]
    v_pk_mul_f32 v[108:109], v[108:109], v[112:113] neg_lo:[1,0] neg_hi:[1,0]
    s_lshl_b32 s9, s3, 3
    v_mov_b32 v2, s9
    s_mov_b64 s[10:11], exec
    s_mov_b64 exec, 1
    ds_write_b64 v2, v[112:113] offset:8192
    ds_write_b64 v2, v[108:109] offset:8224
    s_mov_b64 exec, s[10:11]
    v_mov_b32 v2, 0
    s_waitcnt lgkmcnt(0)
    s_barrier
    ds_read_b128 v[88:91], v2 offset:8192
    ds_read_b128 v[96:99], v2 offset:8224
    ds_read_b128 v[92:95], v2 offset:8208
    ds_read_b128 v[100:103], v2 offset:8240
    s_lshl_b32 s9, s6, 9
    s_add_u32 s9, s9, 5242880
    s_waitcnt lgkmcnt(0)
    v_pk_fma_f32 v[64:65], v[64:65], v[88:89], v[96:97]
    v_pk_fma_f32 v[66:67], v[66:67], v[90:91], v[98:99]
    v_pk_fma_f32 v[68:69], v[68:69], v[92:93], v[100:101]
    v_pk_fma_f32 v[70:71], v[70:71], v[94:95], v[102:103]
    v_cvt_pk_bf16_f32 v104, v64, v65
    v_cvt_pk_bf16_f32 v105, v66, v67
    v_cvt_pk_bf16_f32 v106, v68, v69
    v_cvt_pk_bf16_f32 v107, v70, v71
    buffer_store_dwordx4 v[104:107], v20, s[52:55], s9 offen sc1
    v_pk_fma_f32 v[72:73], v[72:73], v[88:89], v[96:97]
    v_pk_fma_f32 v[74:75], v[74:75], v[90:91], v[98:99]
    v_pk_fma_f32 v[76:77], v[76:77], v[92:93], v[100:101]
    v_pk_fma_f32 v[78:79], v[78:79], v[94:95], v[102:103]
    v_cvt_pk_bf16_f32 v108, v72, v73
    v_cvt_pk_bf16_f32 v109, v74, v75
    v_cvt_pk_bf16_f32 v110, v76, v77
    v_cvt_pk_bf16_f32 v111, v78, v79
    buffer_store_dwordx4 v[108:111], v21, s[52:55], s9 offen sc1
    v_bfe_u32 v2, v1, 2, 2
    v_bfe_u32 v3, v1, 1, 1
    v_lshl_add_u32 v2, v3, 3, v2
    v_lshrrev_b32 v3, 4, v1
    v_lshl_add_u32 v2, v3, 4, v2
    v_lshlrev_b32 v2, 4, v2
    v_and_b32 v3, 1, v1
    v_lshl_add_u32 v2, v3, 3, v2
    s_lshl_b32 s9, s3, 10
    v_add_u32 v2, s9, v2
    v_lshrrev_b32 v3, 5, v1
    v_lshlrev_b32_e64 v28, 17, v3
    v_bfe_u32 v3, v1, 3, 2
    v_lshl_add_u32 v28, v3, 15, v28
    v_and_b32 v3, 7, v1
    v_lshl_add_u32 v28, v3, 4, v28
    s_lshl_b32 s9, s3, 18
    s_lshl_b32 s10, s6, 7
    s_add_u32 s9, s9, s10
    s_add_u32 s9, s9, 7340032
    s_add_u32 s10, s9, 1048576
    s_cmp_eq_u32 s3, 3
    s_nop 0
    s_cselect_b32 s10, 16777216, s10
    ds_read_b64_tr_b16 v[40:41], v2 offset:0
    ds_read_b64_tr_b16 v[42:43], v2 offset:64
    ds_read_b64_tr_b16 v[44:45], v2 offset:4096
    ds_read_b64_tr_b16 v[46:47], v2 offset:4160
    s_waitcnt lgkmcnt(0)
    s_nop 0
    buffer_store_dwordx4 v[40:43], v28, s[52:55], s9 offen sc1
    buffer_store_dwordx4 v[44:47], v28, s[52:55], s10 offen sc1
    s_waitcnt vmcnt(4)
    s_nop 0
    ds_read_b64_tr_b16 a[88:89], v14 offset:0
    ds_read_b64_tr_b16 a[90:91], v14 offset:512
    ds_read_b64_tr_b16 a[92:93], v15 offset:0
    ds_read_b64_tr_b16 a[94:95], v15 offset:512
    ds_read_b64_tr_b16 a[96:97], v14 offset:2048
    ds_read_b64_tr_b16 a[98:99], v14 offset:2560
    ds_read_b64_tr_b16 a[100:101], v15 offset:2048
    ds_read_b64_tr_b16 a[102:103], v15 offset:2560
    ds_read_b64_tr_b16 a[104:105], v14 offset:4096
    ds_read_b64_tr_b16 a[106:107], v14 offset:4608
    ds_read_b64_tr_b16 a[108:109], v15 offset:4096
    ds_read_b64_tr_b16 a[110:111], v15 offset:4608
    ds_read_b64_tr_b16 a[112:113], v14 offset:6144
    ds_read_b64_tr_b16 a[114:115], v14 offset:6656
    ds_read_b64_tr_b16 a[116:117], v15 offset:6144
    ds_read_b64_tr_b16 a[118:119], v15 offset:6656
    ds_read_b64_tr_b16 a[120:121], v14 offset:8192
    ds_read_b64_tr_b16 a[122:123], v14 offset:8704
    ds_read_b64_tr_b16 a[124:125], v15 offset:8192
    ds_read_b64_tr_b16 a[126:127], v15 offset:8704
    ds_read_b64_tr_b16 a[128:129], v14 offset:10240
    ds_read_b64_tr_b16 a[130:131], v14 offset:10752
    ds_read_b64_tr_b16 a[132:133], v15 offset:10240
    ds_read_b64_tr_b16 a[134:135], v15 offset:10752
    ds_read_b64_tr_b16 a[136:137], v14 offset:12288
    ds_read_b64_tr_b16 a[138:139], v14 offset:12800
    ds_read_b64_tr_b16 a[140:141], v15 offset:12288
    ds_read_b64_tr_b16 a[142:143], v15 offset:12800
    ds_read_b64_tr_b16 a[144:145], v14 offset:14336
    ds_read_b64_tr_b16 a[146:147], v14 offset:14848
    ds_read_b64_tr_b16 a[148:149], v15 offset:14336
    ds_read_b64_tr_b16 a[150:151], v15 offset:14848
    ds_read_b64_tr_b16 a[152:153], v14 offset:16384
    ds_read_b64_tr_b16 a[154:155], v14 offset:16896
    ds_read_b64_tr_b16 a[156:157], v15 offset:16384
    ds_read_b64_tr_b16 a[158:159], v15 offset:16896
    ds_read_b64_tr_b16 a[160:161], v14 offset:18432
    ds_read_b64_tr_b16 a[162:163], v14 offset:18944
    ds_read_b64_tr_b16 a[164:165], v15 offset:18432
    ds_read_b64_tr_b16 a[166:167], v15 offset:18944
    ds_read_b64_tr_b16 a[168:169], v14 offset:20480
    ds_read_b64_tr_b16 a[170:171], v14 offset:20992
    ds_read_b64_tr_b16 a[172:173], v15 offset:20480
    ds_read_b64_tr_b16 a[174:175], v15 offset:20992
    s_waitcnt lgkmcnt(0)
    s_mul_i32 s24, s3, 1835008
    s_lshl_b32 s27, s17, 7
    s_add_u32 s24, s24, s27
    s_nop 0
    s_add_u32 s24, s24, 1261568
    s_mul_i32 s27, s3, 22528
    s_add_u32 s27, s27, 73728
    s_add_u32 s25, s27, 20480
    s_mul_i32 s71, s22, 57344
    s_add_u32 s24, s24, s71
    s_lshl_b32 s71, s22, 11
    s_add_u32 m0, s27, s71
    s_nop 0
    buffer_load_dwordx4 v16, s[72:75], s24 offen lds
    s_add_u32 m0, m0, 1024
    s_add_u32 s24, s24, 28672
    buffer_load_dwordx4 v16, s[72:75], s24 offen lds
    s_add_u32 m0, m0, 1024
    s_add_u32 s24, s24, 28672
    s_cmp_eq_u32 m0, s25
    s_nop 0
    s_cselect_b32 s71, 20480, 0
    s_cselect_b32 s27, 573440, 0
    s_sub_u32 m0, m0, s71
    s_sub_u32 s24, s24, s27
    buffer_load_dwordx4 v16, s[72:75], s24 offen lds
    s_add_u32 m0, m0, 1024
    s_add_u32 s24, s24, 28672
    buffer_load_dwordx4 v16, s[72:75], s24 offen lds
    s_add_u32 m0, m0, 1024
    s_add_u32 s24, s24, 28672
    s_cmp_eq_u32 m0, s25
    s_nop 0
    s_cselect_b32 s71, 20480, 0
    s_cselect_b32 s27, 573440, 0
    s_sub_u32 m0, m0, s71
    s_sub_u32 s24, s24, s27
    buffer_load_dwordx4 v16, s[72:75], s24 offen lds
    s_add_u32 m0, m0, 1024
    s_add_u32 s24, s24, 28672
    buffer_load_dwordx4 v16, s[72:75], s24 offen lds
    s_add_u32 m0, m0, 1024
    s_add_u32 s24, s24, 28672
    s_cmp_eq_u32 m0, s25
    s_nop 0
    s_cselect_b32 s71, 20480, 0
    s_cselect_b32 s27, 573440, 0
    s_sub_u32 m0, m0, s71
    s_sub_u32 s24, s24, s27
    buffer_load_dwordx4 v16, s[72:75], s24 offen lds
    s_add_u32 m0, m0, 1024
    s_add_u32 s24, s24, 28672
    buffer_load_dwordx4 v16, s[72:75], s24 offen lds
    s_add_u32 m0, m0, 1024
    s_add_u32 s24, s24, 28672
    s_cmp_eq_u32 m0, s25
    s_nop 0
    s_cselect_b32 s71, 20480, 0
    s_cselect_b32 s27, 573440, 0
    s_sub_u32 m0, m0, s71
    s_sub_u32 s24, s24, s27
    buffer_load_dwordx4 v16, s[72:75], s24 offen lds
    s_add_u32 m0, m0, 1024
    s_add_u32 s24, s24, 28672
    buffer_load_dwordx4 v16, s[72:75], s24 offen lds
    s_add_u32 m0, m0, 1024
    s_add_u32 s24, s24, 28672
    s_cmp_eq_u32 m0, s25
    s_nop 0
    s_cselect_b32 s71, 20480, 0
    s_cselect_b32 s27, 573440, 0
    s_sub_u32 m0, m0, s71
    s_sub_u32 s24, s24, s27
    buffer_load_dwordx4 v16, s[72:75], s24 offen lds
    s_add_u32 m0, m0, 1024
    s_add_u32 s24, s24, 28672
    buffer_load_dwordx4 v16, s[72:75], s24 offen lds
    s_add_u32 m0, m0, 1024
    s_add_u32 s24, s24, 28672
    s_cmp_eq_u32 m0, s25
    s_nop 0
    s_cselect_b32 s71, 20480, 0
    s_cselect_b32 s27, 573440, 0
    s_sub_u32 m0, m0, s71
    s_sub_u32 s24, s24, s27
    buffer_load_dwordx4 v16, s[72:75], s24 offen lds
    s_add_u32 m0, m0, 1024
    s_add_u32 s24, s24, 28672
    buffer_load_dwordx4 v16, s[72:75], s24 offen lds
    s_add_u32 m0, m0, 1024
    s_add_u32 s24, s24, 28672
    s_cmp_eq_u32 m0, s25
    s_nop 0
    s_cselect_b32 s71, 20480, 0
    s_cselect_b32 s27, 573440, 0
    s_sub_u32 m0, m0, s71
    s_sub_u32 s24, s24, s27
    buffer_load_dwordx4 v16, s[72:75], s24 offen lds
    s_add_u32 m0, m0, 1024
    s_add_u32 s24, s24, 28672
    buffer_load_dwordx4 v16, s[72:75], s24 offen lds
    s_add_u32 m0, m0, 1024
    s_add_u32 s24, s24, 28672
    s_cmp_eq_u32 m0, s25
    s_nop 0
    s_cselect_b32 s71, 20480, 0
    s_cselect_b32 s27, 573440, 0
    s_sub_u32 m0, m0, s71
    s_sub_u32 s24, s24, s27
    buffer_load_dwordx4 v16, s[72:75], s24 offen lds
    s_add_u32 m0, m0, 1024
    s_add_u32 s24, s24, 28672
    buffer_load_dwordx4 v16, s[72:75], s24 offen lds
    s_add_u32 m0, m0, 1024
    s_add_u32 s24, s24, 28672
    s_cmp_eq_u32 m0, s25
    s_nop 0
    s_cselect_b32 s71, 20480, 0
    s_cselect_b32 s27, 573440, 0
    s_sub_u32 m0, m0, s71
    s_sub_u32 s24, s24, s27
    buffer_load_dwordx4 v16, s[72:75], s24 offen lds
    s_add_u32 m0, m0, 1024
    s_add_u32 s24, s24, 28672
    buffer_load_dwordx4 v16, s[72:75], s24 offen lds
    s_cmp_eq_u32 s18, 0
    s_cbranch_scc1 L_nog1
    v_lshrrev_b32_e64 v2, 3, v1
    v_mul_u32_u24 v2, 4096, v2
    v_bfe_u32 v3, v1, 4, 1
    v_lshlrev_b32 v3, 2, v3
    v_and_b32 v240, 7, v1
    v_xor_b32_e64 v240, v240, v3
    v_lshl_add_u32 v240, v240, 4, v2
    v_bfe_u32 v2, v1, 2, 2
    v_lshrrev_b32 v3, 5, v1
    v_lshl_add_u32 v3, v3, 2, v2
    v_lshlrev_b32 v3, 7, v3
    v_lshrrev_b32_e64 v2, 1, v2
    v_lshl_add_u32 v3, v2, 6, v3
    v_bfe_u32 v2, v1, 4, 1
    v_lshl_add_u32 v3, v2, 5, v3
    v_and_b32_e64 v2, 3, v1
    v_lshl_add_u32 v3, v2, 3, v3
    s_mul_i32 s9, s3, 28672
    s_add_u32 s9, s9, 49152
    v_add_u32 v241, s9, v3
    v_xor_b32 v242, 64, v241
    s_mul_i32 s9, s3, 12288
    v_add_u32 v243, s9, v3
    v_xor_b32 v229, 64, v243
    v_lshlrev_b32_e64 v12, 4, v1
    v_add_u32 v13, 131072, v12
    s_mul_i32 s26, s16, 262144
    s_mul_i32 s27, s3, 32768
    s_add_u32 s26, s26, s27
    s_add_u32 s26, s26, 5242880
    s_mov_b32 s28, s26
    s_mov_b32 s56, s34
    s_mov_b32 s57, s35
    s_mov_b32 s58, 3584
    s_mov_b32 s59, 0x20000
    v_lshrrev_b32 v2, 5, v1
    v_lshlrev_b32 v2, 3, v2
    s_lshl_b32 s9, s17, 7
    s_lshr_b32 s10, s3, 1
    s_lshl_b32 s10, s10, 6
    s_add_u32 s9, s9, s10
    buffer_load_dwordx2 v[20:21], v2, s[56:59], s9 offen offset:0
    buffer_load_dwordx2 v[22:23], v2, s[56:59], s9 offen offset:16
    buffer_load_dwordx2 v[24:25], v2, s[56:59], s9 offen offset:32
    buffer_load_dwordx2 v[26:27], v2, s[56:59], s9 offen offset:48
    s_mov_b32 s12, 0
L_g1_spin:
    s_mov_b32 s26, s28
    buffer_load_dwordx4 v[32:35], v12, s[52:55], s26 offen offset:0 sc1
    buffer_load_dwordx4 v[36:39], v13, s[52:55], s26 offen offset:0 sc1
    buffer_load_dwordx4 v[40:43], v12, s[52:55], s26 offen offset:1024 sc1
    buffer_load_dwordx4 v[44:47], v13, s[52:55], s26 offen offset:1024 sc1
    buffer_load_dwordx4 v[48:51], v12, s[52:55], s26 offen offset:2048 sc1
    buffer_load_dwordx4 v[52:55], v13, s[52:55], s26 offen offset:2048 sc1
    buffer_load_dwordx4 v[56:59], v12, s[52:55], s26 offen offset:3072 sc1
    buffer_load_dwordx4 v[60:63], v13, s[52:55], s26 offen offset:3072 sc1
    s_add_u32 s26, s26, 4096
    buffer_load_dwordx4 v[64:67], v12, s[52:55], s26 offen offset:0 sc1
    buffer_load_dwordx4 v[68:71], v13, s[52:55], s26 offen offset:0 sc1
    buffer_load_dwordx4 v[72:75], v12, s[52:55], s26 offen offset:1024 sc1
    buffer_load_dwordx4 v[76:79], v13, s[52:55], s26 offen offset:1024 sc1
    s_waitcnt vmcnt(0)
    s_nop 0
    v_max3_u32 v2, v32, v33, v34
    v_max3_u32 v2, v2, v35, v36
    v_max3_u32 v2, v2, v37, v38
    v_max3_u32 v2, v2, v39, v40
    v_max3_u32 v2, v2, v41, v42
    v_max3_u32 v2, v2, v43, v44
    v_max3_u32 v2, v2, v45, v46
    v_max3_u32 v2, v2, v47, v48
    v_max3_u32 v2, v2, v49, v50
    v_max3_u32 v2, v2, v51, v52
    v_max3_u32 v2, v2, v53, v54
    v_max3_u32 v2, v2, v55, v56
    v_max3_u32 v2, v2, v57, v58
    v_max3_u32 v2, v2, v59, v60
    v_max3_u32 v2, v2, v61, v62
    v_max3_u32 v2, v2, v63, v64
    v_max3_u32 v2, v2, v65, v66
    v_max3_u32 v2, v2, v67, v68
    v_max3_u32 v2, v2, v69, v70
    v_max3_u32 v2, v2, v71, v72
    v_max3_u32 v2, v2, v73, v74
    v_max3_u32 v2, v2, v75, v76
    v_max3_u32 v2, v2, v77, v78
    v_max_u32 v2, v2, v79
    v_cmp_eq_u32 vcc, -1, v2
    s_cbranch_vccz L_g1_go
L_g1_gate:
    s_add_u32 s12, s12, 1
    s_cmp_gt_u32 s12, 131072
    s_cbranch_scc1 L_g1_go
    buffer_load_dwordx4 v[32:35], v12, s[52:55], s28 offen sc1
    s_waitcnt vmcnt(0)
    v_max3_u32 v2, v32, v33, v34
    v_max_u32 v2, v2, v35
    v_cmp_eq_u32 vcc, -1, v2
    s_cbranch_vccnz L_g1_gate
    s_branch L_g1_spin
L_g1_go:
    v_mfma_f32_32x32x16_bf16 v[128:143], a[0:3], v[32:35], 0
    ds_read_b64_tr_b16 a[176:177], v14 offset:0
    v_mfma_f32_32x32x16_bf16 v[144:159], a[0:3], v[36:39], 0
    ds_read_b64_tr_b16 a[178:179], v14 offset:512
    v_mfma_f32_32x32x16_bf16 v[160:175], a[4:7], v[32:35], 0
    ds_read_b64_tr_b16 a[180:181], v15 offset:0
    v_mfma_f32_32x32x16_bf16 v[176:191], a[4:7], v[36:39], 0
    ds_read_b64_tr_b16 a[182:183], v15 offset:512
    buffer_load_dwordx4 v[32:35], v12, s[52:55], s26 offen offset:2048 sc1
    buffer_load_dwordx4 v[36:39], v13, s[52:55], s26 offen offset:2048 sc1
    v_mfma_f32_32x32x16_bf16 v[128:143], a[8:11], v[40:43], v[128:143]
    ds_read_b64_tr_b16 a[184:185], v14 offset:2048
    v_mfma_f32_32x32x16_bf16 v[144:159], a[8:11], v[44:47], v[144:159]
    ds_read_b64_tr_b16 a[186:187], v14 offset:2560
    v_mfma_f32_32x32x16_bf16 v[160:175], a[12:15], v[40:43], v[160:175]
    ds_read_b64_tr_b16 a[188:189], v15 offset:2048
    v_mfma_f32_32x32x16_bf16 v[176:191], a[12:15], v[44:47], v[176:191]
    ds_read_b64_tr_b16 a[190:191], v15 offset:2560
    buffer_load_dwordx4 v[40:43], v12, s[52:55], s26 offen offset:3072 sc1
    buffer_load_dwordx4 v[44:47], v13, s[52:55], s26 offen offset:3072 sc1
    s_add_u32 s26, s26, 4096
    v_mfma_f32_32x32x16_bf16 v[128:143], a[16:19], v[48:51], v[128:143]
    ds_read_b64_tr_b16 a[192:193], v14 offset:4096
    v_mfma_f32_32x32x16_bf16 v[144:159], a[16:19], v[52:55], v[144:159]
    ds_read_b64_tr_b16 a[194:195], v14 offset:4608
    v_mfma_f32_32x32x16_bf16 v[160:175], a[20:23], v[48:51], v[160:175]
    ds_read_b64_tr_b16 a[196:197], v15 offset:4096
    v_mfma_f32_32x32x16_bf16 v[176:191], a[20:23], v[52:55], v[176:191]
    ds_read_b64_tr_b16 a[198:199], v15 offset:4608
    buffer_load_dwordx4 v[48:51], v12, s[52:55], s26 offen offset:0 sc1
    buffer_load_dwordx4 v[52:55], v13, s[52:55], s26 offen offset:0 sc1
    v_mfma_f32_32x32x16_bf16 v[128:143], a[24:27], v[56:59], v[128:143]
    ds_read_b64_tr_b16 a[200:201], v14 offset:6144
    v_mfma_f32_32x32x16_bf16 v[144:159], a[24:27], v[60:63], v[144:159]
    ds_read_b64_tr_b16 a[202:203], v14 offset:6656
    v_mfma_f32_32x32x16_bf16 v[160:175], a[28:31], v[56:59], v[160:175]
    ds_read_b64_tr_b16 a[204:205], v15 offset:6144
    v_mfma_f32_32x32x16_bf16 v[176:191], a[28:31], v[60:63], v[176:191]
    ds_read_b64_tr_b16 a[206:207], v15 offset:6656
    buffer_load_dwordx4 v[56:59], v12, s[52:55], s26 offen offset:1024 sc1
    buffer_load_dwordx4 v[60:63], v13, s[52:55], s26 offen offset:1024 sc1
    v_mfma_f32_32x32x16_bf16 v[128:143], a[32:35], v[64:67], v[128:143]
    ds_read_b64_tr_b16 a[208:209], v14 offset:8192
    v_mfma_f32_32x32x16_bf16 v[144:159], a[32:35], v[68:71], v[144:159]
    ds_read_b64_tr_b16 a[210:211], v14 offset:8704
    v_mfma_f32_32x32x16_bf16 v[160:175], a[36:39], v[64:67], v[160:175]
    ds_read_b64_tr_b16 a[212:213], v15 offset:8192
    v_mfma_f32_32x32x16_bf16 v[176:191], a[36:39], v[68:71], v[176:191]
    ds_read_b64_tr_b16 a[214:215], v15 offset:8704
    buffer_load_dwordx4 v[64:67], v12, s[52:55], s26 offen offset:2048 sc1
    buffer_load_dwordx4 v[68:71], v13, s[52:55], s26 offen offset:2048 sc1
    v_mfma_f32_32x32x16_bf16 v[128:143], a[40:43], v[72:75], v[128:143]
    ds_read_b64_tr_b16 a[216:217], v14 offset:10240
    s_waitcnt vmcnt(8)
    s_nop 0
    v_mfma_f32_32x32x16_bf16 v[144:159], a[40:43], v[76:79], v[144:159]
    ds_read_b64_tr_b16 a[218:219], v14 offset:10752
    v_max3_u32 v2, v32, v33, v34
    v_max3_u32 v3, v35, v36, v37
    v_mfma_f32_32x32x16_bf16 v[160:175], a[44:47], v[72:75], v[160:175]
    ds_read_b64_tr_b16 a[220:221], v15 offset:10240
    v_max3_u32 v2, v2, v38, v39
    v_max_u32 v2, v2, v3
    v_cmp_eq_u32 vcc, -1, v2
    v_mfma_f32_32x32x16_bf16 v[176:191], a[44:47], v[76:79], v[176:191]
    ds_read_b64_tr_b16 a[222:223], v15 offset:10752
    buffer_load_dwordx4 v[72:75], v12, s[52:55], s26 offen offset:3072 sc1
    buffer_load_dwordx4 v[76:79], v13, s[52:55], s26 offen offset:3072 sc1
    s_add_u32 s26, s26, 4096
    s_cbranch_vccnz L_g1_slow6
L_g1_back6:
    s_nop 0
    v_mfma_f32_32x32x16_bf16 v[128:143], a[48:51], v[32:35], v[128:143]
    ds_read_b64_tr_b16 a[224:225], v14 offset:12288
    s_waitcnt vmcnt(8)
    s_nop 0
    v_mfma_f32_32x32x16_bf16 v[144:159], a[48:51], v[36:39], v[144:159]
    ds_read_b64_tr_b16 a[226:227], v14 offset:12800
    v_max3_u32 v2, v40, v41, v42
    v_max3_u32 v3, v43, v44, v45
    v_mfma_f32_32x32x16_bf16 v[160:175], a[52:55], v[32:35], v[160:175]
    ds_read_b64_tr_b16 a[228:229], v15 offset:12288
    v_max3_u32 v2, v2, v46, v47
    v_max_u32 v2, v2, v3
    v_cmp_eq_u32 vcc, -1, v2
    v_mfma_f32_32x32x16_bf16 v[176:191], a[52:55], v[36:39], v[176:191]
    ds_read_b64_tr_b16 a[230:231], v15 offset:12800
    buffer_load_dwordx4 v[32:35], v12, s[52:55], s26 offen offset:0 sc1
    buffer_load_dwordx4 v[36:39], v13, s[52:55], s26 offen offset:0 sc1
    s_cbranch_vccnz L_g1_slow7
L_g1_back7:
    s_nop 0
    v_mfma_f32_32x32x16_bf16 v[128:143], a[56:59], v[40:43], v[128:143]
    ds_read_b64_tr_b16 a[232:233], v14 offset:14336
    s_waitcnt vmcnt(8)
    s_nop 0
    v_mfma_f32_32x32x16_bf16 v[144:159], a[56:59], v[44:47], v[144:159]
    ds_read_b64_tr_b16 a[234:235], v14 offset:14848
    v_max3_u32 v2, v48, v49, v50
    v_max3_u32 v3, v51, v52, v53
    v_mfma_f32_32x32x16_bf16 v[160:175], a[60:63], v[40:43], v[160:175]
    ds_read_b64_tr_b16 a[236:237], v15 offset:14336
    v_max3_u32 v2, v2, v54, v55
    v_max_u32 v2, v2, v3
    v_cmp_eq_u32 vcc, -1, v2
    v_mfma_f32_32x32x16_bf16 v[176:191], a[60:63], v[44:47], v[176:191]
    ds_read_b64_tr_b16 a[238:239], v15 offset:14848
    buffer_load_dwordx4 v[40:43], v12, s[52:55], s26 offen offset:1024 sc1
    buffer_load_dwordx4 v[44:47], v13, s[52:55], s26 offen offset:1024 sc1
    s_cbranch_vccnz L_g1_slow8
L_g1_back8:
    s_nop 0
    v_mfma_f32_32x32x16_bf16 v[128:143], a[64:67], v[48:51], v[128:143]
    ds_read_b64_tr_b16 a[240:241], v14 offset:16384
    s_waitcnt vmcnt(8)
    s_nop 0
    v_mfma_f32_32x32x16_bf16 v[144:159], a[64:67], v[52:55], v[144:159]
    ds_read_b64_tr_b16 a[242:243], v14 offset:16896
    v_max3_u32 v2, v56, v57, v58
    v_max3_u32 v3, v59, v60, v61
    v_mfma_f32_32x32x16_bf16 v[160:175], a[68:71], v[48:51], v[160:175]
    ds_read_b64_tr_b16 a[244:245], v15 offset:16384
    v_max3_u32 v2, v2, v62, v63
    v_max_u32 v2, v2, v3
    v_cmp_eq_u32 vcc, -1, v2
    v_mfma_f32_32x32x16_bf16 v[176:191], a[68:71], v[52:55], v[176:191]
    ds_read_b64_tr_b16 a[246:247], v15 offset:16896
    buffer_load_dwordx4 v[48:51], v12, s[52:55], s26 offen offset:2048 sc1
    buffer_load_dwordx4 v[52:55], v13, s[52:55], s26 offen offset:2048 sc1
    s_cbranch_vccnz L_g1_slow9
L_g1_back9:
    s_nop 0
    v_mfma_f32_32x32x16_bf16 v[128:143], a[72:75], v[56:59], v[128:143]
    ds_read_b64_tr_b16 a[248:249], v14 offset:18432
    s_waitcnt vmcnt(8)
    s_nop 0
    v_mfma_f32_32x32x16_bf16 v[144:159], a[72:75], v[60:63], v[144:159]
    ds_read_b64_tr_b16 a[250:251], v14 offset:18944
    v_max3_u32 v2, v64, v65, v66
    v_max3_u32 v3, v67, v68, v69
    v_mfma_f32_32x32x16_bf16 v[160:175], a[76:79], v[56:59], v[160:175]
    ds_read_b64_tr_b16 a[252:253], v15 offset:18432
    v_max3_u32 v2, v2, v70, v71
    v_max_u32 v2, v2, v3
    v_cmp_eq_u32 vcc, -1, v2
    v_mfma_f32_32x32x16_bf16 v[176:191], a[76:79], v[60:63], v[176:191]
    ds_read_b64_tr_b16 a[254:255], v15 offset:18944
    buffer_load_dwordx4 v[56:59], v12, s[52:55], s26 offen offset:3072 sc1
    buffer_load_dwordx4 v[60:63], v13, s[52:55], s26 offen offset:3072 sc1
    s_add_u32 s26, s26, 4096
    s_cbranch_vccnz L_g1_slow10
L_g1_back10:
    v_mfma_f32_32x32x16_bf16 v[128:143], a[80:83], v[64:67], v[128:143]
    s_waitcnt vmcnt(8)
    v_mfma_f32_32x32x16_bf16 v[144:159], a[80:83], v[68:71], v[144:159]
    v_max3_u32 v2, v72, v73, v74
    v_max3_u32 v3, v75, v76, v77
    v_mfma_f32_32x32x16_bf16 v[160:175], a[84:87], v[64:67], v[160:175]
    v_max3_u32 v2, v2, v78, v79
    v_max_u32 v2, v2, v3
    v_cmp_eq_u32 vcc, -1, v2
    v_mfma_f32_32x32x16_bf16 v[176:191], a[84:87], v[68:71], v[176:191]
    buffer_load_dwordx4 v[64:67], v12, s[52:55], s26 offen offset:0 sc1
    buffer_load_dwordx4 v[68:71], v13, s[52:55], s26 offen offset:0 sc1
    s_cbranch_vccnz L_g1_slow11
L_g1_back11:
    v_mfma_f32_32x32x16_bf16 v[128:143], a[88:91], v[72:75], v[128:143]
    s_waitcnt vmcnt(8)
    v_mfma_f32_32x32x16_bf16 v[144:159], a[88:91], v[76:79], v[144:159]
    v_max3_u32 v2, v32, v33, v34
    v_max3_u32 v3, v35, v36, v37
    v_mfma_f32_32x32x16_bf16 v[160:175], a[92:95], v[72:75], v[160:175]
    v_max3_u32 v2, v2, v38, v39
    v_max_u32 v2, v2, v3
    v_cmp_eq_u32 vcc, -1, v2
    v_mfma_f32_32x32x16_bf16 v[176:191], a[92:95], v[76:79], v[176:191]
    buffer_load_dwordx4 v[72:75], v12, s[52:55], s26 offen offset:1024 sc1
    buffer_load_dwordx4 v[76:79], v13, s[52:55], s26 offen offset:1024 sc1
    s_cbranch_vccnz L_g1_slow12
L_g1_back12:
    v_mfma_f32_32x32x16_bf16 v[128:143], a[96:99], v[32:35], v[128:143]
    s_waitcnt vmcnt(8)
    v_mfma_f32_32x32x16_bf16 v[144:159], a[96:99], v[36:39], v[144:159]
    v_max3_u32 v2, v40, v41, v42
    v_max3_u32 v3, v43, v44, v45
    v_mfma_f32_32x32x16_bf16 v[160:175], a[100:103], v[32:35], v[160:175]
    v_max3_u32 v2, v2, v46, v47
    v_max_u32 v2, v2, v3
    v_cmp_eq_u32 vcc, -1, v2
    v_mfma_f32_32x32x16_bf16 v[176:191], a[100:103], v[36:39], v[176:191]
    buffer_load_dwordx4 v[32:35], v12, s[52:55], s26 offen offset:2048 sc1
    buffer_load_dwordx4 v[36:39], v13, s[52:55], s26 offen offset:2048 sc1
    s_cbranch_vccnz L_g1_slow13
L_g1_back13:
    v_mfma_f32_32x32x16_bf16 v[128:143], a[104:107], v[40:43], v[128:143]
    s_waitcnt vmcnt(8)
    v_mfma_f32_32x32x16_bf16 v[144:159], a[104:107], v[44:47], v[144:159]
    v_max3_u32 v2, v48, v49, v50
    v_max3_u32 v3, v51, v52, v53
    v_mfma_f32_32x32x16_bf16 v[160:175], a[108:111], v[40:43], v[160:175]
    v_max3_u32 v2, v2, v54, v55
    v_max_u32 v2, v2, v3
    v_cmp_eq_u32 vcc, -1, v2
    v_mfma_f32_32x32x16_bf16 v[176:191], a[108:111], v[44:47], v[176:191]
    buffer_load_dwordx4 v[40:43], v12, s[52:55], s26 offen offset:3072 sc1
    buffer_load_dwordx4 v[44:47], v13, s[52:55], s26 offen offset:3072 sc1
    s_add_u32 s26, s26, 4096
    s_cbranch_vccnz L_g1_slow14
L_g1_back14:
    v_mfma_f32_32x32x16_bf16 v[128:143], a[112:115], v[48:51], v[128:143]
    s_waitcnt vmcnt(8)
    v_mfma_f32_32x32x16_bf16 v[144:159], a[112:115], v[52:55], v[144:159]
    v_max3_u32 v2, v56, v57, v58
    v_max3_u32 v3, v59, v60, v61
    v_mfma_f32_32x32x16_bf16 v[160:175], a[116:119], v[48:51], v[160:175]
    v_max3_u32 v2, v2, v62, v63
    v_max_u32 v2, v2, v3
    v_cmp_eq_u32 vcc, -1, v2
    v_mfma_f32_32x32x16_bf16 v[176:191], a[116:119], v[52:55], v[176:191]
    buffer_load_dwordx4 v[48:51], v12, s[52:55], s26 offen offset:0 sc1
    buffer_load_dwordx4 v[52:55], v13, s[52:55], s26 offen offset:0 sc1
    s_cbranch_vccnz L_g1_slow15
L_g1_back15:
    v_mfma_f32_32x32x16_bf16 v[128:143], a[120:123], v[56:59], v[128:143]
    s_waitcnt vmcnt(8)
    v_mfma_f32_32x32x16_bf16 v[144:159], a[120:123], v[60:63], v[144:159]
    v_max3_u32 v2, v64, v65, v66
    v_max3_u32 v3, v67, v68, v69
    v_mfma_f32_32x32x16_bf16 v[160:175], a[124:127], v[56:59], v[160:175]
    v_max3_u32 v2, v2, v70, v71
    v_max_u32 v2, v2, v3
    v_cmp_eq_u32 vcc, -1, v2
    v_mfma_f32_32x32x16_bf16 v[176:191], a[124:127], v[60:63], v[176:191]
    buffer_load_dwordx4 v[56:59], v12, s[52:55], s26 offen offset:1024 sc1
    buffer_load_dwordx4 v[60:63], v13, s[52:55], s26 offen offset:1024 sc1
    s_cbranch_vccnz L_g1_slow16
L_g1_back16:
    v_mfma_f32_32x32x16_bf16 v[128:143], a[128:131], v[64:67], v[128:143]
    s_waitcnt vmcnt(8)
    v_mfma_f32_32x32x16_bf16 v[144:159], a[128:131], v[68:71], v[144:159]
    v_max3_u32 v2, v72, v73, v74
    v_max3_u32 v3, v75, v76, v77
    v_mfma_f32_32x32x16_bf16 v[160:175], a[132:135], v[64:67], v[160:175]
    v_max3_u32 v2, v2, v78, v79
    v_max_u32 v2, v2, v3
    v_cmp_eq_u32 vcc, -1, v2
    v_mfma_f32_32x32x16_bf16 v[176:191], a[132:135], v[68:71], v[176:191]
    buffer_load_dwordx4 v[64:67], v12, s[52:55], s26 offen offset:2048 sc1
    buffer_load_dwordx4 v[68:71], v13, s[52:55], s26 offen offset:2048 sc1
    s_cbranch_vccnz L_g1_slow17
L_g1_back17:
    v_mfma_f32_32x32x16_bf16 v[128:143], a[136:139], v[72:75], v[128:143]
    s_waitcnt vmcnt(8)
    v_mfma_f32_32x32x16_bf16 v[144:159], a[136:139], v[76:79], v[144:159]
    v_max3_u32 v2, v32, v33, v34
    v_max3_u32 v3, v35, v36, v37
    v_mfma_f32_32x32x16_bf16 v[160:175], a[140:143], v[72:75], v[160:175]
    v_max3_u32 v2, v2, v38, v39
    v_max_u32 v2, v2, v3
    v_cmp_eq_u32 vcc, -1, v2
    v_mfma_f32_32x32x16_bf16 v[176:191], a[140:143], v[76:79], v[176:191]
    buffer_load_dwordx4 v[72:75], v12, s[52:55], s26 offen offset:3072 sc1
    buffer_load_dwordx4 v[76:79], v13, s[52:55], s26 offen offset:3072 sc1
    s_add_u32 s26, s26, 4096
    s_cbranch_vccnz L_g1_slow18
L_g1_back18:
    v_mfma_f32_32x32x16_bf16 v[128:143], a[144:147], v[32:35], v[128:143]
    s_waitcnt vmcnt(8)
    v_mfma_f32_32x32x16_bf16 v[144:159], a[144:147], v[36:39], v[144:159]
    v_max3_u32 v2, v40, v41, v42
    v_max3_u32 v3, v43, v44, v45
    v_mfma_f32_32x32x16_bf16 v[160:175], a[148:151], v[32:35], v[160:175]
    v_max3_u32 v2, v2, v46, v47
    v_max_u32 v2, v2, v3
    v_cmp_eq_u32 vcc, -1, v2
    v_mfma_f32_32x32x16_bf16 v[176:191], a[148:151], v[36:39], v[176:191]
    buffer_load_dwordx4 v[32:35], v12, s[52:55], s26 offen offset:0 sc1
    buffer_load_dwordx4 v[36:39], v13, s[52:55], s26 offen offset:0 sc1
    s_cbranch_vccnz L_g1_slow19
L_g1_back19:
    v_mfma_f32_32x32x16_bf16 v[128:143], a[152:155], v[40:43], v[128:143]
    s_waitcnt vmcnt(8)
    v_mfma_f32_32x32x16_bf16 v[144:159], a[152:155], v[44:47], v[144:159]
    v_max3_u32 v2, v48, v49, v50
    v_max3_u32 v3, v51, v52, v53
    v_mfma_f32_32x32x16_bf16 v[160:175], a[156:159], v[40:43], v[160:175]
    v_max3_u32 v2, v2, v54, v55
    v_max_u32 v2, v2, v3
    v_cmp_eq_u32 vcc, -1, v2
    v_mfma_f32_32x32x16_bf16 v[176:191], a[156:159], v[44:47], v[176:191]
    buffer_load_dwordx4 v[40:43], v12, s[52:55], s26 offen offset:1024 sc1
    buffer_load_dwordx4 v[44:47], v13, s[52:55], s26 offen offset:1024 sc1
    s_cbranch_vccnz L_g1_slow20
L_g1_back20:
    v_mfma_f32_32x32x16_bf16 v[128:143], a[160:163], v[48:51], v[128:143]
    s_waitcnt vmcnt(8)
    v_mfma_f32_32x32x16_bf16 v[144:159], a[160:163], v[52:55], v[144:159]
    v_max3_u32 v2, v56, v57, v58
    v_max3_u32 v3, v59, v60, v61
    v_mfma_f32_32x32x16_bf16 v[160:175], a[164:167], v[48:51], v[160:175]
    v_max3_u32 v2, v2, v62, v63
    v_max_u32 v2, v2, v3
    v_cmp_eq_u32 vcc, -1, v2
    v_mfma_f32_32x32x16_bf16 v[176:191], a[164:167], v[52:55], v[176:191]
    buffer_load_dwordx4 v[48:51], v12, s[52:55], s26 offen offset:2048 sc1
    buffer_load_dwordx4 v[52:55], v13, s[52:55], s26 offen offset:2048 sc1
    s_cbranch_vccnz L_g1_slow21
L_g1_back21:
    v_mfma_f32_32x32x16_bf16 v[128:143], a[168:171], v[56:59], v[128:143]
    s_waitcnt vmcnt(8)
    v_mfma_f32_32x32x16_bf16 v[144:159], a[168:171], v[60:63], v[144:159]
    v_max3_u32 v2, v64, v65, v66
    v_max3_u32 v3, v67, v68, v69
    v_mfma_f32_32x32x16_bf16 v[160:175], a[172:175], v[56:59], v[160:175]
    v_max3_u32 v2, v2, v70, v71
    v_max_u32 v2, v2, v3
    v_cmp_eq_u32 vcc, -1, v2
    v_mfma_f32_32x32x16_bf16 v[176:191], a[172:175], v[60:63], v[176:191]
    buffer_load_dwordx4 v[56:59], v12, s[52:55], s26 offen offset:3072 sc1
    buffer_load_dwordx4 v[60:63], v13, s[52:55], s26 offen offset:3072 sc1
    s_add_u32 s26, s26, 4096
    s_cbranch_vccnz L_g1_slow22
L_g1_back22:
    s_waitcnt lgkmcnt(0)
    v_mfma_f32_32x32x16_bf16 v[128:143], a[176:179], v[64:67], v[128:143]
    s_waitcnt vmcnt(8)
    s_nop 0
    v_mfma_f32_32x32x16_bf16 v[144:159], a[176:179], v[68:71], v[144:159]
    v_max3_u32 v2, v72, v73, v74
    v_max3_u32 v3, v75, v76, v77
    v_mfma_f32_32x32x16_bf16 v[160:175], a[180:183], v[64:67], v[160:175]
    v_max3_u32 v2, v2, v78, v79
    v_max_u32 v2, v2, v3
    v_cmp_eq_u32 vcc, -1, v2
    v_mfma_f32_32x32x16_bf16 v[176:191], a[180:183], v[68:71], v[176:191]
    buffer_load_dwordx4 v[64:67], v12, s[52:55], s26 offen offset:0 sc1
    buffer_load_dwordx4 v[68:71], v13, s[52:55], s26 offen offset:0 sc1
    s_cbranch_vccnz L_g1_slow23
L_g1_back23:
    v_mfma_f32_32x32x16_bf16 v[128:143], a[184:187], v[72:75], v[128:143]
    s_waitcnt vmcnt(8)
    v_mfma_f32_32x32x16_bf16 v[144:159], a[184:187], v[76:79], v[144:159]
    v_max3_u32 v2, v32, v33, v34
    v_max3_u32 v3, v35, v36, v37
    v_mfma_f32_32x32x16_bf16 v[160:175], a[188:191], v[72:75], v[160:175]
    v_max3_u32 v2, v2, v38, v39
    v_max_u32 v2, v2, v3
    v_cmp_eq_u32 vcc, -1, v2
    v_mfma_f32_32x32x16_bf16 v[176:191], a[188:191], v[76:79], v[176:191]
    buffer_load_dwordx4 v[72:75], v12, s[52:55], s26 offen offset:1024 sc1
    buffer_load_dwordx4 v[76:79], v13, s[52:55], s26 offen offset:1024 sc1
    s_cbranch_vccnz L_g1_slow24
L_g1_back24:
    v_mfma_f32_32x32x16_bf16 v[128:143], a[192:195], v[32:35], v[128:143]
    s_waitcnt vmcnt(8)
    v_mfma_f32_32x32x16_bf16 v[144:159], a[192:195], v[36:39], v[144:159]
    v_max3_u32 v2, v40, v41, v42
    v_max3_u32 v3, v43, v44, v45
    v_mfma_f32_32x32x16_bf16 v[160:175], a[196:199], v[32:35], v[160:175]
    v_max3_u32 v2, v2, v46, v47
    v_max_u32 v2, v2, v3
    v_cmp_eq_u32 vcc, -1, v2
    v_mfma_f32_32x32x16_bf16 v[176:191], a[196:199], v[36:39], v[176:191]
    buffer_load_dwordx4 v[32:35], v12, s[52:55], s26 offen offset:2048 sc1
    buffer_load_dwordx4 v[36:39], v13, s[52:55], s26 offen offset:2048 sc1
    s_cbranch_vccnz L_g1_slow25
L_g1_back25:
    v_mfma_f32_32x32x16_bf16 v[128:143], a[200:203], v[40:43], v[128:143]
    s_waitcnt vmcnt(8)
    v_mfma_f32_32x32x16_bf16 v[144:159], a[200:203], v[44:47], v[144:159]
    v_max3_u32 v2, v48, v49, v50
    v_max3_u32 v3, v51, v52, v53
    v_mfma_f32_32x32x16_bf16 v[160:175], a[204:207], v[40:43], v[160:175]
    v_max3_u32 v2, v2, v54, v55
    v_max_u32 v2, v2, v3
    v_cmp_eq_u32 vcc, -1, v2
    v_mfma_f32_32x32x16_bf16 v[176:191], a[204:207], v[44:47], v[176:191]
    buffer_load_dwordx4 v[40:43], v12, s[52:55], s26 offen offset:3072 sc1
    buffer_load_dwordx4 v[44:47], v13, s[52:55], s26 offen offset:3072 sc1
    s_add_u32 s26, s26, 4096
    s_cbranch_vccnz L_g1_slow26
L_g1_back26:
    v_mfma_f32_32x32x16_bf16 v[128:143], a[208:211], v[48:51], v[128:143]
    s_waitcnt vmcnt(8)
    v_mfma_f32_32x32x16_bf16 v[144:159], a[208:211], v[52:55], v[144:159]
    v_max3_u32 v2, v56, v57, v58
    v_max3_u32 v3, v59, v60, v61
    v_mfma_f32_32x32x16_bf16 v[160:175], a[212:215], v[48:51], v[160:175]
    v_max3_u32 v2, v2, v62, v63
    v_max_u32 v2, v2, v3
    v_cmp_eq_u32 vcc, -1, v2
    v_mfma_f32_32x32x16_bf16 v[176:191], a[212:215], v[52:55], v[176:191]
    s_cbranch_vccnz L_g1_slow27
L_g1_back27:
    v_mfma_f32_32x32x16_bf16 v[128:143], a[216:219], v[56:59], v[128:143]
    s_waitcnt vmcnt(6)
    v_mfma_f32_32x32x16_bf16 v[144:159], a[216:219], v[60:63], v[144:159]
    v_max3_u32 v2, v64, v65, v66
    v_max3_u32 v3, v67, v68, v69
    v_mfma_f32_32x32x16_bf16 v[160:175], a[220:223], v[56:59], v[160:175]
    v_max3_u32 v2, v2, v70, v71
    v_max_u32 v2, v2, v3
    v_cmp_eq_u32 vcc, -1, v2
    v_mfma_f32_32x32x16_bf16 v[176:191], a[220:223], v[60:63], v[176:191]
    s_cbranch_vccnz L_g1_slow28
L_g1_back28:
    v_mfma_f32_32x32x16_bf16 v[128:143], a[224:227], v[64:67], v[128:143]
    s_waitcnt vmcnt(4)
    v_mfma_f32_32x32x16_bf16 v[144:159], a[224:227], v[68:71], v[144:159]
    v_max3_u32 v2, v72, v73, v74
    v_max3_u32 v3, v75, v76, v77
    v_mfma_f32_32x32x16_bf16 v[160:175], a[228:231], v[64:67], v[160:175]
    v_max3_u32 v2, v2, v78, v79
    v_max_u32 v2, v2, v3
    v_cmp_eq_u32 vcc, -1, v2
    v_mfma_f32_32x32x16_bf16 v[176:191], a[228:231], v[68:71], v[176:191]
    s_cbranch_vccnz L_g1_slow29
L_g1_back29:
    v_mfma_f32_32x32x16_bf16 v[128:143], a[232:235], v[72:75], v[128:143]
    s_waitcnt vmcnt(2)
    v_mfma_f32_32x32x16_bf16 v[144:159], a[232:235], v[76:79], v[144:159]
    v_max3_u32 v2, v32, v33, v34
    v_max3_u32 v3, v35, v36, v37
    v_mfma_f32_32x32x16_bf16 v[160:175], a[236:239], v[72:75], v[160:175]
    v_max3_u32 v2, v2, v38, v39
    v_max_u32 v2, v2, v3
    v_cmp_eq_u32 vcc, -1, v2
    v_mfma_f32_32x32x16_bf16 v[176:191], a[236:239], v[76:79], v[176:191]
    s_cbranch_vccnz L_g1_slow30
L_g1_back30:
    v_mfma_f32_32x32x16_bf16 v[128:143], a[240:243], v[32:35], v[128:143]
    s_waitcnt vmcnt(0)
    v_mfma_f32_32x32x16_bf16 v[144:159], a[240:243], v[36:39], v[144:159]
    v_max3_u32 v2, v40, v41, v42
    v_max3_u32 v3, v43, v44, v45
    v_mfma_f32_32x32x16_bf16 v[160:175], a[244:247], v[32:35], v[160:175]
    v_max3_u32 v2, v2, v46, v47
    v_max_u32 v2, v2, v3
    v_cmp_eq_u32 vcc, -1, v2
    v_mfma_f32_32x32x16_bf16 v[176:191], a[244:247], v[36:39], v[176:191]
    s_cbranch_vccnz L_g1_slow31
L_g1_back31:
    s_nop 0
    v_mfma_f32_32x32x16_bf16 v[128:143], a[248:251], v[40:43], v[128:143]
    v_mfma_f32_32x32x16_bf16 v[144:159], a[248:251], v[44:47], v[144:159]
    v_mfma_f32_32x32x16_bf16 v[160:175], a[252:255], v[40:43], v[160:175]
    v_mfma_f32_32x32x16_bf16 v[176:191], a[252:255], v[44:47], v[176:191]
    s_barrier
    s_cmp_lg_u32 s3, 0
    s_cbranch_scc1 L_arr2
    v_mov_b32 v250, s8
    v_mov_b32 v251, 0
    s_lshl_b32 s9, s6, 7
    s_add_u32 s9, s9, 65536
    s_mov_b64 s[10:11], exec
    s_mov_b64 exec, 1
    buffer_store_dword v250, v251, s[52:55], s9 offen sc1
    s_mov_b64 exec, s[10:11]
L_arr2:
    v_lshlrev_b32 v3, 4, v1
    s_mul_i32 s9, s3, 12288
    v_add_u32 v2, s9, v3
    s_cmp_lg_u32 s3, 0
    s_cbranch_scc1 L_g1_x0
    s_nop 1
    ds_write_b128 v3, v[144:147] offset:20480
    s_mul_i32 s24, s3, 1835008
    s_lshl_b32 s27, s20, 7
    s_add_u32 s24, s24, s27
    s_mul_i32 s27, s3, 28672
    s_add_u32 s27, s27, 49152
    s_add_u32 s25, s27, 28672
    s_mul_i32 s71, s23, 65536
    s_add_u32 s24, s24, s71
    s_lshl_b32 s71, s23, 11
    s_add_u32 m0, s27, s71
    s_nop 0
    buffer_load_dwordx4 v240, s[76:79], s24 offen lds
    s_add_u32 m0, m0, 1024
    s_add_u32 s24, s24, 32768
    ds_write_b128 v3, v[148:151] offset:21504
    buffer_load_dwordx4 v240, s[76:79], s24 offen lds
    s_add_u32 m0, m0, 1024
    s_add_u32 s24, s24, 32768
    s_cmp_eq_u32 m0, s25
    s_nop 0
    s_cselect_b32 s71, 28672, 0
    s_cselect_b32 s27, 917504, 0
    s_sub_u32 m0, m0, s71
    s_sub_u32 s24, s24, s27
    ds_write_b128 v3, v[152:155] offset:22528
    buffer_load_dwordx4 v240, s[76:79], s24 offen lds
    s_add_u32 m0, m0, 1024
    s_add_u32 s24, s24, 32768
    buffer_load_dwordx4 v240, s[76:79], s24 offen lds
    s_add_u32 m0, m0, 1024
    s_add_u32 s24, s24, 32768
    s_cmp_eq_u32 m0, s25
    s_nop 0
    s_cselect_b32 s71, 28672, 0
    s_cselect_b32 s27, 917504, 0
    s_sub_u32 m0, m0, s71
    s_sub_u32 s24, s24, s27
    ds_write_b128 v3, v[156:159] offset:23552
    buffer_load_dwordx4 v240, s[76:79], s24 offen lds
    s_add_u32 m0, m0, 1024
    s_add_u32 s24, s24, 32768
    ds_write_b128 v3, v[160:163] offset:28672
    buffer_load_dwordx4 v240, s[76:79], s24 offen lds
    s_add_u32 m0, m0, 1024
    s_add_u32 s24, s24, 32768
    s_cmp_eq_u32 m0, s25
    s_nop 0
    s_cselect_b32 s71, 28672, 0
    s_cselect_b32 s27, 917504, 0
    s_sub_u32 m0, m0, s71
    s_sub_u32 s24, s24, s27
    ds_write_b128 v3, v[164:167] offset:29696
    buffer_load_dwordx4 v240, s[76:79], s24 offen lds
    s_add_u32 m0, m0, 1024
    s_add_u32 s24, s24, 32768
    buffer_load_dwordx4 v240, s[76:79], s24 offen lds
    s_add_u32 m0, m0, 1024
    s_add_u32 s24, s24, 32768
    s_cmp_eq_u32 m0, s25
    s_nop 0
    s_cselect_b32 s71, 28672, 0
    s_cselect_b32 s27, 917504, 0
    s_sub_u32 m0, m0, s71
    s_sub_u32 s24, s24, s27
    ds_write_b128 v3, v[168:171] offset:30720
    buffer_load_dwordx4 v240, s[76:79], s24 offen lds
    s_add_u32 m0, m0, 1024
    s_add_u32 s24, s24, 32768
    ds_write_b128 v3, v[172:175] offset:31744
    buffer_load_dwordx4 v240, s[76:79], s24 offen lds
    s_add_u32 m0, m0, 1024
    s_add_u32 s24, s24, 32768
    s_cmp_eq_u32 m0, s25
    s_nop 0
    s_cselect_b32 s71, 28672, 0
    s_cselect_b32 s27, 917504, 0
    s_sub_u32 m0, m0, s71
    s_sub_u32 s24, s24, s27
    ds_write_b128 v3, v[176:179] offset:36864
    buffer_load_dwordx4 v240, s[76:79], s24 offen lds
    s_add_u32 m0, m0, 1024
    s_add_u32 s24, s24, 32768
    buffer_load_dwordx4 v240, s[76:79], s24 offen lds
    s_add_u32 m0, m0, 1024
    s_add_u32 s24, s24, 32768
    s_cmp_eq_u32 m0, s25
    s_nop 0
    s_cselect_b32 s71, 28672, 0
    s_cselect_b32 s27, 917504, 0
    s_sub_u32 m0, m0, s71
    s_sub_u32 s24, s24, s27
    ds_write_b128 v3, v[180:183] offset:37888
    buffer_load_dwordx4 v240, s[76:79], s24 offen lds
    s_add_u32 m0, m0, 1024
    s_add_u32 s24, s24, 32768
    ds_write_b128 v3, v[184:187] offset:38912
    buffer_load_dwordx4 v240, s[76:79], s24 offen lds
    s_add_u32 m0, m0, 1024
    s_add_u32 s24, s24, 32768
    s_cmp_eq_u32 m0, s25
    s_nop 0
    s_cselect_b32 s71, 28672, 0
    s_cselect_b32 s27, 917504, 0
    s_sub_u32 m0, m0, s71
    s_sub_u32 s24, s24, s27
    ds_write_b128 v3, v[188:191] offset:39936
    buffer_load_dwordx4 v240, s[76:79], s24 offen lds
    s_add_u32 m0, m0, 1024
    s_add_u32 s24, s24, 32768
    buffer_load_dwordx4 v240, s[76:79], s24 offen lds
    s_add_u32 m0, m0, 1024
    s_add_u32 s24, s24, 32768
    s_cmp_eq_u32 m0, s25
    s_nop 0
    s_cselect_b32 s71, 28672, 0
    s_cselect_b32 s27, 917504, 0
    s_sub_u32 m0, m0, s71
    s_sub_u32 s24, s24, s27
    v_mov_b32 v192, v128
    v_mov_b32 v193, v129
    v_mov_b32 v194, v130
    v_mov_b32 v195, v131
    v_mov_b32 v196, v132
    v_mov_b32 v197, v133
    v_mov_b32 v198, v134
    v_mov_b32 v199, v135
    v_mov_b32 v200, v136
    v_mov_b32 v201, v137
    v_mov_b32 v202, v138
    v_mov_b32 v203, v139
    v_mov_b32 v204, v140
    v_mov_b32 v205, v141
    v_mov_b32 v206, v142
    v_mov_b32 v207, v143
    s_branch L_g1_xd
L_g1_x0:
    s_cmp_lg_u32 s3, 1
    s_cbranch_scc1 L_g1_x1
    s_nop 0
    ds_write_b128 v3, v[128:131] offset:0
    s_mul_i32 s24, s3, 1835008
    s_lshl_b32 s27, s20, 7
    s_add_u32 s24, s24, s27
    s_mul_i32 s27, s3, 28672
    s_add_u32 s27, s27, 49152
    s_add_u32 s25, s27, 28672
    s_mul_i32 s71, s23, 65536
    s_add_u32 s24, s24, s71
    s_lshl_b32 s71, s23, 11
    s_add_u32 m0, s27, s71
    s_nop 0
    buffer_load_dwordx4 v240, s[76:79], s24 offen lds
    s_add_u32 m0, m0, 1024
    s_add_u32 s24, s24, 32768
    ds_write_b128 v3, v[132:135] offset:1024
    buffer_load_dwordx4 v240, s[76:79], s24 offen lds
    s_add_u32 m0, m0, 1024
    s_add_u32 s24, s24, 32768
    s_cmp_eq_u32 m0, s25
    s_nop 0
    s_cselect_b32 s71, 28672, 0
    s_cselect_b32 s27, 917504, 0
    s_sub_u32 m0, m0, s71
    s_sub_u32 s24, s24, s27
    ds_write_b128 v3, v[136:139] offset:2048
    buffer_load_dwordx4 v240, s[76:79], s24 offen lds
    s_add_u32 m0, m0, 1024
    s_add_u32 s24, s24, 32768
    buffer_load_dwordx4 v240, s[76:79], s24 offen lds
    s_add_u32 m0, m0, 1024
    s_add_u32 s24, s24, 32768
    s_cmp_eq_u32 m0, s25
    s_nop 0
    s_cselect_b32 s71, 28672, 0
    s_cselect_b32 s27, 917504, 0
    s_sub_u32 m0, m0, s71
    s_sub_u32 s24, s24, s27
    ds_write_b128 v3, v[140:143] offset:3072
    buffer_load_dwordx4 v240, s[76:79], s24 offen lds
    s_add_u32 m0, m0, 1024
    s_add_u32 s24, s24, 32768
    ds_write_b128 v3, v[160:163] offset:32768
    buffer_load_dwordx4 v240, s[76:79], s24 offen lds
    s_add_u32 m0, m0, 1024
    s_add_u32 s24, s24, 32768
    s_cmp_eq_u32 m0, s25
    s_nop 0
    s_cselect_b32 s71, 28672, 0
    s_cselect_b32 s27, 917504, 0
    s_sub_u32 m0, m0, s71
    s_sub_u32 s24, s24, s27
    ds_write_b128 v3, v[164:167] offset:33792
    buffer_load_dwordx4 v240, s[76:79], s24 offen lds
    s_add_u32 m0, m0, 1024
    s_add_u32 s24, s24, 32768
    buffer_load_dwordx4 v240, s[76:79], s24 offen lds
    s_add_u32 m0, m0, 1024
    s_add_u32 s24, s24, 32768
    s_cmp_eq_u32 m0, s25
    s_nop 0
    s_cselect_b32 s71, 28672, 0
    s_cselect_b32 s27, 917504, 0
    s_sub_u32 m0, m0, s71
    s_sub_u32 s24, s24, s27
    ds_write_b128 v3, v[168:171] offset:34816
    buffer_load_dwordx4 v240, s[76:79], s24 offen lds
    s_add_u32 m0, m0, 1024
    s_add_u32 s24, s24, 32768
    ds_write_b128 v3, v[172:175] offset:35840
    buffer_load_dwordx4 v240, s[76:79], s24 offen lds
    s_add_u32 m0, m0, 1024
    s_add_u32 s24, s24, 32768
    s_cmp_eq_u32 m0, s25
    s_nop 0
    s_cselect_b32 s71, 28672, 0
    s_cselect_b32 s27, 917504, 0
    s_sub_u32 m0, m0, s71
    s_sub_u32 s24, s24, s27
    ds_write_b128 v3, v[176:179] offset:40960
    buffer_load_dwordx4 v240, s[76:79], s24 offen lds
    s_add_u32 m0, m0, 1024
    s_add_u32 s24, s24, 32768
    buffer_load_dwordx4 v240, s[76:79], s24 offen lds
    s_add_u32 m0, m0, 1024
    s_add_u32 s24, s24, 32768
    s_cmp_eq_u32 m0, s25
    s_nop 0
    s_cselect_b32 s71, 28672, 0
    s_cselect_b32 s27, 917504, 0
    s_sub_u32 m0, m0, s71
    s_sub_u32 s24, s24, s27
    ds_write_b128 v3, v[180:183] offset:41984
    buffer_load_dwordx4 v240, s[76:79], s24 offen lds
    s_add_u32 m0, m0, 1024
    s_add_u32 s24, s24, 32768
    ds_write_b128 v3, v[184:187] offset:43008
    buffer_load_dwordx4 v240, s[76:79], s24 offen lds
    s_add_u32 m0, m0, 1024
    s_add_u32 s24, s24, 32768
    s_cmp_eq_u32 m0, s25
    s_nop 0
    s_cselect_b32 s71, 28672, 0
    s_cselect_b32 s27, 917504, 0
    s_sub_u32 m0, m0, s71
    s_sub_u32 s24, s24, s27
    ds_write_b128 v3, v[188:191] offset:44032
    buffer_load_dwordx4 v240, s[76:79], s24 offen lds
    s_add_u32 m0, m0, 1024
    s_add_u32 s24, s24, 32768
    buffer_load_dwordx4 v240, s[76:79], s24 offen lds
    s_add_u32 m0, m0, 1024
    s_add_u32 s24, s24, 32768
    s_cmp_eq_u32 m0, s25
    s_nop 0
    s_cselect_b32 s71, 28672, 0
    s_cselect_b32 s27, 917504, 0
    s_sub_u32 m0, m0, s71
    s_sub_u32 s24, s24, s27
    v_mov_b32 v192, v144
    v_mov_b32 v193, v145
    v_mov_b32 v194, v146
    v_mov_b32 v195, v147
    v_mov_b32 v196, v148
    v_mov_b32 v197, v149
    v_mov_b32 v198, v150
    v_mov_b32 v199, v151
    v_mov_b32 v200, v152
    v_mov_b32 v201, v153
    v_mov_b32 v202, v154
    v_mov_b32 v203, v155
    v_mov_b32 v204, v156
    v_mov_b32 v205, v157
    v_mov_b32 v206, v158
    v_mov_b32 v207, v159
    s_branch L_g1_xd
L_g1_x1:
    s_cmp_lg_u32 s3, 2
    s_cbranch_scc1 L_g1_x2
    s_nop 0
    ds_write_b128 v3, v[128:131] offset:4096
    s_mul_i32 s24, s3, 1835008
    s_lshl_b32 s27, s20, 7
    s_add_u32 s24, s24, s27
    s_mul_i32 s27, s3, 28672
    s_add_u32 s27, s27, 49152
    s_add_u32 s25, s27, 28672
    s_mul_i32 s71, s23, 65536
    s_add_u32 s24, s24, s71
    s_lshl_b32 s71, s23, 11
    s_add_u32 m0, s27, s71
    s_nop 0
    buffer_load_dwordx4 v240, s[76:79], s24 offen lds
    s_add_u32 m0, m0, 1024
    s_add_u32 s24, s24, 32768
    ds_write_b128 v3, v[132:135] offset:5120
    buffer_load_dwordx4 v240, s[76:79], s24 offen lds
    s_add_u32 m0, m0, 1024
    s_add_u32 s24, s24, 32768
    s_cmp_eq_u32 m0, s25
    s_nop 0
    s_cselect_b32 s71, 28672, 0
    s_cselect_b32 s27, 917504, 0
    s_sub_u32 m0, m0, s71
    s_sub_u32 s24, s24, s27
    ds_write_b128 v3, v[136:139] offset:6144
    buffer_load_dwordx4 v240, s[76:79], s24 offen lds
    s_add_u32 m0, m0, 1024
    s_add_u32 s24, s24, 32768
    buffer_load_dwordx4 v240, s[76:79], s24 offen lds
    s_add_u32 m0, m0, 1024
    s_add_u32 s24, s24, 32768
    s_cmp_eq_u32 m0, s25
    s_nop 0
    s_cselect_b32 s71, 28672, 0
    s_cselect_b32 s27, 917504, 0
    s_sub_u32 m0, m0, s71
    s_sub_u32 s24, s24, s27
    ds_write_b128 v3, v[140:143] offset:7168
    buffer_load_dwordx4 v240, s[76:79], s24 offen lds
    s_add_u32 m0, m0, 1024
    s_add_u32 s24, s24, 32768
    ds_write_b128 v3, v[144:147] offset:12288
    buffer_load_dwordx4 v240, s[76:79], s24 offen lds
    s_add_u32 m0, m0, 1024
    s_add_u32 s24, s24, 32768
    s_cmp_eq_u32 m0, s25
    s_nop 0
    s_cselect_b32 s71, 28672, 0
    s_cselect_b32 s27, 917504, 0
    s_sub_u32 m0, m0, s71
    s_sub_u32 s24, s24, s27
    ds_write_b128 v3, v[148:151] offset:13312
    buffer_load_dwordx4 v240, s[76:79], s24 offen lds
    s_add_u32 m0, m0, 1024
    s_add_u32 s24, s24, 32768
    buffer_load_dwordx4 v240, s[76:79], s24 offen lds
    s_add_u32 m0, m0, 1024
    s_add_u32 s24, s24, 32768
    s_cmp_eq_u32 m0, s25
    s_nop 0
    s_cselect_b32 s71, 28672, 0
    s_cselect_b32 s27, 917504, 0
    s_sub_u32 m0, m0, s71
    s_sub_u32 s24, s24, s27
    ds_write_b128 v3, v[152:155] offset:14336
    buffer_load_dwordx4 v240, s[76:79], s24 offen lds
    s_add_u32 m0, m0, 1024
    s_add_u32 s24, s24, 32768
    ds_write_b128 v3, v[156:159] offset:15360
    buffer_load_dwordx4 v240, s[76:79], s24 offen lds
    s_add_u32 m0, m0, 1024
    s_add_u32 s24, s24, 32768
    s_cmp_eq_u32 m0, s25
    s_nop 0
    s_cselect_b32 s71, 28672, 0
    s_cselect_b32 s27, 917504, 0
    s_sub_u32 m0, m0, s71
    s_sub_u32 s24, s24, s27
    ds_write_b128 v3, v[176:179] offset:45056
    buffer_load_dwordx4 v240, s[76:79], s24 offen lds
    s_add_u32 m0, m0, 1024
    s_add_u32 s24, s24, 32768
    buffer_load_dwordx4 v240, s[76:79], s24 offen lds
    s_add_u32 m0, m0, 1024
    s_add_u32 s24, s24, 32768
    s_cmp_eq_u32 m0, s25
    s_nop 0
    s_cselect_b32 s71, 28672, 0
    s_cselect_b32 s27, 917504, 0
    s_sub_u32 m0, m0, s71
    s_sub_u32 s24, s24, s27
    ds_write_b128 v3, v[180:183] offset:46080
    buffer_load_dwordx4 v240, s[76:79], s24 offen lds
    s_add_u32 m0, m0, 1024
    s_add_u32 s24, s24, 32768
    ds_write_b128 v3, v[184:187] offset:47104
    buffer_load_dwordx4 v240, s[76:79], s24 offen lds
    s_add_u32 m0, m0, 1024
    s_add_u32 s24, s24, 32768
    s_cmp_eq_u32 m0, s25
    s_nop 0
    s_cselect_b32 s71, 28672, 0
    s_cselect_b32 s27, 917504, 0
    s_sub_u32 m0, m0, s71
    s_sub_u32 s24, s24, s27
    ds_write_b128 v3, v[188:191] offset:48128
    buffer_load_dwordx4 v240, s[76:79], s24 offen lds
    s_add_u32 m0, m0, 1024
    s_add_u32 s24, s24, 32768
    buffer_load_dwordx4 v240, s[76:79], s24 offen lds
    s_add_u32 m0, m0, 1024
    s_add_u32 s24, s24, 32768
    s_cmp_eq_u32 m0, s25
    s_nop 0
    s_cselect_b32 s71, 28672, 0
    s_cselect_b32 s27, 917504, 0
    s_sub_u32 m0, m0, s71
    s_sub_u32 s24, s24, s27
    v_mov_b32 v192, v160
    v_mov_b32 v193, v161
    v_mov_b32 v194, v162
    v_mov_b32 v195, v163
    v_mov_b32 v196, v164
    v_mov_b32 v197, v165
    v_mov_b32 v198, v166
    v_mov_b32 v199, v167
    v_mov_b32 v200, v168
    v_mov_b32 v201, v169
    v_mov_b32 v202, v170
    v_mov_b32 v203, v171
    v_mov_b32 v204, v172
    v_mov_b32 v205, v173
    v_mov_b32 v206, v174
    v_mov_b32 v207, v175
    s_branch L_g1_xd
L_g1_x2:
    s_nop 0
    ds_write_b128 v3, v[128:131] offset:8192
    s_mul_i32 s24, s3, 1835008
    s_lshl_b32 s27, s20, 7
    s_add_u32 s24, s24, s27
    s_mul_i32 s27, s3, 28672
    s_add_u32 s27, s27, 49152
    s_add_u32 s25, s27, 28672
    s_mul_i32 s71, s23, 65536
    s_add_u32 s24, s24, s71
    s_lshl_b32 s71, s23, 11
    s_add_u32 m0, s27, s71
    s_nop 0
    buffer_load_dwordx4 v240, s[76:79], s24 offen lds
    s_add_u32 m0, m0, 1024
    s_add_u32 s24, s24, 32768
    ds_write_b128 v3, v[132:135] offset:9216
    buffer_load_dwordx4 v240, s[76:79], s24 offen lds
    s_add_u32 m0, m0, 1024
    s_add_u32 s24, s24, 32768
    s_cmp_eq_u32 m0, s25
    s_nop 0
    s_cselect_b32 s71, 28672, 0
    s_cselect_b32 s27, 917504, 0
    s_sub_u32 m0, m0, s71
    s_sub_u32 s24, s24, s27
    ds_write_b128 v3, v[136:139] offset:10240
    buffer_load_dwordx4 v240, s[76:79], s24 offen lds
    s_add_u32 m0, m0, 1024
    s_add_u32 s24, s24, 32768
    buffer_load_dwordx4 v240, s[76:79], s24 offen lds
    s_add_u32 m0, m0, 1024
    s_add_u32 s24, s24, 32768
    s_cmp_eq_u32 m0, s25
    s_nop 0
    s_cselect_b32 s71, 28672, 0
    s_cselect_b32 s27, 917504, 0
    s_sub_u32 m0, m0, s71
    s_sub_u32 s24, s24, s27
    ds_write_b128 v3, v[140:143] offset:11264
    buffer_load_dwordx4 v240, s[76:79], s24 offen lds
    s_add_u32 m0, m0, 1024
    s_add_u32 s24, s24, 32768
    ds_write_b128 v3, v[144:147] offset:16384
    buffer_load_dwordx4 v240, s[76:79], s24 offen lds
    s_add_u32 m0, m0, 1024
    s_add_u32 s24, s24, 32768
    s_cmp_eq_u32 m0, s25
    s_nop 0
    s_cselect_b32 s71, 28672, 0
    s_cselect_b32 s27, 917504, 0
    s_sub_u32 m0, m0, s71
    s_sub_u32 s24, s24, s27
    ds_write_b128 v3, v[148:151] offset:17408
    buffer_load_dwordx4 v240, s[76:79], s24 offen lds
    s_add_u32 m0, m0, 1024
    s_add_u32 s24, s24, 32768
    buffer_load_dwordx4 v240, s[76:79], s24 offen lds
    s_add_u32 m0, m0, 1024
    s_add_u32 s24, s24, 32768
    s_cmp_eq_u32 m0, s25
    s_nop 0
    s_cselect_b32 s71, 28672, 0
    s_cselect_b32 s27, 917504, 0
    s_sub_u32 m0, m0, s71
    s_sub_u32 s24, s24, s27
    ds_write_b128 v3, v[152:155] offset:18432
    buffer_load_dwordx4 v240, s[76:79], s24 offen lds
    s_add_u32 m0, m0, 1024
    s_add_u32 s24, s24, 32768
    ds_write_b128 v3, v[156:159] offset:19456
    buffer_load_dwordx4 v240, s[76:79], s24 offen lds
    s_add_u32 m0, m0, 1024
    s_add_u32 s24, s24, 32768
    s_cmp_eq_u32 m0, s25
    s_nop 0
    s_cselect_b32 s71, 28672, 0
    s_cselect_b32 s27, 917504, 0
    s_sub_u32 m0, m0, s71
    s_sub_u32 s24, s24, s27
    ds_write_b128 v3, v[160:163] offset:24576
    buffer_load_dwordx4 v240, s[76:79], s24 offen lds
    s_add_u32 m0, m0, 1024
    s_add_u32 s24, s24, 32768
    buffer_load_dwordx4 v240, s[76:79], s24 offen lds
    s_add_u32 m0, m0, 1024
    s_add_u32 s24, s24, 32768
    s_cmp_eq_u32 m0, s25
    s_nop 0
    s_cselect_b32 s71, 28672, 0
    s_cselect_b32 s27, 917504, 0
    s_sub_u32 m0, m0, s71
    s_sub_u32 s24, s24, s27
    ds_write_b128 v3, v[164:167] offset:25600
    buffer_load_dwordx4 v240, s[76:79], s24 offen lds
    s_add_u32 m0, m0, 1024
    s_add_u32 s24, s24, 32768
    ds_write_b128 v3, v[168:171] offset:26624
    buffer_load_dwordx4 v240, s[76:79], s24 offen lds
    s_add_u32 m0, m0, 1024
    s_add_u32 s24, s24, 32768
    s_cmp_eq_u32 m0, s25
    s_nop 0
    s_cselect_b32 s71, 28672, 0
    s_cselect_b32 s27, 917504, 0
    s_sub_u32 m0, m0, s71
    s_sub_u32 s24, s24, s27
    ds_write_b128 v3, v[172:175] offset:27648
    buffer_load_dwordx4 v240, s[76:79], s24 offen lds
    s_add_u32 m0, m0, 1024
    s_add_u32 s24, s24, 32768
    buffer_load_dwordx4 v240, s[76:79], s24 offen lds
    s_add_u32 m0, m0, 1024
    s_add_u32 s24, s24, 32768
    s_cmp_eq_u32 m0, s25
    s_nop 0
    s_cselect_b32 s71, 28672, 0
    s_cselect_b32 s27, 917504, 0
    s_sub_u32 m0, m0, s71
    s_sub_u32 s24, s24, s27
    v_mov_b32 v192, v176
    v_mov_b32 v193, v177
    v_mov_b32 v194, v178
    v_mov_b32 v195, v179
    v_mov_b32 v196, v180
    v_mov_b32 v197, v181
    v_mov_b32 v198, v182
    v_mov_b32 v199, v183
    v_mov_b32 v200, v184
    v_mov_b32 v201, v185
    v_mov_b32 v202, v186
    v_mov_b32 v203, v187
    v_mov_b32 v204, v188
    v_mov_b32 v205, v189
    v_mov_b32 v206, v190
    v_mov_b32 v207, v191
L_g1_xd:
    s_waitcnt lgkmcnt(0)
    s_barrier
    ds_read_b128 v[128:131], v2 offset:0
    ds_read_b128 v[132:135], v2 offset:1024
    ds_read_b128 v[136:139], v2 offset:2048
    buffer_load_dwordx4 v240, s[76:79], s24 offen lds
    s_add_u32 m0, m0, 1024
    s_add_u32 s24, s24, 32768
    ds_read_b128 v[140:143], v2 offset:3072
    ds_read_b128 v[144:147], v2 offset:4096
    ds_read_b128 v[148:151], v2 offset:5120
    buffer_load_dwordx4 v240, s[76:79], s24 offen lds
    s_add_u32 m0, m0, 1024
    s_add_u32 s24, s24, 32768
    s_cmp_eq_u32 m0, s25
    s_nop 0
    s_cselect_b32 s71, 28672, 0
    s_cselect_b32 s27, 917504, 0
    s_sub_u32 m0, m0, s71
    s_sub_u32 s24, s24, s27
    ds_read_b128 v[152:155], v2 offset:6144
    ds_read_b128 v[156:159], v2 offset:7168
    ds_read_b128 v[160:163], v2 offset:8192
    buffer_load_dwordx4 v240, s[76:79], s24 offen lds
    s_add_u32 m0, m0, 1024
    s_add_u32 s24, s24, 32768
    ds_read_b128 v[164:167], v2 offset:9216
    ds_read_b128 v[168:171], v2 offset:10240
    ds_read_b128 v[172:175], v2 offset:11264
    buffer_load_dwordx4 v240, s[76:79], s24 offen lds
    s_add_u32 m0, m0, 1024
    s_add_u32 s24, s24, 32768
    s_cmp_eq_u32 m0, s25
    s_nop 0
    s_cselect_b32 s71, 28672, 0
    s_cselect_b32 s27, 917504, 0
    s_sub_u32 m0, m0, s71
    s_sub_u32 s24, s24, s27
    s_waitcnt lgkmcnt(8)
    s_nop 0
    v_pk_add_f32 v[192:193], v[192:193], v[128:129]
    v_pk_add_f32 v[194:195], v[194:195], v[130:131]
    buffer_load_dwordx4 v240, s[76:79], s24 offen lds
    s_add_u32 m0, m0, 1024
    s_add_u32 s24, s24, 32768
    v_pk_add_f32 v[196:197], v[196:197], v[132:133]
    v_pk_add_f32 v[198:199], v[198:199], v[134:135]
    v_pk_add_f32 v[200:201], v[200:201], v[136:137]
    buffer_load_dwordx4 v240, s[76:79], s24 offen lds
    s_add_u32 m0, m0, 1024
    s_add_u32 s24, s24, 32768
    s_cmp_eq_u32 m0, s25
    s_nop 0
    s_cselect_b32 s71, 28672, 0
    s_cselect_b32 s27, 917504, 0
    s_sub_u32 m0, m0, s71
    s_sub_u32 s24, s24, s27
    v_pk_add_f32 v[202:203], v[202:203], v[138:139]
    v_pk_add_f32 v[204:205], v[204:205], v[140:141]
    v_pk_add_f32 v[206:207], v[206:207], v[142:143]
    buffer_load_dwordx4 v240, s[76:79], s24 offen lds
    s_add_u32 m0, m0, 1024
    s_add_u32 s24, s24, 32768
    s_waitcnt lgkmcnt(4)
    s_nop 0
    v_pk_add_f32 v[192:193], v[192:193], v[144:145]
    v_pk_add_f32 v[194:195], v[194:195], v[146:147]
    buffer_load_dwordx4 v240, s[76:79], s24 offen lds
    s_add_u32 m0, m0, 1024
    s_add_u32 s24, s24, 32768
    s_cmp_eq_u32 m0, s25
    s_nop 0
    s_cselect_b32 s71, 28672, 0
    s_cselect_b32 s27, 917504, 0
    s_sub_u32 m0, m0, s71
    s_sub_u32 s24, s24, s27
    v_pk_add_f32 v[196:197], v[196:197], v[148:149]
    v_pk_add_f32 v[198:199], v[198:199], v[150:151]
    v_pk_add_f32 v[200:201], v[200:201], v[152:153]
    buffer_load_dwordx4 v240, s[76:79], s24 offen lds
    s_add_u32 m0, m0, 1024
    s_add_u32 s24, s24, 32768
    v_pk_add_f32 v[202:203], v[202:203], v[154:155]
    v_pk_add_f32 v[204:205], v[204:205], v[156:157]
    v_pk_add_f32 v[206:207], v[206:207], v[158:159]
    buffer_load_dwordx4 v240, s[76:79], s24 offen lds
    s_add_u32 m0, m0, 1024
    s_add_u32 s24, s24, 32768
    s_cmp_eq_u32 m0, s25
    s_nop 0
    s_cselect_b32 s71, 28672, 0
    s_cselect_b32 s27, 917504, 0
    s_sub_u32 m0, m0, s71
    s_sub_u32 s24, s24, s27
    s_waitcnt lgkmcnt(0)
    s_nop 0
    v_pk_add_f32 v[192:193], v[192:193], v[160:161]
    v_pk_add_f32 v[194:195], v[194:195], v[162:163]
    buffer_load_dwordx4 v240, s[76:79], s24 offen lds
    s_add_u32 m0, m0, 1024
    s_add_u32 s24, s24, 32768
    v_pk_add_f32 v[196:197], v[196:197], v[164:165]
    v_pk_add_f32 v[198:199], v[198:199], v[166:167]
    v_pk_add_f32 v[200:201], v[200:201], v[168:169]
    buffer_load_dwordx4 v240, s[76:79], s24 offen lds
    v_pk_add_f32 v[202:203], v[202:203], v[170:171]
    v_pk_add_f32 v[204:205], v[204:205], v[172:173]
    v_pk_add_f32 v[206:207], v[206:207], v[174:175]
    s_barrier
    v_mov_b32 v30, 0xffff0000
    v_lshlrev_b32 v208, 16, v20
    v_and_b32 v209, v30, v20
    v_lshlrev_b32 v210, 16, v21
    v_and_b32 v211, v30, v21
    v_lshlrev_b32 v212, 16, v22
    v_and_b32 v213, v30, v22
    v_lshlrev_b32 v214, 16, v23
    s_mul_i32 s24, s3, 1835008
    s_lshl_b32 s27, s20, 7
    s_add_u32 s24, s24, s27
    s_add_u32 s24, s24, 917504
    s_mul_i32 s27, s3, 12288
    s_mov_b32 m0, s27
    s_nop 0
    buffer_load_dwordx4 v240, s[76:79], s24 offen lds
    s_add_u32 m0, m0, 1024
    s_add_u32 s24, s24, 32768
    v_and_b32 v215, v30, v23
    v_lshlrev_b32 v216, 16, v24
    v_and_b32 v217, v30, v24
    v_lshlrev_b32 v218, 16, v25
    v_and_b32 v219, v30, v25
    v_lshlrev_b32 v220, 16, v26
    v_and_b32_e64 v221, v30, v26
    buffer_load_dwordx4 v240, s[76:79], s24 offen lds
    s_add_u32 m0, m0, 1024
    s_add_u32 s24, s24, 32768
    v_lshlrev_b32 v222, 16, v27
    v_and_b32 v223, v30, v27
    v_pk_add_f32 v[192:193], v[192:193], v[208:209]
    v_pk_add_f32 v[194:195], v[194:195], v[210:211]
    v_pk_add_f32 v[196:197], v[196:197], v[212:213]
    v_pk_add_f32 v[198:199], v[198:199], v[214:215]
    v_pk_add_f32 v[200:201], v[200:201], v[216:217]
    buffer_load_dwordx4 v240, s[76:79], s24 offen lds
    s_add_u32 m0, m0, 1024
    s_add_u32 s24, s24, 32768
    v_pk_add_f32 v[202:203], v[202:203], v[218:219]
    v_pk_add_f32 v[204:205], v[204:205], v[220:221]
    v_pk_add_f32 v[206:207], v[206:207], v[222:223]
    v_mov_b32 v224, 0xc0135761
    v_mov_b32 v226, 0xbdd2d3e8
    v_mov_b32_e64 v228, 1.0
    v_pk_mul_f32 v[208:209], v[192:193], v[192:193]
    buffer_load_dwordx4 v240, s[76:79], s24 offen lds
    s_add_u32 m0, m0, 1024
    s_add_u32 s24, s24, 32768
    v_pk_mul_f32 v[210:211], v[194:195], v[194:195]
    v_pk_mul_f32 v[212:213], v[196:197], v[196:197]
    v_pk_mul_f32 v[214:215], v[198:199], v[198:199]
    v_pk_mul_f32 v[216:217], v[200:201], v[200:201]
    v_pk_mul_f32 v[218:219], v[202:203], v[202:203]
    v_pk_mul_f32 v[220:221], v[204:205], v[204:205]
    v_pk_mul_f32 v[222:223], v[206:207], v[206:207]
    buffer_load_dwordx4 v240, s[76:79], s24 offen lds
    s_add_u32 m0, m0, 1024
    s_add_u32 s24, s24, 32768
    v_pk_fma_f32 v[208:209], v[208:209], v[226:227], v[224:225] op_sel_hi:[1,0,0]
    v_pk_fma_f32 v[210:211], v[210:211], v[226:227], v[224:225] op_sel_hi:[1,0,0]
    v_pk_fma_f32 v[212:213], v[212:213], v[226:227], v[224:225] op_sel_hi:[1,0,0]
    v_pk_fma_f32 v[214:215], v[214:215], v[226:227], v[224:225] op_sel_hi:[1,0,0]
    v_pk_fma_f32 v[216:217], v[216:217], v[226:227], v[224:225] op_sel_hi:[1,0,0]
    v_pk_fma_f32 v[218:219], v[218:219], v[226:227], v[224:225] op_sel_hi:[1,0,0]
    v_pk_fma_f32 v[220:221], v[220:221], v[226:227], v[224:225] op_sel_hi:[1,0,0]
    buffer_load_dwordx4 v240, s[76:79], s24 offen lds
    s_add_u32 m0, m0, 1024
    s_add_u32 s24, s24, 32768
    v_pk_fma_f32 v[222:223], v[222:223], v[226:227], v[224:225] op_sel_hi:[1,0,0]
    v_pk_mul_f32 v[208:209], v[208:209], v[192:193]
    v_pk_mul_f32 v[210:211], v[210:211], v[194:195]
    v_pk_mul_f32 v[212:213], v[212:213], v[196:197]
    v_pk_mul_f32 v[214:215], v[214:215], v[198:199]
    v_pk_mul_f32 v[216:217], v[216:217], v[200:201]
    v_pk_mul_f32 v[218:219], v[218:219], v[202:203]
    buffer_load_dwordx4 v240, s[76:79], s24 offen lds
    s_add_u32 m0, m0, 1024
    s_add_u32 s24, s24, 32768
    v_pk_mul_f32 v[220:221], v[220:221], v[204:205]
    v_pk_mul_f32 v[222:223], v[222:223], v[206:207]
    v_exp_f32 v208, v208
    v_exp_f32 v209, v209
    v_exp_f32 v210, v210
    v_exp_f32 v211, v211
    v_exp_f32_e64 v212, v212
    buffer_load_dwordx4 v240, s[76:79], s24 offen lds
    s_add_u32 m0, m0, 1024
    s_add_u32 s24, s24, 32768
    v_exp_f32 v213, v213
    v_exp_f32 v214, v214
    v_exp_f32 v215, v215
    v_exp_f32 v216, v216
    v_exp_f32 v217, v217
    v_exp_f32 v218, v218
    v_exp_f32_e64 v219, v219
    buffer_load_dwordx4 v240, s[76:79], s24 offen lds
    s_add_u32 m0, m0, 1024
    s_add_u32 s24, s24, 32768
    v_exp_f32 v220, v220
    v_exp_f32 v221, v221
    v_exp_f32 v222, v222
    v_exp_f32 v223, v223
    v_pk_add_f32 v[208:209], v[208:209], v[228:229] op_sel_hi:[1,0]
    v_pk_add_f32 v[210:211], v[210:211], v[228:229] op_sel_hi:[1,0]
    v_pk_add_f32 v[212:213], v[212:213], v[228:229] op_sel_hi:[1,0]
    buffer_load_dwordx4 v240, s[76:79], s24 offen lds
    s_add_u32 m0, m0, 1024
    s_add_u32 s24, s24, 32768
    v_pk_add_f32 v[214:215], v[214:215], v[228:229] op_sel_hi:[1,0]
    v_pk_add_f32 v[216:217], v[216:217], v[228:229] op_sel_hi:[1,0]
    v_pk_add_f32 v[218:219], v[218:219], v[228:229] op_sel_hi:[1,0]
    v_pk_add_f32 v[220:221], v[220:221], v[228:229] op_sel_hi:[1,0]
    v_pk_add_f32 v[222:223], v[222:223], v[228:229] op_sel_hi:[1,0]
    v_rcp_f32 v208, v208
    v_rcp_f32 v209, v209
    buffer_load_dwordx4 v240, s[76:79], s24 offen lds
    s_add_u32 m0, m0, 1024
    s_add_u32 s24, s24, 32768
    v_rcp_f32 v210, v210
    v_rcp_f32 v211, v211
    v_rcp_f32 v212, v212
    v_rcp_f32 v213, v213
    v_rcp_f32 v214, v214
    v_rcp_f32 v215, v215
    v_rcp_f32 v216, v216
    buffer_load_dwordx4 v240, s[76:79], s24 offen lds
    v_rcp_f32 v217, v217
    v_rcp_f32 v218, v218
    v_rcp_f32 v219, v219
    v_rcp_f32 v220, v220
    v_rcp_f32 v221, v221
    v_rcp_f32 v222, v222
    v_rcp_f32 v223, v223
    v_pk_mul_f32 v[192:193], v[192:193], v[208:209]
    v_pk_mul_f32 v[194:195], v[194:195], v[210:211]
    v_pk_mul_f32 v[196:197], v[196:197], v[212:213]
    v_pk_mul_f32 v[198:199], v[198:199], v[214:215]
    v_pk_mul_f32 v[200:201], v[200:201], v[216:217]
    v_pk_mul_f32 v[202:203], v[202:203], v[218:219]
    v_pk_mul_f32 v[204:205], v[204:205], v[220:221]
    v_pk_mul_f32 v[206:207], v[206:207], v[222:223]
    v_cvt_pk_bf16_f32 v232, v192, v193
    v_cvt_pk_bf16_f32 v233, v194, v195
    v_cvt_pk_bf16_f32 v234, v196, v197
    v_cvt_pk_bf16_f32 v235, v198, v199
    v_cvt_pk_bf16_f32 v236, v200, v201
    v_cvt_pk_bf16_f32 v237, v202, v203
    v_cvt_pk_bf16_f32 v238, v204, v205
    v_cvt_pk_bf16_f32 v239, v206, v207
    s_lshl_b32 s9, s16, 1
    s_and_b32 s10, s3, 1
    s_add_u32 s9, s9, s10
    s_mul_i32 s9, s9, 114688
    s_lshl_b32 s10, s17, 12
    s_add_u32 s9, s9, s10
    s_lshr_b32 s10, s3, 1
    s_lshl_b32 s10, s10, 11
    s_add_u32 s9, s9, s10
    s_add_u32 s9, s9, 9437184
    buffer_store_dwordx4 v[232:235], v12, s[52:55], s9 offen offset:0 sc1
    buffer_store_dwordx4 v[236:239], v12, s[52:55], s9 offen offset:1024 sc1
    s_waitcnt vmcnt(14)
    s_branch L_g1_done
L_nog1:
    s_waitcnt vmcnt(0)
    s_barrier
    s_cmp_lg_u32 s3, 0
    s_cbranch_scc1 L_arr2b
    v_mov_b32 v250, s8
    v_mov_b32 v251, 0
    s_lshl_b32 s9, s6, 7
    s_add_u32 s9, s9, 65536
    s_mov_b64 s[10:11], exec
    s_mov_b64 exec, 1
    buffer_store_dword v250, v251, s[52:55], s9 offen sc1
    s_mov_b64 exec, s[10:11]
L_arr2b:
    s_cmp_eq_u32 s21, 1
    s_cbranch_scc1 L_idle_load
    s_sub_u32 s9, s5, 28
    s_add_u32 s10, s9, 3
    s_cmp_eq_u32 s9, 0
    s_cselect_b32 s10, 0, s10
    s_cmp_ge_u32 s4, 4
    s_cselect_b32 s9, s9, s10
    s_and_b32 s10, s4, 3
    s_lshl_b32 s10, s10, 3
    s_add_u32 s20, s9, s10
    v_lshrrev_b32 v2, 3, v1
    v_mul_u32_u24 v2, 4096, v2
    v_bfe_u32 v3, v1, 4, 1
    v_lshlrev_b32 v3, 2, v3
    v_and_b32 v240, 7, v1
    v_xor_b32_e64 v240, v240, v3
    v_lshl_add_u32 v240, v240, 4, v2
    v_bfe_u32 v2, v1, 2, 2
    v_lshrrev_b32 v3, 5, v1
    v_lshl_add_u32 v3, v3, 2, v2
    v_lshlrev_b32 v3, 7, v3
    v_lshrrev_b32_e64 v2, 1, v2
    v_lshl_add_u32 v3, v2, 6, v3
    v_bfe_u32 v2, v1, 4, 1
    v_lshl_add_u32 v3, v2, 5, v3
    v_and_b32_e64 v2, 3, v1
    v_lshl_add_u32 v3, v2, 3, v3
    s_mul_i32 s9, s3, 28672
    s_add_u32 s9, s9, 49152
    v_add_u32 v241, s9, v3
    v_xor_b32 v242, 64, v241
    s_mul_i32 s9, s3, 12288
    v_add_u32 v243, s9, v3
    v_xor_b32 v229, 64, v243
    s_mul_i32 s24, s3, 1835008
    s_lshl_b32 s27, s20, 7
    s_add_u32 s24, s24, s27
    s_mul_i32 s27, s3, 28672
    s_add_u32 s27, s27, 49152
    s_add_u32 s25, s27, 28672
    s_mul_i32 s71, s23, 65536
    s_add_u32 s24, s24, s71
    s_lshl_b32 s71, s23, 11
    s_add_u32 m0, s27, s71
    s_nop 0
    buffer_load_dwordx4 v240, s[76:79], s24 offen lds
    s_add_u32 m0, m0, 1024
    s_add_u32 s24, s24, 32768
    buffer_load_dwordx4 v240, s[76:79], s24 offen lds
    s_add_u32 m0, m0, 1024
    s_add_u32 s24, s24, 32768
    s_cmp_eq_u32 m0, s25
    s_nop 0
    s_cselect_b32 s71, 28672, 0
    s_cselect_b32 s27, 917504, 0
    s_sub_u32 m0, m0, s71
    s_sub_u32 s24, s24, s27
    buffer_load_dwordx4 v240, s[76:79], s24 offen lds
    s_add_u32 m0, m0, 1024
    s_add_u32 s24, s24, 32768
    buffer_load_dwordx4 v240, s[76:79], s24 offen lds
    s_add_u32 m0, m0, 1024
    s_add_u32 s24, s24, 32768
    s_cmp_eq_u32 m0, s25
    s_nop 0
    s_cselect_b32 s71, 28672, 0
    s_cselect_b32 s27, 917504, 0
    s_sub_u32 m0, m0, s71
    s_sub_u32 s24, s24, s27
    buffer_load_dwordx4 v240, s[76:79], s24 offen lds
    s_add_u32 m0, m0, 1024
    s_add_u32 s24, s24, 32768
    buffer_load_dwordx4 v240, s[76:79], s24 offen lds
    s_add_u32 m0, m0, 1024
    s_add_u32 s24, s24, 32768
    s_cmp_eq_u32 m0, s25
    s_nop 0
    s_cselect_b32 s71, 28672, 0
    s_cselect_b32 s27, 917504, 0
    s_sub_u32 m0, m0, s71
    s_sub_u32 s24, s24, s27
    buffer_load_dwordx4 v240, s[76:79], s24 offen lds
    s_add_u32 m0, m0, 1024
    s_add_u32 s24, s24, 32768
    buffer_load_dwordx4 v240, s[76:79], s24 offen lds
    s_add_u32 m0, m0, 1024
    s_add_u32 s24, s24, 32768
    s_cmp_eq_u32 m0, s25
    s_nop 0
    s_cselect_b32 s71, 28672, 0
    s_cselect_b32 s27, 917504, 0
    s_sub_u32 m0, m0, s71
    s_sub_u32 s24, s24, s27
    buffer_load_dwordx4 v240, s[76:79], s24 offen lds
    s_add_u32 m0, m0, 1024
    s_add_u32 s24, s24, 32768
    buffer_load_dwordx4 v240, s[76:79], s24 offen lds
    s_add_u32 m0, m0, 1024
    s_add_u32 s24, s24, 32768
    s_cmp_eq_u32 m0, s25
    s_nop 0
    s_cselect_b32 s71, 28672, 0
    s_cselect_b32 s27, 917504, 0
    s_sub_u32 m0, m0, s71
    s_sub_u32 s24, s24, s27
    buffer_load_dwordx4 v240, s[76:79], s24 offen lds
    s_add_u32 m0, m0, 1024
    s_add_u32 s24, s24, 32768
    buffer_load_dwordx4 v240, s[76:79], s24 offen lds
    s_add_u32 m0, m0, 1024
    s_add_u32 s24, s24, 32768
    s_cmp_eq_u32 m0, s25
    s_nop 0
    s_cselect_b32 s71, 28672, 0
    s_cselect_b32 s27, 917504, 0
    s_sub_u32 m0, m0, s71
    s_sub_u32 s24, s24, s27
    buffer_load_dwordx4 v240, s[76:79], s24 offen lds
    s_add_u32 m0, m0, 1024
    s_add_u32 s24, s24, 32768
    buffer_load_dwordx4 v240, s[76:79], s24 offen lds
    s_add_u32 m0, m0, 1024
    s_add_u32 s24, s24, 32768
    s_cmp_eq_u32 m0, s25
    s_nop 0
    s_cselect_b32 s71, 28672, 0
    s_cselect_b32 s27, 917504, 0
    s_sub_u32 m0, m0, s71
    s_sub_u32 s24, s24, s27
    buffer_load_dwordx4 v240, s[76:79], s24 offen lds
    s_add_u32 m0, m0, 1024
    s_add_u32 s24, s24, 32768
    buffer_load_dwordx4 v240, s[76:79], s24 offen lds
    s_add_u32 m0, m0, 1024
    s_add_u32 s24, s24, 32768
    s_cmp_eq_u32 m0, s25
    s_nop 0
    s_cselect_b32 s71, 28672, 0
    s_cselect_b32 s27, 917504, 0
    s_sub_u32 m0, m0, s71
    s_sub_u32 s24, s24, s27
    buffer_load_dwordx4 v240, s[76:79], s24 offen lds
    s_add_u32 m0, m0, 1024
    s_add_u32 s24, s24, 32768
    buffer_load_dwordx4 v240, s[76:79], s24 offen lds
    s_add_u32 m0, m0, 1024
    s_add_u32 s24, s24, 32768
    s_cmp_eq_u32 m0, s25
    s_nop 0
    s_cselect_b32 s71, 28672, 0
    s_cselect_b32 s27, 917504, 0
    s_sub_u32 m0, m0, s71
    s_sub_u32 s24, s24, s27
    buffer_load_dwordx4 v240, s[76:79], s24 offen lds
    s_add_u32 m0, m0, 1024
    s_add_u32 s24, s24, 32768
    buffer_load_dwordx4 v240, s[76:79], s24 offen lds
    s_add_u32 m0, m0, 1024
    s_add_u32 s24, s24, 32768
    s_cmp_eq_u32 m0, s25
    s_nop 0
    s_cselect_b32 s71, 28672, 0
    s_cselect_b32 s27, 917504, 0
    s_sub_u32 m0, m0, s71
    s_sub_u32 s24, s24, s27
    buffer_load_dwordx4 v240, s[76:79], s24 offen lds
    s_add_u32 m0, m0, 1024
    s_add_u32 s24, s24, 32768
    buffer_load_dwordx4 v240, s[76:79], s24 offen lds
    s_add_u32 m0, m0, 1024
    s_add_u32 s24, s24, 32768
    s_cmp_eq_u32 m0, s25
    s_nop 0
    s_cselect_b32 s71, 28672, 0
    s_cselect_b32 s27, 917504, 0
    s_sub_u32 m0, m0, s71
    s_sub_u32 s24, s24, s27
    buffer_load_dwordx4 v240, s[76:79], s24 offen lds
    s_add_u32 m0, m0, 1024
    s_add_u32 s24, s24, 32768
    buffer_load_dwordx4 v240, s[76:79], s24 offen lds
    s_add_u32 m0, m0, 1024
    s_add_u32 s24, s24, 32768
    s_cmp_eq_u32 m0, s25
    s_nop 0
    s_cselect_b32 s71, 28672, 0
    s_cselect_b32 s27, 917504, 0
    s_sub_u32 m0, m0, s71
    s_sub_u32 s24, s24, s27
    buffer_load_dwordx4 v240, s[76:79], s24 offen lds
    s_add_u32 m0, m0, 1024
    s_add_u32 s24, s24, 32768
    buffer_load_dwordx4 v240, s[76:79], s24 offen lds
    s_add_u32 m0, m0, 1024
    s_add_u32 s24, s24, 32768
    s_cmp_eq_u32 m0, s25
    s_nop 0
    s_cselect_b32 s71, 28672, 0
    s_cselect_b32 s27, 917504, 0
    s_sub_u32 m0, m0, s71
    s_sub_u32 s24, s24, s27
    buffer_load_dwordx4 v240, s[76:79], s24 offen lds
    s_add_u32 m0, m0, 1024
    s_add_u32 s24, s24, 32768
    buffer_load_dwordx4 v240, s[76:79], s24 offen lds
    s_waitcnt vmcnt(20)
    s_mul_i32 s24, s3, 1835008
    s_lshl_b32 s27, s20, 7
    s_add_u32 s24, s24, s27
    s_nop 0
    s_add_u32 s24, s24, 917504
    s_mul_i32 s27, s3, 12288
    s_mov_b32 m0, s27
    s_nop 0
    buffer_load_dwordx4 v240, s[76:79], s24 offen lds
    s_add_u32 m0, m0, 1024
    s_add_u32 s24, s24, 32768
    buffer_load_dwordx4 v240, s[76:79], s24 offen lds
    s_add_u32 m0, m0, 1024
    s_add_u32 s24, s24, 32768
    buffer_load_dwordx4 v240, s[76:79], s24 offen lds
    s_add_u32 m0, m0, 1024
    s_add_u32 s24, s24, 32768
    buffer_load_dwordx4 v240, s[76:79], s24 offen lds
    s_add_u32 m0, m0, 1024
    s_add_u32 s24, s24, 32768
    buffer_load_dwordx4 v240, s[76:79], s24 offen lds
    s_add_u32 m0, m0, 1024
    s_add_u32 s24, s24, 32768
    buffer_load_dwordx4 v240, s[76:79], s24 offen lds
    s_add_u32 m0, m0, 1024
    s_add_u32 s24, s24, 32768
    buffer_load_dwordx4 v240, s[76:79], s24 offen lds
    s_add_u32 m0, m0, 1024
    s_add_u32 s24, s24, 32768
    buffer_load_dwordx4 v240, s[76:79], s24 offen lds
    s_add_u32 m0, m0, 1024
    s_add_u32 s24, s24, 32768
    buffer_load_dwordx4 v240, s[76:79], s24 offen lds
    s_add_u32 m0, m0, 1024
    s_add_u32 s24, s24, 32768
    buffer_load_dwordx4 v240, s[76:79], s24 offen lds
    s_add_u32 m0, m0, 1024
    s_add_u32 s24, s24, 32768
    buffer_load_dwordx4 v240, s[76:79], s24 offen lds
    s_add_u32 m0, m0, 1024
    s_add_u32 s24, s24, 32768
    buffer_load_dwordx4 v240, s[76:79], s24 offen lds
    s_mul_i32 s24, s3, 1835008
    s_lshl_b32 s27, s20, 7
    s_add_u32 s24, s24, s27
    s_add_u32 s24, s24, 1310720
    s_mul_i32 s27, s3, 28672
    s_add_u32 s27, s27, 49152
    s_mov_b32 m0, s27
    s_nop 0
    buffer_load_dwordx4 v240, s[76:79], s24 offen lds
    s_add_u32 m0, m0, 1024
    s_add_u32 s24, s24, 32768
    buffer_load_dwordx4 v240, s[76:79], s24 offen lds
    s_add_u32 m0, m0, 1024
    s_add_u32 s24, s24, 32768
    buffer_load_dwordx4 v240, s[76:79], s24 offen lds
    s_add_u32 m0, m0, 1024
    s_add_u32 s24, s24, 32768
    buffer_load_dwordx4 v240, s[76:79], s24 offen lds
    s_add_u32 m0, m0, 1024
    s_add_u32 s24, s24, 32768
    buffer_load_dwordx4 v240, s[76:79], s24 offen lds
    s_add_u32 m0, m0, 1024
    s_add_u32 s24, s24, 32768
    buffer_load_dwordx4 v240, s[76:79], s24 offen lds
    s_add_u32 m0, m0, 1024
    s_add_u32 s24, s24, 32768
    buffer_load_dwordx4 v240, s[76:79], s24 offen lds
    s_add_u32 m0, m0, 1024
    s_add_u32 s24, s24, 32768
    buffer_load_dwordx4 v240, s[76:79], s24 offen lds
    s_add_u32 m0, m0, 1024
    s_add_u32 s24, s24, 32768
    buffer_load_dwordx4 v240, s[76:79], s24 offen lds
    s_add_u32 m0, m0, 1024
    s_add_u32 s24, s24, 32768
    buffer_load_dwordx4 v240, s[76:79], s24 offen lds
    s_add_u32 m0, m0, 1024
    s_add_u32 s24, s24, 32768
    buffer_load_dwordx4 v240, s[76:79], s24 offen lds
    s_add_u32 m0, m0, 1024
    s_add_u32 s24, s24, 32768
    buffer_load_dwordx4 v240, s[76:79], s24 offen lds
    s_add_u32 m0, m0, 1024
    s_add_u32 s24, s24, 32768
    buffer_load_dwordx4 v240, s[76:79], s24 offen lds
    s_add_u32 m0, m0, 1024
    s_add_u32 s24, s24, 32768
    buffer_load_dwordx4 v240, s[76:79], s24 offen lds
    s_add_u32 m0, m0, 1024
    s_add_u32 s24, s24, 32768
    buffer_load_dwordx4 v240, s[76:79], s24 offen lds
    s_add_u32 m0, m0, 1024
    s_add_u32 s24, s24, 32768
    buffer_load_dwordx4 v240, s[76:79], s24 offen lds
    s_branch L_end_prof
L_idle_load:
    v_lshrrev_b32 v2, 3, v1
    v_mul_u32_u24 v2, 4096, v2
    v_bfe_u32 v3, v1, 4, 1
    v_lshlrev_b32 v3, 2, v3
    v_and_b32 v240, 7, v1
    v_xor_b32_e64 v240, v240, v3
    v_lshl_add_u32 v240, v240, 4, v2
    v_bfe_u32 v2, v1, 2, 2
    v_lshrrev_b32 v3, 5, v1
    v_lshl_add_u32 v3, v3, 2, v2
    v_lshlrev_b32 v3, 7, v3
    v_lshrrev_b32_e64 v2, 1, v2
    v_lshl_add_u32 v3, v2, 6, v3
    v_bfe_u32 v2, v1, 4, 1
    v_lshl_add_u32 v3, v2, 5, v3
    v_and_b32_e64 v2, 3, v1
    v_lshl_add_u32 v3, v2, 3, v3
    s_mul_i32 s9, s3, 28672
    s_add_u32 s9, s9, 49152
    v_add_u32 v241, s9, v3
    v_xor_b32 v242, 64, v241
    s_mul_i32 s9, s3, 12288
    v_add_u32 v243, s9, v3
    v_xor_b32 v229, 64, v243
    s_mul_i32 s24, s3, 1835008
    s_lshl_b32 s27, s20, 7
    s_add_u32 s24, s24, s27
    s_mul_i32 s27, s3, 28672
    s_add_u32 s27, s27, 49152
    s_add_u32 s25, s27, 28672
    s_mul_i32 s71, s23, 65536
    s_add_u32 s24, s24, s71
    s_lshl_b32 s71, s23, 11
    s_add_u32 m0, s27, s71
    s_nop 0
    buffer_load_dwordx4 v240, s[76:79], s24 offen lds
    s_add_u32 m0, m0, 1024
    s_add_u32 s24, s24, 32768
    buffer_load_dwordx4 v240, s[76:79], s24 offen lds
    s_add_u32 m0, m0, 1024
    s_add_u32 s24, s24, 32768
    s_cmp_eq_u32 m0, s25
    s_nop 0
    s_cselect_b32 s71, 28672, 0
    s_cselect_b32 s27, 917504, 0
    s_sub_u32 m0, m0, s71
    s_sub_u32 s24, s24, s27
    buffer_load_dwordx4 v240, s[76:79], s24 offen lds
    s_add_u32 m0, m0, 1024
    s_add_u32 s24, s24, 32768
    buffer_load_dwordx4 v240, s[76:79], s24 offen lds
    s_add_u32 m0, m0, 1024
    s_add_u32 s24, s24, 32768
    s_cmp_eq_u32 m0, s25
    s_nop 0
    s_cselect_b32 s71, 28672, 0
    s_cselect_b32 s27, 917504, 0
    s_sub_u32 m0, m0, s71
    s_sub_u32 s24, s24, s27
    buffer_load_dwordx4 v240, s[76:79], s24 offen lds
    s_add_u32 m0, m0, 1024
    s_add_u32 s24, s24, 32768
    buffer_load_dwordx4 v240, s[76:79], s24 offen lds
    s_add_u32 m0, m0, 1024
    s_add_u32 s24, s24, 32768
    s_cmp_eq_u32 m0, s25
    s_nop 0
    s_cselect_b32 s71, 28672, 0
    s_cselect_b32 s27, 917504, 0
    s_sub_u32 m0, m0, s71
    s_sub_u32 s24, s24, s27
    buffer_load_dwordx4 v240, s[76:79], s24 offen lds
    s_add_u32 m0, m0, 1024
    s_add_u32 s24, s24, 32768
    buffer_load_dwordx4 v240, s[76:79], s24 offen lds
    s_add_u32 m0, m0, 1024
    s_add_u32 s24, s24, 32768
    s_cmp_eq_u32 m0, s25
    s_nop 0
    s_cselect_b32 s71, 28672, 0
    s_cselect_b32 s27, 917504, 0
    s_sub_u32 m0, m0, s71
    s_sub_u32 s24, s24, s27
    buffer_load_dwordx4 v240, s[76:79], s24 offen lds
    s_add_u32 m0, m0, 1024
    s_add_u32 s24, s24, 32768
    buffer_load_dwordx4 v240, s[76:79], s24 offen lds
    s_add_u32 m0, m0, 1024
    s_add_u32 s24, s24, 32768
    s_cmp_eq_u32 m0, s25
    s_nop 0
    s_cselect_b32 s71, 28672, 0
    s_cselect_b32 s27, 917504, 0
    s_sub_u32 m0, m0, s71
    s_sub_u32 s24, s24, s27
    buffer_load_dwordx4 v240, s[76:79], s24 offen lds
    s_add_u32 m0, m0, 1024
    s_add_u32 s24, s24, 32768
    buffer_load_dwordx4 v240, s[76:79], s24 offen lds
    s_add_u32 m0, m0, 1024
    s_add_u32 s24, s24, 32768
    s_cmp_eq_u32 m0, s25
    s_nop 0
    s_cselect_b32 s71, 28672, 0
    s_cselect_b32 s27, 917504, 0
    s_sub_u32 m0, m0, s71
    s_sub_u32 s24, s24, s27
    buffer_load_dwordx4 v240, s[76:79], s24 offen lds
    s_add_u32 m0, m0, 1024
    s_add_u32 s24, s24, 32768
    buffer_load_dwordx4 v240, s[76:79], s24 offen lds
    s_add_u32 m0, m0, 1024
    s_add_u32 s24, s24, 32768
    s_cmp_eq_u32 m0, s25
    s_nop 0
    s_cselect_b32 s71, 28672, 0
    s_cselect_b32 s27, 917504, 0
    s_sub_u32 m0, m0, s71
    s_sub_u32 s24, s24, s27
    buffer_load_dwordx4 v240, s[76:79], s24 offen lds
    s_add_u32 m0, m0, 1024
    s_add_u32 s24, s24, 32768
    buffer_load_dwordx4 v240, s[76:79], s24 offen lds
    s_add_u32 m0, m0, 1024
    s_add_u32 s24, s24, 32768
    s_cmp_eq_u32 m0, s25
    s_nop 0
    s_cselect_b32 s71, 28672, 0
    s_cselect_b32 s27, 917504, 0
    s_sub_u32 m0, m0, s71
    s_sub_u32 s24, s24, s27
    buffer_load_dwordx4 v240, s[76:79], s24 offen lds
    s_add_u32 m0, m0, 1024
    s_add_u32 s24, s24, 32768
    buffer_load_dwordx4 v240, s[76:79], s24 offen lds
    s_add_u32 m0, m0, 1024
    s_add_u32 s24, s24, 32768
    s_cmp_eq_u32 m0, s25
    s_nop 0
    s_cselect_b32 s71, 28672, 0
    s_cselect_b32 s27, 917504, 0
    s_sub_u32 m0, m0, s71
    s_sub_u32 s24, s24, s27
    buffer_load_dwordx4 v240, s[76:79], s24 offen lds
    s_add_u32 m0, m0, 1024
    s_add_u32 s24, s24, 32768
    buffer_load_dwordx4 v240, s[76:79], s24 offen lds
    s_add_u32 m0, m0, 1024
    s_add_u32 s24, s24, 32768
    s_cmp_eq_u32 m0, s25
    s_nop 0
    s_cselect_b32 s71, 28672, 0
    s_cselect_b32 s27, 917504, 0
    s_sub_u32 m0, m0, s71
    s_sub_u32 s24, s24, s27
    buffer_load_dwordx4 v240, s[76:79], s24 offen lds
    s_add_u32 m0, m0, 1024
    s_add_u32 s24, s24, 32768
    buffer_load_dwordx4 v240, s[76:79], s24 offen lds
    s_add_u32 m0, m0, 1024
    s_add_u32 s24, s24, 32768
    s_cmp_eq_u32 m0, s25
    s_nop 0
    s_cselect_b32 s71, 28672, 0
    s_cselect_b32 s27, 917504, 0
    s_sub_u32 m0, m0, s71
    s_sub_u32 s24, s24, s27
    buffer_load_dwordx4 v240, s[76:79], s24 offen lds
    s_add_u32 m0, m0, 1024
    s_add_u32 s24, s24, 32768
    buffer_load_dwordx4 v240, s[76:79], s24 offen lds
    s_add_u32 m0, m0, 1024
    s_add_u32 s24, s24, 32768
    s_cmp_eq_u32 m0, s25
    s_nop 0
    s_cselect_b32 s71, 28672, 0
    s_cselect_b32 s27, 917504, 0
    s_sub_u32 m0, m0, s71
    s_sub_u32 s24, s24, s27
    buffer_load_dwordx4 v240, s[76:79], s24 offen lds
    s_add_u32 m0, m0, 1024
    s_add_u32 s24, s24, 32768
    buffer_load_dwordx4 v240, s[76:79], s24 offen lds
    s_add_u32 m0, m0, 1024
    s_add_u32 s24, s24, 32768
    s_cmp_eq_u32 m0, s25
    s_nop 0
    s_cselect_b32 s71, 28672, 0
    s_cselect_b32 s27, 917504, 0
    s_sub_u32 m0, m0, s71
    s_sub_u32 s24, s24, s27
    buffer_load_dwordx4 v240, s[76:79], s24 offen lds
    s_add_u32 m0, m0, 1024
    s_add_u32 s24, s24, 32768
    buffer_load_dwordx4 v240, s[76:79], s24 offen lds
    s_mul_i32 s24, s3, 1835008
    s_lshl_b32 s27, s20, 7
    s_add_u32 s24, s24, s27
    s_add_u32 s24, s24, 917504
    s_mul_i32 s27, s3, 12288
    s_mov_b32 m0, s27
    s_nop 0
    buffer_load_dwordx4 v240, s[76:79], s24 offen lds
    s_add_u32 m0, m0, 1024
    s_add_u32 s24, s24, 32768
    buffer_load_dwordx4 v240, s[76:79], s24 offen lds
    s_add_u32 m0, m0, 1024
    s_add_u32 s24, s24, 32768
    buffer_load_dwordx4 v240, s[76:79], s24 offen lds
    s_add_u32 m0, m0, 1024
    s_add_u32 s24, s24, 32768
    buffer_load_dwordx4 v240, s[76:79], s24 offen lds
    s_add_u32 m0, m0, 1024
    s_add_u32 s24, s24, 32768
    buffer_load_dwordx4 v240, s[76:79], s24 offen lds
    s_add_u32 m0, m0, 1024
    s_add_u32 s24, s24, 32768
    buffer_load_dwordx4 v240, s[76:79], s24 offen lds
    s_add_u32 m0, m0, 1024
    s_add_u32 s24, s24, 32768
    buffer_load_dwordx4 v240, s[76:79], s24 offen lds
    s_add_u32 m0, m0, 1024
    s_add_u32 s24, s24, 32768
    buffer_load_dwordx4 v240, s[76:79], s24 offen lds
    s_add_u32 m0, m0, 1024
    s_add_u32 s24, s24, 32768
    buffer_load_dwordx4 v240, s[76:79], s24 offen lds
    s_add_u32 m0, m0, 1024
    s_add_u32 s24, s24, 32768
    buffer_load_dwordx4 v240, s[76:79], s24 offen lds
    s_add_u32 m0, m0, 1024
    s_add_u32 s24, s24, 32768
    buffer_load_dwordx4 v240, s[76:79], s24 offen lds
    s_add_u32 m0, m0, 1024
    s_add_u32 s24, s24, 32768
    buffer_load_dwordx4 v240, s[76:79], s24 offen lds
    s_waitcnt vmcnt(12)
L_g1_done:
    s_nop 0
    ds_read_b64_tr_b16 a[0:1], v241 offset:0
    ds_read_b64_tr_b16 a[2:3], v241 offset:1024
    ds_read_b64_tr_b16 a[4:5], v242 offset:0
    ds_read_b64_tr_b16 a[6:7], v242 offset:1024
    ds_read_b64_tr_b16 a[8:9], v241 offset:2048
    ds_read_b64_tr_b16 a[10:11], v241 offset:3072
    ds_read_b64_tr_b16 a[12:13], v242 offset:2048
    ds_read_b64_tr_b16 a[14:15], v242 offset:3072
    ds_read_b64_tr_b16 a[16:17], v241 offset:4096
    ds_read_b64_tr_b16 a[18:19], v241 offset:5120
    ds_read_b64_tr_b16 a[20:21], v242 offset:4096
    ds_read_b64_tr_b16 a[22:23], v242 offset:5120
    ds_read_b64_tr_b16 a[24:25], v241 offset:6144
    ds_read_b64_tr_b16 a[26:27], v241 offset:7168
    ds_read_b64_tr_b16 a[28:29], v242 offset:6144
    ds_read_b64_tr_b16 a[30:31], v242 offset:7168
    ds_read_b64_tr_b16 a[32:33], v241 offset:8192
    ds_read_b64_tr_b16 a[34:35], v241 offset:9216
    ds_read_b64_tr_b16 a[36:37], v242 offset:8192
    ds_read_b64_tr_b16 a[38:39], v242 offset:9216
    ds_read_b64_tr_b16 a[40:41], v241 offset:10240
    ds_read_b64_tr_b16 a[42:43], v241 offset:11264
    ds_read_b64_tr_b16 a[44:45], v242 offset:10240
    ds_read_b64_tr_b16 a[46:47], v242 offset:11264
    ds_read_b64_tr_b16 a[48:49], v241 offset:12288
    ds_read_b64_tr_b16 a[50:51], v241 offset:13312
    ds_read_b64_tr_b16 a[52:53], v242 offset:12288
    ds_read_b64_tr_b16 a[54:55], v242 offset:13312
    ds_read_b64_tr_b16 a[56:57], v241 offset:14336
    ds_read_b64_tr_b16 a[58:59], v241 offset:15360
    ds_read_b64_tr_b16 a[60:61], v242 offset:14336
    ds_read_b64_tr_b16 a[62:63], v242 offset:15360
    ds_read_b64_tr_b16 a[64:65], v241 offset:16384
    ds_read_b64_tr_b16 a[66:67], v241 offset:17408
    ds_read_b64_tr_b16 a[68:69], v242 offset:16384
    ds_read_b64_tr_b16 a[70:71], v242 offset:17408
    ds_read_b64_tr_b16 a[72:73], v241 offset:18432
    ds_read_b64_tr_b16 a[74:75], v241 offset:19456
    ds_read_b64_tr_b16 a[76:77], v242 offset:18432
    ds_read_b64_tr_b16 a[78:79], v242 offset:19456
    ds_read_b64_tr_b16 a[80:81], v241 offset:20480
    ds_read_b64_tr_b16 a[82:83], v241 offset:21504
    ds_read_b64_tr_b16 a[84:85], v242 offset:20480
    ds_read_b64_tr_b16 a[86:87], v242 offset:21504
    ds_read_b64_tr_b16 a[88:89], v241 offset:22528
    ds_read_b64_tr_b16 a[90:91], v241 offset:23552
    ds_read_b64_tr_b16 a[92:93], v242 offset:22528
    ds_read_b64_tr_b16 a[94:95], v242 offset:23552
    ds_read_b64_tr_b16 a[96:97], v241 offset:24576
    ds_read_b64_tr_b16 a[98:99], v241 offset:25600
    ds_read_b64_tr_b16 a[100:101], v242 offset:24576
    ds_read_b64_tr_b16 a[102:103], v242 offset:25600
    ds_read_b64_tr_b16 a[104:105], v241 offset:26624
    ds_read_b64_tr_b16 a[106:107], v241 offset:27648
    ds_read_b64_tr_b16 a[108:109], v242 offset:26624
    ds_read_b64_tr_b16 a[110:111], v242 offset:27648
    s_waitcnt lgkmcnt(0)
    s_mul_i32 s24, s3, 1835008
    s_lshl_b32 s27, s20, 7
    s_add_u32 s24, s24, s27
    s_nop 0
    s_add_u32 s24, s24, 1310720
    s_mul_i32 s27, s3, 28672
    s_add_u32 s27, s27, 49152
    s_mov_b32 m0, s27
    s_nop 0
    buffer_load_dwordx4 v240, s[76:79], s24 offen lds
    s_add_u32 m0, m0, 1024
    s_add_u32 s24, s24, 32768
    buffer_load_dwordx4 v240, s[76:79], s24 offen lds
    s_add_u32 m0, m0, 1024
    s_add_u32 s24, s24, 32768
    buffer_load_dwordx4 v240, s[76:79], s24 offen lds
    s_add_u32 m0, m0, 1024
    s_add_u32 s24, s24, 32768
    buffer_load_dwordx4 v240, s[76:79], s24 offen lds
    s_add_u32 m0, m0, 1024
    s_add_u32 s24, s24, 32768
    buffer_load_dwordx4 v240, s[76:79], s24 offen lds
    s_add_u32 m0, m0, 1024
    s_add_u32 s24, s24, 32768
    buffer_load_dwordx4 v240, s[76:79], s24 offen lds
    s_add_u32 m0, m0, 1024
    s_add_u32 s24, s24, 32768
    buffer_load_dwordx4 v240, s[76:79], s24 offen lds
    s_add_u32 m0, m0, 1024
    s_add_u32 s24, s24, 32768
    buffer_load_dwordx4 v240, s[76:79], s24 offen lds
    s_add_u32 m0, m0, 1024
    s_add_u32 s24, s24, 32768
    buffer_load_dwordx4 v240, s[76:79], s24 offen lds
    s_add_u32 m0, m0, 1024
    s_add_u32 s24, s24, 32768
    buffer_load_dwordx4 v240, s[76:79], s24 offen lds
    s_add_u32 m0, m0, 1024
    s_add_u32 s24, s24, 32768
    buffer_load_dwordx4 v240, s[76:79], s24 offen lds
    s_add_u32 m0, m0, 1024
    s_add_u32 s24, s24, 32768
    buffer_load_dwordx4 v240, s[76:79], s24 offen lds
    s_add_u32 m0, m0, 1024
    s_add_u32 s24, s24, 32768
    buffer_load_dwordx4 v240, s[76:79], s24 offen lds
    s_add_u32 m0, m0, 1024
    s_add_u32 s24, s24, 32768
    buffer_load_dwordx4 v240, s[76:79], s24 offen lds
    s_add_u32 m0, m0, 1024
    s_add_u32 s24, s24, 32768
    buffer_load_dwordx4 v240, s[76:79], s24 offen lds
    s_add_u32 m0, m0, 1024
    s_add_u32 s24, s24, 32768
    buffer_load_dwordx4 v240, s[76:79], s24 offen lds
    v_lshlrev_b32_e64 v12, 4, v1
    v_add_u32 v13, 114688, v12
    s_mul_i32 s26, s19, 229376
    s_mul_i32 s27, s3, 28672
    s_add_u32 s26, s26, s27
    s_add_u32 s26, s26, 9437184
    s_mov_b32 s28, s26
    s_mov_b32 s60, s38
    s_mov_b32 s61, s39
    s_mov_b32 s62, 4096
    s_mov_b32 s63, 0x20000
    v_and_b32 v2, 31, v1
    s_and_b32 s10, s3, 1
    s_lshl_b32 s10, s10, 5
    s_lshl_b32 s9, s20, 6
    s_add_u32 s9, s9, s10
    v_add_u32 v28, s9, v2
    v_lshlrev_b32 v2, 1, v28
    buffer_load_ushort v29, v2, s[60:63], 0 offen
    v_lshrrev_b32 v3, 5, v1
    v_lshlrev_b32 v3, 3, v3
    v_lshl_add_u32 v31, v28, 4, v3
    s_lshl_b32 s9, s19, 1
    s_lshr_b32 s10, s3, 1
    s_add_u32 s9, s9, s10
    s_lshl_b32 s9, s9, 17
    s_add_u32 s29, s9, 7340032
    v_and_b32 v2, 7, v1
    s_lshl_b32 s9, s20, 3
    v_add_u32 v2, s9, v2
    v_lshlrev_b32_e64 v30, 7, v2
    s_mov_b32 s9, 65536
    buffer_load_dword v250, v30, s[52:55], s9 offen sc1
    s_mov_b32 s12, 0
L_g2_spin:
    s_mov_b32 s26, s28
    buffer_load_dwordx4 v[32:35], v12, s[52:55], s26 offen offset:0 sc1
    buffer_load_dwordx4 v[36:39], v13, s[52:55], s26 offen offset:0 sc1
    buffer_load_dwordx4 v[40:43], v12, s[52:55], s26 offen offset:1024 sc1
    buffer_load_dwordx4 v[44:47], v13, s[52:55], s26 offen offset:1024 sc1
    buffer_load_dwordx4 v[48:51], v12, s[52:55], s26 offen offset:2048 sc1
    buffer_load_dwordx4 v[52:55], v13, s[52:55], s26 offen offset:2048 sc1
    buffer_load_dwordx4 v[56:59], v12, s[52:55], s26 offen offset:3072 sc1
    buffer_load_dwordx4 v[60:63], v13, s[52:55], s26 offen offset:3072 sc1
    s_add_u32 s26, s26, 4096
    buffer_load_dwordx4 v[64:67], v12, s[52:55], s26 offen offset:0 sc1
    buffer_load_dwordx4 v[68:71], v13, s[52:55], s26 offen offset:0 sc1
    buffer_load_dwordx4 v[72:75], v12, s[52:55], s26 offen offset:1024 sc1
    buffer_load_dwordx4 v[76:79], v13, s[52:55], s26 offen offset:1024 sc1
    s_waitcnt vmcnt(0)
    s_nop 0
    v_max3_u32 v2, v32, v33, v34
    v_max3_u32 v2, v2, v35, v36
    v_max3_u32 v2, v2, v37, v38
    v_max3_u32 v2, v2, v39, v40
    v_max3_u32 v2, v2, v41, v42
    v_max3_u32 v2, v2, v43, v44
    v_max3_u32 v2, v2, v45, v46
    v_max3_u32 v2, v2, v47, v48
    v_max3_u32 v2, v2, v49, v50
    v_max3_u32 v2, v2, v51, v52
    v_max3_u32 v2, v2, v53, v54
    v_max3_u32 v2, v2, v55, v56
    v_max3_u32 v2, v2, v57, v58
    v_max3_u32 v2, v2, v59, v60
    v_max3_u32 v2, v2, v61, v62
    v_max3_u32 v2, v2, v63, v64
    v_max3_u32 v2, v2, v65, v66
    v_max3_u32 v2, v2, v67, v68
    v_max3_u32 v2, v2, v69, v70
    v_max3_u32 v2, v2, v71, v72
    v_max3_u32 v2, v2, v73, v74
    v_max3_u32 v2, v2, v75, v76
    v_max3_u32 v2, v2, v77, v78
    v_max_u32 v2, v2, v79
    v_cmp_eq_u32 vcc, -1, v2
    s_cbranch_vccz L_g2_go
L_g2_gate:
    s_add_u32 s12, s12, 1
    s_cmp_gt_u32 s12, 131072
    s_cbranch_scc1 L_g2_go
    buffer_load_dwordx4 v[32:35], v12, s[52:55], s28 offen sc1
    s_waitcnt vmcnt(0)
    v_max3_u32 v2, v32, v33, v34
    v_max_u32 v2, v2, v35
    v_cmp_eq_u32 vcc, -1, v2
    s_cbranch_vccnz L_g2_gate
    s_branch L_g2_spin
L_g2_go:
    s_mov_b32 s12, 0
L_hflag:
    v_cmp_ne_u32 vcc, s8, v250
    s_cbranch_vccz L_hflag_ok
    s_add_u32 s12, s12, 1
    s_cmp_gt_u32 s12, 131072
    s_cbranch_scc1 L_hflag_ok
    s_nop 0
    s_mov_b32 s9, 65536
    buffer_load_dword v250, v30, s[52:55], s9 offen sc1
    s_waitcnt vmcnt(0)
    s_branch L_hflag
L_hflag_ok:
    s_mov_b32 s9, s29
    s_nop 0
    buffer_load_dwordx2 v[20:21], v31, s[52:55], s9 offen sc1
    s_add_u32 s9, s9, 32768
    buffer_load_dwordx2 v[22:23], v31, s[52:55], s9 offen sc1
    s_add_u32 s9, s9, 32768
    buffer_load_dwordx2 v[24:25], v31, s[52:55], s9 offen sc1
    s_add_u32 s9, s9, 32768
    buffer_load_dwordx2 v[26:27], v31, s[52:55], s9 offen sc1
    s_mov_b32 s12, 0
    s_nop 0
    v_mfma_f32_32x32x16_bf16 v[128:143], v[32:35], a[0:3], 0
    ds_read_b64_tr_b16 a[112:113], v243 offset:0
    v_mfma_f32_32x32x16_bf16 v[144:159], v[32:35], a[4:7], 0
    ds_read_b64_tr_b16 a[114:115], v243 offset:1024
    v_mfma_f32_32x32x16_bf16 v[160:175], v[36:39], a[0:3], 0
    ds_read_b64_tr_b16 a[116:117], v229 offset:0
    v_mfma_f32_32x32x16_bf16 v[176:191], v[36:39], a[4:7], 0
    ds_read_b64_tr_b16 a[118:119], v229 offset:1024
    buffer_load_dwordx4 v[32:35], v12, s[52:55], s26 offen offset:2048 sc1
    buffer_load_dwordx4 v[36:39], v13, s[52:55], s26 offen offset:2048 sc1
    v_mfma_f32_32x32x16_bf16 v[128:143], v[40:43], a[8:11], v[128:143]
    ds_read_b64_tr_b16 a[120:121], v243 offset:2048
    v_mfma_f32_32x32x16_bf16 v[144:159], v[40:43], a[12:15], v[144:159]
    ds_read_b64_tr_b16 a[122:123], v243 offset:3072
    v_mfma_f32_32x32x16_bf16 v[160:175], v[44:47], a[8:11], v[160:175]
    ds_read_b64_tr_b16 a[124:125], v229 offset:2048
    v_mfma_f32_32x32x16_bf16 v[176:191], v[44:47], a[12:15], v[176:191]
    ds_read_b64_tr_b16 a[126:127], v229 offset:3072
    buffer_load_dwordx4 v[40:43], v12, s[52:55], s26 offen offset:3072 sc1
    buffer_load_dwordx4 v[44:47], v13, s[52:55], s26 offen offset:3072 sc1
    s_add_u32 s26, s26, 4096
    v_mfma_f32_32x32x16_bf16 v[128:143], v[48:51], a[16:19], v[128:143]
    ds_read_b64_tr_b16 a[128:129], v243 offset:4096
    v_mfma_f32_32x32x16_bf16 v[144:159], v[48:51], a[20:23], v[144:159]
    ds_read_b64_tr_b16 a[130:131], v243 offset:5120
    v_mfma_f32_32x32x16_bf16 v[160:175], v[52:55], a[16:19], v[160:175]
    ds_read_b64_tr_b16 a[132:133], v229 offset:4096
    v_mfma_f32_32x32x16_bf16 v[176:191], v[52:55], a[20:23], v[176:191]
    ds_read_b64_tr_b16 a[134:135], v229 offset:5120
    buffer_load_dwordx4 v[48:51], v12, s[52:55], s26 offen offset:0 sc1
    buffer_load_dwordx4 v[52:55], v13, s[52:55], s26 offen offset:0 sc1
    v_mfma_f32_32x32x16_bf16 v[128:143], v[56:59], a[24:27], v[128:143]
    ds_read_b64_tr_b16 a[136:137], v243 offset:6144
    v_mfma_f32_32x32x16_bf16 v[144:159], v[56:59], a[28:31], v[144:159]
    ds_read_b64_tr_b16 a[138:139], v243 offset:7168
    v_mfma_f32_32x32x16_bf16 v[160:175], v[60:63], a[24:27], v[160:175]
    ds_read_b64_tr_b16 a[140:141], v229 offset:6144
    v_mfma_f32_32x32x16_bf16 v[176:191], v[60:63], a[28:31], v[176:191]
    ds_read_b64_tr_b16 a[142:143], v229 offset:7168
    buffer_load_dwordx4 v[56:59], v12, s[52:55], s26 offen offset:1024 sc1
    buffer_load_dwordx4 v[60:63], v13, s[52:55], s26 offen offset:1024 sc1
    v_mfma_f32_32x32x16_bf16 v[128:143], v[64:67], a[32:35], v[128:143]
    ds_read_b64_tr_b16 a[144:145], v243 offset:8192
    v_mfma_f32_32x32x16_bf16 v[144:159], v[64:67], a[36:39], v[144:159]
    ds_read_b64_tr_b16 a[146:147], v243 offset:9216
    v_mfma_f32_32x32x16_bf16 v[160:175], v[68:71], a[32:35], v[160:175]
    ds_read_b64_tr_b16 a[148:149], v229 offset:8192
    v_mfma_f32_32x32x16_bf16 v[176:191], v[68:71], a[36:39], v[176:191]
    ds_read_b64_tr_b16 a[150:151], v229 offset:9216
    buffer_load_dwordx4 v[64:67], v12, s[52:55], s26 offen offset:2048 sc1
    buffer_load_dwordx4 v[68:71], v13, s[52:55], s26 offen offset:2048 sc1
    v_mfma_f32_32x32x16_bf16 v[128:143], v[72:75], a[40:43], v[128:143]
    ds_read_b64_tr_b16 a[152:153], v243 offset:10240
    s_waitcnt vmcnt(8)
    s_nop 0
    v_mfma_f32_32x32x16_bf16 v[144:159], v[72:75], a[44:47], v[144:159]
    ds_read_b64_tr_b16 a[154:155], v243 offset:11264
    v_max3_u32 v2, v32, v33, v34
    v_max3_u32 v3, v35, v36, v37
    v_mfma_f32_32x32x16_bf16 v[160:175], v[76:79], a[40:43], v[160:175]
    ds_read_b64_tr_b16 a[156:157], v229 offset:10240
    v_max3_u32 v2, v2, v38, v39
    v_max_u32 v2, v2, v3
    v_cmp_eq_u32 vcc, -1, v2
    v_mfma_f32_32x32x16_bf16 v[176:191], v[76:79], a[44:47], v[176:191]
    ds_read_b64_tr_b16 a[158:159], v229 offset:11264
    buffer_load_dwordx4 v[72:75], v12, s[52:55], s26 offen offset:3072 sc1
    buffer_load_dwordx4 v[76:79], v13, s[52:55], s26 offen offset:3072 sc1
    s_add_u32 s26, s26, 4096
    s_cbranch_vccnz L_g2_slow6
L_g2_back6:
    s_nop 0
    v_mfma_f32_32x32x16_bf16 v[128:143], v[32:35], a[48:51], v[128:143]
    ds_read_b64_tr_b16 a[160:161], v241 offset:0
    s_waitcnt vmcnt(8)
    s_nop 0
    v_mfma_f32_32x32x16_bf16 v[144:159], v[32:35], a[52:55], v[144:159]
    ds_read_b64_tr_b16 a[162:163], v241 offset:1024
    v_max3_u32 v2, v40, v41, v42
    v_max3_u32 v3, v43, v44, v45
    v_mfma_f32_32x32x16_bf16 v[160:175], v[36:39], a[48:51], v[160:175]
    ds_read_b64_tr_b16 a[164:165], v242 offset:0
    v_max3_u32 v2, v2, v46, v47
    v_max_u32 v2, v2, v3
    v_cmp_eq_u32 vcc, -1, v2
    v_mfma_f32_32x32x16_bf16 v[176:191], v[36:39], a[52:55], v[176:191]
    ds_read_b64_tr_b16 a[166:167], v242 offset:1024
    buffer_load_dwordx4 v[32:35], v12, s[52:55], s26 offen offset:0 sc1
    buffer_load_dwordx4 v[36:39], v13, s[52:55], s26 offen offset:0 sc1
    s_cbranch_vccnz L_g2_slow7
L_g2_back7:
    s_nop 0
    v_mfma_f32_32x32x16_bf16 v[128:143], v[40:43], a[56:59], v[128:143]
    ds_read_b64_tr_b16 a[168:169], v241 offset:2048
    s_waitcnt vmcnt(8)
    s_nop 0
    v_mfma_f32_32x32x16_bf16 v[144:159], v[40:43], a[60:63], v[144:159]
    ds_read_b64_tr_b16 a[170:171], v241 offset:3072
    v_max3_u32 v2, v48, v49, v50
    v_max3_u32 v3, v51, v52, v53
    v_mfma_f32_32x32x16_bf16 v[160:175], v[44:47], a[56:59], v[160:175]
    ds_read_b64_tr_b16 a[172:173], v242 offset:2048
    v_max3_u32 v2, v2, v54, v55
    v_max_u32 v2, v2, v3
    v_cmp_eq_u32 vcc, -1, v2
    v_mfma_f32_32x32x16_bf16 v[176:191], v[44:47], a[60:63], v[176:191]
    ds_read_b64_tr_b16 a[174:175], v242 offset:3072
    buffer_load_dwordx4 v[40:43], v12, s[52:55], s26 offen offset:1024 sc1
    buffer_load_dwordx4 v[44:47], v13, s[52:55], s26 offen offset:1024 sc1
    s_cbranch_vccnz L_g2_slow8
L_g2_back8:
    s_nop 0
    v_mfma_f32_32x32x16_bf16 v[128:143], v[48:51], a[64:67], v[128:143]
    ds_read_b64_tr_b16 a[176:177], v241 offset:4096
    s_waitcnt vmcnt(8)
    s_nop 0
    v_mfma_f32_32x32x16_bf16 v[144:159], v[48:51], a[68:71], v[144:159]
    ds_read_b64_tr_b16 a[178:179], v241 offset:5120
    v_max3_u32 v2, v56, v57, v58
    v_max3_u32 v3, v59, v60, v61
    v_mfma_f32_32x32x16_bf16 v[160:175], v[52:55], a[64:67], v[160:175]
    ds_read_b64_tr_b16 a[180:181], v242 offset:4096
    v_max3_u32 v2, v2, v62, v63
    v_max_u32 v2, v2, v3
    v_cmp_eq_u32 vcc, -1, v2
    v_mfma_f32_32x32x16_bf16 v[176:191], v[52:55], a[68:71], v[176:191]
    ds_read_b64_tr_b16 a[182:183], v242 offset:5120
    buffer_load_dwordx4 v[48:51], v12, s[52:55], s26 offen offset:2048 sc1
    buffer_load_dwordx4 v[52:55], v13, s[52:55], s26 offen offset:2048 sc1
    s_cbranch_vccnz L_g2_slow9
L_g2_back9:
    s_nop 0
    v_mfma_f32_32x32x16_bf16 v[128:143], v[56:59], a[72:75], v[128:143]
    ds_read_b64_tr_b16 a[184:185], v241 offset:6144
    s_waitcnt vmcnt(8)
    s_nop 0
    v_mfma_f32_32x32x16_bf16 v[144:159], v[56:59], a[76:79], v[144:159]
    ds_read_b64_tr_b16 a[186:187], v241 offset:7168
    v_max3_u32 v2, v64, v65, v66
    v_max3_u32 v3, v67, v68, v69
    v_mfma_f32_32x32x16_bf16 v[160:175], v[60:63], a[72:75], v[160:175]
    ds_read_b64_tr_b16 a[188:189], v242 offset:6144
    v_max3_u32 v2, v2, v70, v71
    v_max_u32 v2, v2, v3
    v_cmp_eq_u32 vcc, -1, v2
    v_mfma_f32_32x32x16_bf16 v[176:191], v[60:63], a[76:79], v[176:191]
    ds_read_b64_tr_b16 a[190:191], v242 offset:7168
    buffer_load_dwordx4 v[56:59], v12, s[52:55], s26 offen offset:3072 sc1
    buffer_load_dwordx4 v[60:63], v13, s[52:55], s26 offen offset:3072 sc1
    s_add_u32 s26, s26, 4096
    s_cbranch_vccnz L_g2_slow10
L_g2_back10:
    s_nop 0
    v_mfma_f32_32x32x16_bf16 v[128:143], v[64:67], a[80:83], v[128:143]
    ds_read_b64_tr_b16 a[192:193], v241 offset:8192
    s_waitcnt vmcnt(8)
    s_nop 0
    v_mfma_f32_32x32x16_bf16 v[144:159], v[64:67], a[84:87], v[144:159]
    ds_read_b64_tr_b16 a[194:195], v241 offset:9216
    v_max3_u32 v2, v72, v73, v74
    v_max3_u32 v3, v75, v76, v77
    v_mfma_f32_32x32x16_bf16 v[160:175], v[68:71], a[80:83], v[160:175]
    ds_read_b64_tr_b16 a[196:197], v242 offset:8192
    v_max3_u32 v2, v2, v78, v79
    v_max_u32 v2, v2, v3
    v_cmp_eq_u32 vcc, -1, v2
    v_mfma_f32_32x32x16_bf16 v[176:191], v[68:71], a[84:87], v[176:191]
    ds_read_b64_tr_b16 a[198:199], v242 offset:9216
    buffer_load_dwordx4 v[64:67], v12, s[52:55], s26 offen offset:0 sc1
    buffer_load_dwordx4 v[68:71], v13, s[52:55], s26 offen offset:0 sc1
    s_cbranch_vccnz L_g2_slow11
L_g2_back11:
    s_nop 0
    v_mfma_f32_32x32x16_bf16 v[128:143], v[72:75], a[88:91], v[128:143]
    ds_read_b64_tr_b16 a[200:201], v241 offset:10240
    s_waitcnt vmcnt(8)
    s_nop 0
    v_mfma_f32_32x32x16_bf16 v[144:159], v[72:75], a[92:95], v[144:159]
    ds_read_b64_tr_b16 a[202:203], v241 offset:11264
    v_max3_u32 v2, v32, v33, v34
    v_max3_u32 v3, v35, v36, v37
    v_mfma_f32_32x32x16_bf16 v[160:175], v[76:79], a[88:91], v[160:175]
    ds_read_b64_tr_b16 a[204:205], v242 offset:10240
    v_max3_u32 v2, v2, v38, v39
    v_max_u32 v2, v2, v3
    v_cmp_eq_u32 vcc, -1, v2
    v_mfma_f32_32x32x16_bf16 v[176:191], v[76:79], a[92:95], v[176:191]
    ds_read_b64_tr_b16 a[206:207], v242 offset:11264
    buffer_load_dwordx4 v[72:75], v12, s[52:55], s26 offen offset:1024 sc1
    buffer_load_dwordx4 v[76:79], v13, s[52:55], s26 offen offset:1024 sc1
    s_cbranch_vccnz L_g2_slow12
L_g2_back12:
    s_nop 0
    v_mfma_f32_32x32x16_bf16 v[128:143], v[32:35], a[96:99], v[128:143]
    ds_read_b64_tr_b16 a[208:209], v241 offset:12288
    s_waitcnt vmcnt(8)
    s_nop 0
    v_mfma_f32_32x32x16_bf16 v[144:159], v[32:35], a[100:103], v[144:159]
    ds_read_b64_tr_b16 a[210:211], v241 offset:13312
    v_max3_u32 v2, v40, v41, v42
    v_max3_u32 v3, v43, v44, v45
    v_mfma_f32_32x32x16_bf16 v[160:175], v[36:39], a[96:99], v[160:175]
    ds_read_b64_tr_b16 a[212:213], v242 offset:12288
    v_max3_u32 v2, v2, v46, v47
    v_max_u32 v2, v2, v3
    v_cmp_eq_u32 vcc, -1, v2
    v_mfma_f32_32x32x16_bf16 v[176:191], v[36:39], a[100:103], v[176:191]
    ds_read_b64_tr_b16 a[214:215], v242 offset:13312
    buffer_load_dwordx4 v[32:35], v12, s[52:55], s26 offen offset:2048 sc1
    buffer_load_dwordx4 v[36:39], v13, s[52:55], s26 offen offset:2048 sc1
    s_cbranch_vccnz L_g2_slow13
L_g2_back13:
    s_nop 0
    v_mfma_f32_32x32x16_bf16 v[128:143], v[40:43], a[104:107], v[128:143]
    ds_read_b64_tr_b16 a[216:217], v241 offset:14336
    s_waitcnt vmcnt(8)
    s_nop 0
    v_mfma_f32_32x32x16_bf16 v[144:159], v[40:43], a[108:111], v[144:159]
    ds_read_b64_tr_b16 a[218:219], v241 offset:15360
    v_max3_u32 v2, v48, v49, v50
    v_max3_u32 v3, v51, v52, v53
    v_mfma_f32_32x32x16_bf16 v[160:175], v[44:47], a[104:107], v[160:175]
    ds_read_b64_tr_b16 a[220:221], v242 offset:14336
    v_max3_u32 v2, v2, v54, v55
    v_max_u32 v2, v2, v3
    v_cmp_eq_u32 vcc, -1, v2
    v_mfma_f32_32x32x16_bf16 v[176:191], v[44:47], a[108:111], v[176:191]
    ds_read_b64_tr_b16 a[222:223], v242 offset:15360
    buffer_load_dwordx4 v[40:43], v12, s[52:55], s26 offen offset:3072 sc1
    buffer_load_dwordx4 v[44:47], v13, s[52:55], s26 offen offset:3072 sc1
    s_add_u32 s26, s26, 4096
    s_cbranch_vccnz L_g2_slow14
L_g2_back14:
    s_waitcnt lgkmcnt(0)
    v_mfma_f32_32x32x16_bf16 v[128:143], v[48:51], a[112:115], v[128:143]
    s_waitcnt vmcnt(8)
    s_nop 0
    v_mfma_f32_32x32x16_bf16 v[144:159], v[48:51], a[116:119], v[144:159]
    v_max3_u32 v2, v56, v57, v58
    v_max3_u32 v3, v59, v60, v61
    v_mfma_f32_32x32x16_bf16 v[160:175], v[52:55], a[112:115], v[160:175]
    v_max3_u32 v2, v2, v62, v63
    v_max_u32 v2, v2, v3
    v_cmp_eq_u32 vcc, -1, v2
    v_mfma_f32_32x32x16_bf16 v[176:191], v[52:55], a[116:119], v[176:191]
    buffer_load_dwordx4 v[48:51], v12, s[52:55], s26 offen offset:0 sc1
    buffer_load_dwordx4 v[52:55], v13, s[52:55], s26 offen offset:0 sc1
    s_cbranch_vccnz L_g2_slow15
L_g2_back15:
    v_mfma_f32_32x32x16_bf16 v[128:143], v[56:59], a[120:123], v[128:143]
    s_waitcnt vmcnt(8)
    v_mfma_f32_32x32x16_bf16 v[144:159], v[56:59], a[124:127], v[144:159]
    v_max3_u32 v2, v64, v65, v66
    v_max3_u32 v3, v67, v68, v69
    v_mfma_f32_32x32x16_bf16 v[160:175], v[60:63], a[120:123], v[160:175]
    v_max3_u32 v2, v2, v70, v71
    v_max_u32 v2, v2, v3
    v_cmp_eq_u32 vcc, -1, v2
    v_mfma_f32_32x32x16_bf16 v[176:191], v[60:63], a[124:127], v[176:191]
    buffer_load_dwordx4 v[56:59], v12, s[52:55], s26 offen offset:1024 sc1
    buffer_load_dwordx4 v[60:63], v13, s[52:55], s26 offen offset:1024 sc1
    s_cbranch_vccnz L_g2_slow16
L_g2_back16:
    v_mfma_f32_32x32x16_bf16 v[128:143], v[64:67], a[128:131], v[128:143]
    s_waitcnt vmcnt(8)
    v_mfma_f32_32x32x16_bf16 v[144:159], v[64:67], a[132:135], v[144:159]
    v_max3_u32 v2, v72, v73, v74
    v_max3_u32 v3, v75, v76, v77
    v_mfma_f32_32x32x16_bf16 v[160:175], v[68:71], a[128:131], v[160:175]
    v_max3_u32 v2, v2, v78, v79
    v_max_u32 v2, v2, v3
    v_cmp_eq_u32 vcc, -1, v2
    v_mfma_f32_32x32x16_bf16 v[176:191], v[68:71], a[132:135], v[176:191]
    buffer_load_dwordx4 v[64:67], v12, s[52:55], s26 offen offset:2048 sc1
    buffer_load_dwordx4 v[68:71], v13, s[52:55], s26 offen offset:2048 sc1
    s_cbranch_vccnz L_g2_slow17
L_g2_back17:
    v_mfma_f32_32x32x16_bf16 v[128:143], v[72:75], a[136:139], v[128:143]
    s_waitcnt vmcnt(8)
    v_mfma_f32_32x32x16_bf16 v[144:159], v[72:75], a[140:143], v[144:159]
    v_max3_u32 v2, v32, v33, v34
    v_max3_u32 v3, v35, v36, v37
    v_mfma_f32_32x32x16_bf16 v[160:175], v[76:79], a[136:139], v[160:175]
    v_max3_u32 v2, v2, v38, v39
    v_max_u32 v2, v2, v3
    v_cmp_eq_u32 vcc, -1, v2
    v_mfma_f32_32x32x16_bf16 v[176:191], v[76:79], a[140:143], v[176:191]
    buffer_load_dwordx4 v[72:75], v12, s[52:55], s26 offen offset:3072 sc1
    buffer_load_dwordx4 v[76:79], v13, s[52:55], s26 offen offset:3072 sc1
    s_add_u32 s26, s26, 4096
    s_cbranch_vccnz L_g2_slow18
L_g2_back18:
    v_mfma_f32_32x32x16_bf16 v[128:143], v[32:35], a[144:147], v[128:143]
    s_waitcnt vmcnt(8)
    v_mfma_f32_32x32x16_bf16 v[144:159], v[32:35], a[148:151], v[144:159]
    v_max3_u32 v2, v40, v41, v42
    v_max3_u32 v3, v43, v44, v45
    v_mfma_f32_32x32x16_bf16 v[160:175], v[36:39], a[144:147], v[160:175]
    v_max3_u32 v2, v2, v46, v47
    v_max_u32 v2, v2, v3
    v_cmp_eq_u32 vcc, -1, v2
    v_mfma_f32_32x32x16_bf16 v[176:191], v[36:39], a[148:151], v[176:191]
    buffer_load_dwordx4 v[32:35], v12, s[52:55], s26 offen offset:0 sc1
    buffer_load_dwordx4 v[36:39], v13, s[52:55], s26 offen offset:0 sc1
    s_cbranch_vccnz L_g2_slow19
L_g2_back19:
    v_mfma_f32_32x32x16_bf16 v[128:143], v[40:43], a[152:155], v[128:143]
    s_waitcnt vmcnt(8)
    v_mfma_f32_32x32x16_bf16 v[144:159], v[40:43], a[156:159], v[144:159]
    v_max3_u32 v2, v48, v49, v50
    v_max3_u32 v3, v51, v52, v53
    v_mfma_f32_32x32x16_bf16 v[160:175], v[44:47], a[152:155], v[160:175]
    v_max3_u32 v2, v2, v54, v55
    v_max_u32 v2, v2, v3
    v_cmp_eq_u32 vcc, -1, v2
    v_mfma_f32_32x32x16_bf16 v[176:191], v[44:47], a[156:159], v[176:191]
    buffer_load_dwordx4 v[40:43], v12, s[52:55], s26 offen offset:1024 sc1
    buffer_load_dwordx4 v[44:47], v13, s[52:55], s26 offen offset:1024 sc1
    s_cbranch_vccnz L_g2_slow20
L_g2_back20:
    v_mfma_f32_32x32x16_bf16 v[128:143], v[48:51], a[160:163], v[128:143]
    s_waitcnt vmcnt(8)
    v_mfma_f32_32x32x16_bf16 v[144:159], v[48:51], a[164:167], v[144:159]
    v_max3_u32 v2, v56, v57, v58
    v_max3_u32 v3, v59, v60, v61
    v_mfma_f32_32x32x16_bf16 v[160:175], v[52:55], a[160:163], v[160:175]
    v_max3_u32 v2, v2, v62, v63
    v_max_u32 v2, v2, v3
    v_cmp_eq_u32 vcc, -1, v2
    v_mfma_f32_32x32x16_bf16 v[176:191], v[52:55], a[164:167], v[176:191]
    buffer_load_dwordx4 v[48:51], v12, s[52:55], s26 offen offset:2048 sc1
    buffer_load_dwordx4 v[52:55], v13, s[52:55], s26 offen offset:2048 sc1
    s_cbranch_vccnz L_g2_slow21
L_g2_back21:
    v_mfma_f32_32x32x16_bf16 v[128:143], v[56:59], a[168:171], v[128:143]
    s_waitcnt vmcnt(8)
    v_mfma_f32_32x32x16_bf16 v[144:159], v[56:59], a[172:175], v[144:159]
    v_max3_u32 v2, v64, v65, v66
    v_max3_u32 v3, v67, v68, v69
    v_mfma_f32_32x32x16_bf16 v[160:175], v[60:63], a[168:171], v[160:175]
    v_max3_u32 v2, v2, v70, v71
    v_max_u32 v2, v2, v3
    v_cmp_eq_u32 vcc, -1, v2
    v_mfma_f32_32x32x16_bf16 v[176:191], v[60:63], a[172:175], v[176:191]
    buffer_load_dwordx4 v[56:59], v12, s[52:55], s26 offen offset:3072 sc1
    buffer_load_dwordx4 v[60:63], v13, s[52:55], s26 offen offset:3072 sc1
    s_add_u32 s26, s26, 4096
    s_cbranch_vccnz L_g2_slow22
L_g2_back22:
    v_mfma_f32_32x32x16_bf16 v[128:143], v[64:67], a[176:179], v[128:143]
    s_waitcnt vmcnt(8)
    v_mfma_f32_32x32x16_bf16 v[144:159], v[64:67], a[180:183], v[144:159]
    v_max3_u32 v2, v72, v73, v74
    v_max3_u32 v3, v75, v76, v77
    v_mfma_f32_32x32x16_bf16 v[160:175], v[68:71], a[176:179], v[160:175]
    v_max3_u32 v2, v2, v78, v79
    v_max_u32 v2, v2, v3
    v_cmp_eq_u32 vcc, -1, v2
    v_mfma_f32_32x32x16_bf16 v[176:191], v[68:71], a[180:183], v[176:191]
    s_cbranch_vccnz L_g2_slow23
L_g2_back23:
    v_mfma_f32_32x32x16_bf16 v[128:143], v[72:75], a[184:187], v[128:143]
    s_waitcnt vmcnt(6)
    v_mfma_f32_32x32x16_bf16 v[144:159], v[72:75], a[188:191], v[144:159]
    v_max3_u32 v2, v32, v33, v34
    v_max3_u32 v3, v35, v36, v37
    v_mfma_f32_32x32x16_bf16 v[160:175], v[76:79], a[184:187], v[160:175]
    v_max3_u32 v2, v2, v38, v39
    v_max_u32 v2, v2, v3
    v_cmp_eq_u32 vcc, -1, v2
    v_mfma_f32_32x32x16_bf16 v[176:191], v[76:79], a[188:191], v[176:191]
    s_cbranch_vccnz L_g2_slow24
L_g2_back24:
    v_mfma_f32_32x32x16_bf16 v[128:143], v[32:35], a[192:195], v[128:143]
    s_waitcnt vmcnt(4)
    v_mfma_f32_32x32x16_bf16 v[144:159], v[32:35], a[196:199], v[144:159]
    v_max3_u32 v2, v40, v41, v42
    v_max3_u32 v3, v43, v44, v45
    v_mfma_f32_32x32x16_bf16 v[160:175], v[36:39], a[192:195], v[160:175]
    v_max3_u32 v2, v2, v46, v47
    v_max_u32 v2, v2, v3
    v_cmp_eq_u32 vcc, -1, v2
    v_mfma_f32_32x32x16_bf16 v[176:191], v[36:39], a[196:199], v[176:191]
    s_cbranch_vccnz L_g2_slow25
L_g2_back25:
    v_mfma_f32_32x32x16_bf16 v[128:143], v[40:43], a[200:203], v[128:143]
    s_waitcnt vmcnt(2)
    v_mfma_f32_32x32x16_bf16 v[144:159], v[40:43], a[204:207], v[144:159]
    v_max3_u32 v2, v48, v49, v50
    v_max3_u32 v3, v51, v52, v53
    v_mfma_f32_32x32x16_bf16 v[160:175], v[44:47], a[200:203], v[160:175]
    v_max3_u32 v2, v2, v54, v55
    v_max_u32 v2, v2, v3
    v_cmp_eq_u32 vcc, -1, v2
    v_mfma_f32_32x32x16_bf16 v[176:191], v[44:47], a[204:207], v[176:191]
    s_cbranch_vccnz L_g2_slow26
L_g2_back26:
    v_mfma_f32_32x32x16_bf16 v[128:143], v[48:51], a[208:211], v[128:143]
    s_waitcnt vmcnt(0)
    v_mfma_f32_32x32x16_bf16 v[144:159], v[48:51], a[212:215], v[144:159]
    v_max3_u32 v2, v56, v57, v58
    v_max3_u32 v3, v59, v60, v61
    v_mfma_f32_32x32x16_bf16 v[160:175], v[52:55], a[208:211], v[160:175]
    v_max3_u32 v2, v2, v62, v63
    v_max_u32 v2, v2, v3
    v_cmp_eq_u32 vcc, -1, v2
    v_mfma_f32_32x32x16_bf16 v[176:191], v[52:55], a[212:215], v[176:191]
    s_cbranch_vccnz L_g2_slow27
L_g2_back27:
    s_nop 0
    v_mfma_f32_32x32x16_bf16 v[128:143], v[56:59], a[216:219], v[128:143]
    v_mfma_f32_32x32x16_bf16 v[144:159], v[56:59], a[220:223], v[144:159]
    v_mfma_f32_32x32x16_bf16 v[160:175], v[60:63], a[216:219], v[160:175]
    v_mfma_f32_32x32x16_bf16 v[176:191], v[60:63], a[220:223], v[176:191]
    s_barrier
    v_lshlrev_b32 v3, 4, v1
    s_mul_i32 s9, s3, 12288
    v_add_u32 v2, s9, v3
    s_cmp_lg_u32 s3, 0
    s_cbranch_scc1 L_g2_x0
    s_nop 3
    ds_write_b128 v3, v[144:147] offset:20480
    ds_write_b128 v3, v[148:151] offset:21504
    ds_write_b128 v3, v[152:155] offset:22528
    ds_write_b128 v3, v[156:159] offset:23552
    ds_write_b128 v3, v[160:163] offset:28672
    ds_write_b128 v3, v[164:167] offset:29696
    ds_write_b128 v3, v[168:171] offset:30720
    ds_write_b128 v3, v[172:175] offset:31744
    ds_write_b128 v3, v[176:179] offset:36864
    ds_write_b128 v3, v[180:183] offset:37888
    ds_write_b128 v3, v[184:187] offset:38912
    ds_write_b128 v3, v[188:191] offset:39936
    v_mov_b32 v192, v128
    v_mov_b32 v193, v129
    v_mov_b32 v194, v130
    v_mov_b32 v195, v131
    v_mov_b32 v196, v132
    v_mov_b32 v197, v133
    v_mov_b32 v198, v134
    v_mov_b32 v199, v135
    v_mov_b32 v200, v136
    v_mov_b32 v201, v137
    v_mov_b32 v202, v138
    v_mov_b32 v203, v139
    v_mov_b32 v204, v140
    v_mov_b32 v205, v141
    v_mov_b32 v206, v142
    v_mov_b32 v207, v143
    s_branch L_g2_xd
L_g2_x0:
    s_cmp_lg_u32 s3, 1
    s_cbranch_scc1 L_g2_x1
    s_nop 0
    ds_write_b128 v3, v[128:131] offset:0
    ds_write_b128 v3, v[132:135] offset:1024
    ds_write_b128 v3, v[136:139] offset:2048
    ds_write_b128 v3, v[140:143] offset:3072
    ds_write_b128 v3, v[160:163] offset:32768
    ds_write_b128 v3, v[164:167] offset:33792
    ds_write_b128 v3, v[168:171] offset:34816
    ds_write_b128 v3, v[172:175] offset:35840
    ds_write_b128 v3, v[176:179] offset:40960
    ds_write_b128 v3, v[180:183] offset:41984
    ds_write_b128 v3, v[184:187] offset:43008
    ds_write_b128 v3, v[188:191] offset:44032
    v_mov_b32 v192, v144
    v_mov_b32 v193, v145
    v_mov_b32 v194, v146
    v_mov_b32 v195, v147
    v_mov_b32 v196, v148
    v_mov_b32 v197, v149
    v_mov_b32 v198, v150
    v_mov_b32 v199, v151
    v_mov_b32 v200, v152
    v_mov_b32 v201, v153
    v_mov_b32 v202, v154
    v_mov_b32 v203, v155
    v_mov_b32 v204, v156
    v_mov_b32 v205, v157
    v_mov_b32 v206, v158
    v_mov_b32 v207, v159
    s_branch L_g2_xd
L_g2_x1:
    s_cmp_lg_u32 s3, 2
    s_cbranch_scc1 L_g2_x2
    s_nop 0
    ds_write_b128 v3, v[128:131] offset:4096
    ds_write_b128 v3, v[132:135] offset:5120
    ds_write_b128 v3, v[136:139] offset:6144
    ds_write_b128 v3, v[140:143] offset:7168
    ds_write_b128 v3, v[144:147] offset:12288
    ds_write_b128 v3, v[148:151] offset:13312
    ds_write_b128 v3, v[152:155] offset:14336
    ds_write_b128 v3, v[156:159] offset:15360
    ds_write_b128 v3, v[176:179] offset:45056
    ds_write_b128 v3, v[180:183] offset:46080
    ds_write_b128 v3, v[184:187] offset:47104
    ds_write_b128 v3, v[188:191] offset:48128
    v_mov_b32 v192, v160
    v_mov_b32 v193, v161
    v_mov_b32 v194, v162
    v_mov_b32 v195, v163
    v_mov_b32 v196, v164
    v_mov_b32 v197, v165
    v_mov_b32 v198, v166
    v_mov_b32 v199, v167
    v_mov_b32 v200, v168
    v_mov_b32 v201, v169
    v_mov_b32 v202, v170
    v_mov_b32 v203, v171
    v_mov_b32 v204, v172
    v_mov_b32 v205, v173
    v_mov_b32 v206, v174
    v_mov_b32 v207, v175
    s_branch L_g2_xd
L_g2_x2:
    s_nop 0
    ds_write_b128 v3, v[128:131] offset:8192
    ds_write_b128 v3, v[132:135] offset:9216
    ds_write_b128 v3, v[136:139] offset:10240
    ds_write_b128 v3, v[140:143] offset:11264
    ds_write_b128 v3, v[144:147] offset:16384
    ds_write_b128 v3, v[148:151] offset:17408
    ds_write_b128 v3, v[152:155] offset:18432
    ds_write_b128 v3, v[156:159] offset:19456
    ds_write_b128 v3, v[160:163] offset:24576
    ds_write_b128 v3, v[164:167] offset:25600
    ds_write_b128 v3, v[168:171] offset:26624
    ds_write_b128 v3, v[172:175] offset:27648
    v_mov_b32 v192, v176
    v_mov_b32 v193, v177
    v_mov_b32 v194, v178
    v_mov_b32 v195, v179
    v_mov_b32 v196, v180
    v_mov_b32 v197, v181
    v_mov_b32 v198, v182
    v_mov_b32 v199, v183
    v_mov_b32 v200, v184
    v_mov_b32 v201, v185
    v_mov_b32 v202, v186
    v_mov_b32 v203, v187
    v_mov_b32 v204, v188
    v_mov_b32 v205, v189
    v_mov_b32 v206, v190
    v_mov_b32 v207, v191
L_g2_xd:
    s_waitcnt lgkmcnt(0)
    s_barrier
    ds_read_b128 v[128:131], v2 offset:0
    ds_read_b128 v[132:135], v2 offset:1024
    ds_read_b128 v[136:139], v2 offset:2048
    ds_read_b128 v[140:143], v2 offset:3072
    ds_read_b128 v[144:147], v2 offset:4096
    ds_read_b128 v[148:151], v2 offset:5120
    ds_read_b128 v[152:155], v2 offset:6144
    ds_read_b128 v[156:159], v2 offset:7168
    ds_read_b128 v[160:163], v2 offset:8192
    ds_read_b128 v[164:167], v2 offset:9216
    ds_read_b128 v[168:171], v2 offset:10240
    ds_read_b128 v[172:175], v2 offset:11264
    s_waitcnt lgkmcnt(8)
    s_nop 0
    v_pk_add_f32 v[192:193], v[192:193], v[128:129]
    v_pk_add_f32 v[194:195], v[194:195], v[130:131]
    v_pk_add_f32 v[196:197], v[196:197], v[132:133]
    v_pk_add_f32 v[198:199], v[198:199], v[134:135]
    v_pk_add_f32 v[200:201], v[200:201], v[136:137]
    v_pk_add_f32 v[202:203], v[202:203], v[138:139]
    v_pk_add_f32 v[204:205], v[204:205], v[140:141]
    v_pk_add_f32 v[206:207], v[206:207], v[142:143]
    s_waitcnt lgkmcnt(4)
    s_nop 0
    v_pk_add_f32 v[192:193], v[192:193], v[144:145]
    v_pk_add_f32 v[194:195], v[194:195], v[146:147]
    v_pk_add_f32 v[196:197], v[196:197], v[148:149]
    v_pk_add_f32 v[198:199], v[198:199], v[150:151]
    v_pk_add_f32 v[200:201], v[200:201], v[152:153]
    v_pk_add_f32 v[202:203], v[202:203], v[154:155]
    v_pk_add_f32 v[204:205], v[204:205], v[156:157]
    v_pk_add_f32 v[206:207], v[206:207], v[158:159]
    s_waitcnt lgkmcnt(0)
    s_nop 0
    v_pk_add_f32 v[192:193], v[192:193], v[160:161]
    v_pk_add_f32 v[194:195], v[194:195], v[162:163]
    v_pk_add_f32 v[196:197], v[196:197], v[164:165]
    v_pk_add_f32 v[198:199], v[198:199], v[166:167]
    v_pk_add_f32 v[200:201], v[200:201], v[168:169]
    v_pk_add_f32 v[202:203], v[202:203], v[170:171]
    v_pk_add_f32 v[204:205], v[204:205], v[172:173]
    v_pk_add_f32 v[206:207], v[206:207], v[174:175]
    v_mov_b32 v30, 0xffff0000
    s_waitcnt vmcnt(0)
    v_lshlrev_b32 v208, 16, v20
    v_and_b32 v209, v30, v20
    v_lshlrev_b32 v210, 16, v21
    v_and_b32 v211, v30, v21
    v_lshlrev_b32 v212, 16, v22
    v_and_b32 v213, v30, v22
    v_lshlrev_b32 v214, 16, v23
    v_and_b32 v215, v30, v23
    v_lshlrev_b32 v216, 16, v24
    v_and_b32 v217, v30, v24
    v_lshlrev_b32 v218, 16, v25
    v_and_b32 v219, v30, v25
    v_lshlrev_b32 v220, 16, v26
    v_and_b32 v221, v30, v26
    v_lshlrev_b32 v222, 16, v27
    v_and_b32 v223, v30, v27
    v_lshlrev_b32 v224, 16, v29
    v_pk_add_f32 v[192:193], v[192:193], v[224:225] op_sel_hi:[1,0]
    v_pk_add_f32 v[194:195], v[194:195], v[224:225] op_sel_hi:[1,0]
    v_pk_add_f32 v[196:197], v[196:197], v[224:225] op_sel_hi:[1,0]
    v_pk_add_f32 v[198:199], v[198:199], v[224:225] op_sel_hi:[1,0]
    v_pk_add_f32 v[200:201], v[200:201], v[224:225] op_sel_hi:[1,0]
    v_pk_add_f32 v[202:203], v[202:203], v[224:225] op_sel_hi:[1,0]
    v_pk_add_f32 v[204:205], v[204:205], v[224:225] op_sel_hi:[1,0]
    v_pk_add_f32 v[206:207], v[206:207], v[224:225] op_sel_hi:[1,0]
    v_pk_add_f32 v[192:193], v[192:193], v[208:209]
    v_pk_add_f32 v[194:195], v[194:195], v[210:211]
    v_pk_add_f32 v[196:197], v[196:197], v[212:213]
    v_pk_add_f32 v[198:199], v[198:199], v[214:215]
    v_pk_add_f32 v[200:201], v[200:201], v[216:217]
    v_pk_add_f32 v[202:203], v[202:203], v[218:219]
    v_pk_add_f32 v[204:205], v[204:205], v[220:221]
    v_pk_add_f32 v[206:207], v[206:207], v[222:223]
    v_cvt_pk_bf16_f32 v232, v192, v193
    v_cvt_pk_bf16_f32 v233, v194, v195
    v_cvt_pk_bf16_f32 v234, v196, v197
    v_cvt_pk_bf16_f32 v235, v198, v199
    v_cvt_pk_bf16_f32 v236, v200, v201
    v_cvt_pk_bf16_f32 v237, v202, v203
    v_cvt_pk_bf16_f32 v238, v204, v205
    v_cvt_pk_bf16_f32 v239, v206, v207
    v_mul_u32_u24 v2, 896, v28
    v_lshrrev_b32 v3, 5, v1
    v_lshl_add_u32 v2, v3, 4, v2
    s_lshl_b32 s9, s19, 7
    s_lshr_b32 s10, s3, 1
    s_lshl_b32 s10, s10, 6
    s_add_u32 s9, s9, s10
    s_mov_b32 s80, s40
    s_mov_b32 s81, s41
    s_nop 0
    s_mov_b32 s82, 1835008
    s_mov_b32 s83, 0x20000
    v_permlane32_swap_b32 v232, v234
    v_permlane32_swap_b32 v233, v235
    v_permlane32_swap_b32 v236, v238
    v_permlane32_swap_b32 v237, v239
    buffer_store_dwordx4 v[232:235], v2, s[80:83], s9 offen offset:0
    buffer_store_dwordx4 v[236:239], v2, s[80:83], s9 offen offset:32
L_end_prof:
L_end:
    s_endpgm
L_g1_slow6:
    s_add_u32 s12, s12, 1
    s_cmp_gt_u32 s12, 131072
    s_cbranch_scc1 L_g1_back6
    s_nop 0
    s_add_u32 s9, s28, 4096
    buffer_load_dwordx4 v[32:35], v12, s[52:55], s9 offen offset:2048 sc1
    buffer_load_dwordx4 v[36:39], v13, s[52:55], s9 offen offset:2048 sc1
    s_waitcnt vmcnt(0)
    s_nop 0
    v_max3_u32 v2, v32, v33, v34
    v_max3_u32 v2, v2, v35, v36
    v_max3_u32 v2, v2, v37, v38
    v_max_u32 v2, v2, v39
    v_cmp_eq_u32 vcc, -1, v2
    s_cbranch_vccnz L_g1_slow6
    s_branch L_g1_back6
L_g1_slow7:
    s_add_u32 s12, s12, 1
    s_cmp_gt_u32 s12, 131072
    s_cbranch_scc1 L_g1_back7
    s_add_u32 s9, s28, 4096
    buffer_load_dwordx4 v[40:43], v12, s[52:55], s9 offen offset:3072 sc1
    buffer_load_dwordx4 v[44:47], v13, s[52:55], s9 offen offset:3072 sc1
    s_waitcnt vmcnt(0)
    s_nop 0
    v_max3_u32 v2, v40, v41, v42
    v_max3_u32 v2, v2, v43, v44
    v_max3_u32 v2, v2, v45, v46
    v_max_u32 v2, v2, v47
    v_cmp_eq_u32 vcc, -1, v2
    s_cbranch_vccnz L_g1_slow7
    s_branch L_g1_back7
L_g1_slow8:
    s_add_u32 s12, s12, 1
    s_cmp_gt_u32 s12, 131072
    s_cbranch_scc1 L_g1_back8
    s_add_u32 s9, s28, 8192
    buffer_load_dwordx4 v[48:51], v12, s[52:55], s9 offen offset:0 sc1
    buffer_load_dwordx4 v[52:55], v13, s[52:55], s9 offen offset:0 sc1
    s_waitcnt vmcnt(0)
    s_nop 0
    v_max3_u32 v2, v48, v49, v50
    v_max3_u32 v2, v2, v51, v52
    v_max3_u32 v2, v2, v53, v54
    v_max_u32 v2, v2, v55
    v_cmp_eq_u32 vcc, -1, v2
    s_cbranch_vccnz L_g1_slow8
    s_branch L_g1_back8
L_g1_slow9:
    s_add_u32 s12, s12, 1
    s_cmp_gt_u32 s12, 131072
    s_cbranch_scc1 L_g1_back9
    s_add_u32 s9, s28, 8192
    buffer_load_dwordx4 v[56:59], v12, s[52:55], s9 offen offset:1024 sc1
    buffer_load_dwordx4 v[60:63], v13, s[52:55], s9 offen offset:1024 sc1
    s_waitcnt vmcnt(0)
    s_nop 0
    v_max3_u32 v2, v56, v57, v58
    v_max3_u32 v2, v2, v59, v60
    v_max3_u32 v2, v2, v61, v62
    v_max_u32 v2, v2, v63
    v_cmp_eq_u32 vcc, -1, v2
    s_cbranch_vccnz L_g1_slow9
    s_branch L_g1_back9
L_g1_slow10:
    s_add_u32 s12, s12, 1
    s_cmp_gt_u32 s12, 131072
    s_cbranch_scc1 L_g1_back10
    s_add_u32 s9, s28, 8192
    buffer_load_dwordx4 v[64:67], v12, s[52:55], s9 offen offset:2048 sc1
    buffer_load_dwordx4 v[68:71], v13, s[52:55], s9 offen offset:2048 sc1
    s_waitcnt vmcnt(0)
    s_nop 0
    v_max3_u32 v2, v64, v65, v66
    v_max3_u32 v2, v2, v67, v68
    v_max3_u32 v2, v2, v69, v70
    v_max_u32 v2, v2, v71
    v_cmp_eq_u32 vcc, -1, v2
    s_cbranch_vccnz L_g1_slow10
    s_branch L_g1_back10
L_g1_slow11:
    s_add_u32 s12, s12, 1
    s_cmp_gt_u32 s12, 131072
    s_cbranch_scc1 L_g1_back11
    s_add_u32 s9, s28, 8192
    buffer_load_dwordx4 v[72:75], v12, s[52:55], s9 offen offset:3072 sc1
    buffer_load_dwordx4 v[76:79], v13, s[52:55], s9 offen offset:3072 sc1
    s_waitcnt vmcnt(0)
    s_nop 0
    v_max3_u32 v2, v72, v73, v74
    v_max3_u32 v2, v2, v75, v76
    v_max3_u32 v2, v2, v77, v78
    v_max_u32 v2, v2, v79
    v_cmp_eq_u32 vcc, -1, v2
    s_cbranch_vccnz L_g1_slow11
    s_branch L_g1_back11
L_g1_slow12:
    s_add_u32 s12, s12, 1
    s_cmp_gt_u32 s12, 131072
    s_cbranch_scc1 L_g1_back12
    s_add_u32 s9, s28, 12288
    buffer_load_dwordx4 v[32:35], v12, s[52:55], s9 offen offset:0 sc1
    buffer_load_dwordx4 v[36:39], v13, s[52:55], s9 offen offset:0 sc1
    s_waitcnt vmcnt(0)
    s_nop 0
    v_max3_u32 v2, v32, v33, v34
    v_max3_u32 v2, v2, v35, v36
    v_max3_u32 v2, v2, v37, v38
    v_max_u32 v2, v2, v39
    v_cmp_eq_u32 vcc, -1, v2
    s_cbranch_vccnz L_g1_slow12
    s_branch L_g1_back12
L_g1_slow13:
    s_add_u32 s12, s12, 1
    s_cmp_gt_u32 s12, 131072
    s_cbranch_scc1 L_g1_back13
    s_add_u32 s9, s28, 12288
    buffer_load_dwordx4 v[40:43], v12, s[52:55], s9 offen offset:1024 sc1
    buffer_load_dwordx4 v[44:47], v13, s[52:55], s9 offen offset:1024 sc1
    s_waitcnt vmcnt(0)
    s_nop 0
    v_max3_u32 v2, v40, v41, v42
    v_max3_u32 v2, v2, v43, v44
    v_max3_u32 v2, v2, v45, v46
    v_max_u32 v2, v2, v47
    v_cmp_eq_u32 vcc, -1, v2
    s_cbranch_vccnz L_g1_slow13
    s_branch L_g1_back13
L_g1_slow14:
    s_add_u32 s12, s12, 1
    s_cmp_gt_u32 s12, 131072
    s_cbranch_scc1 L_g1_back14
    s_add_u32 s9, s28, 12288
    buffer_load_dwordx4 v[48:51], v12, s[52:55], s9 offen offset:2048 sc1
    buffer_load_dwordx4 v[52:55], v13, s[52:55], s9 offen offset:2048 sc1
    s_waitcnt vmcnt(0)
    s_nop 0
    v_max3_u32 v2, v48, v49, v50
    v_max3_u32 v2, v2, v51, v52
    v_max3_u32 v2, v2, v53, v54
    v_max_u32 v2, v2, v55
    v_cmp_eq_u32 vcc, -1, v2
    s_cbranch_vccnz L_g1_slow14
    s_branch L_g1_back14
L_g1_slow15:
    s_add_u32 s12, s12, 1
    s_cmp_gt_u32 s12, 131072
    s_cbranch_scc1 L_g1_back15
    s_add_u32 s9, s28, 12288
    buffer_load_dwordx4 v[56:59], v12, s[52:55], s9 offen offset:3072 sc1
    buffer_load_dwordx4 v[60:63], v13, s[52:55], s9 offen offset:3072 sc1
    s_waitcnt vmcnt(0)
    s_nop 0
    v_max3_u32 v2, v56, v57, v58
    v_max3_u32 v2, v2, v59, v60
    v_max3_u32 v2, v2, v61, v62
    v_max_u32 v2, v2, v63
    v_cmp_eq_u32 vcc, -1, v2
    s_cbranch_vccnz L_g1_slow15
    s_branch L_g1_back15
L_g1_slow16:
    s_add_u32 s12, s12, 1
    s_cmp_gt_u32 s12, 131072
    s_cbranch_scc1 L_g1_back16
    s_add_u32 s9, s28, 16384
    buffer_load_dwordx4 v[64:67], v12, s[52:55], s9 offen offset:0 sc1
    buffer_load_dwordx4 v[68:71], v13, s[52:55], s9 offen offset:0 sc1
    s_waitcnt vmcnt(0)
    s_nop 0
    v_max3_u32 v2, v64, v65, v66
    v_max3_u32 v2, v2, v67, v68
    v_max3_u32 v2, v2, v69, v70
    v_max_u32 v2, v2, v71
    v_cmp_eq_u32 vcc, -1, v2
    s_cbranch_vccnz L_g1_slow16
    s_branch L_g1_back16
L_g1_slow17:
    s_add_u32 s12, s12, 1
    s_cmp_gt_u32 s12, 131072
    s_cbranch_scc1 L_g1_back17
    s_add_u32 s9, s28, 16384
    buffer_load_dwordx4 v[72:75], v12, s[52:55], s9 offen offset:1024 sc1
    buffer_load_dwordx4 v[76:79], v13, s[52:55], s9 offen offset:1024 sc1
    s_waitcnt vmcnt(0)
    s_nop 0
    v_max3_u32 v2, v72, v73, v74
    v_max3_u32 v2, v2, v75, v76
    v_max3_u32 v2, v2, v77, v78
    v_max_u32 v2, v2, v79
    v_cmp_eq_u32 vcc, -1, v2
    s_cbranch_vccnz L_g1_slow17
    s_branch L_g1_back17
L_g1_slow18:
    s_add_u32 s12, s12, 1
    s_cmp_gt_u32 s12, 131072
    s_cbranch_scc1 L_g1_back18
    s_add_u32 s9, s28, 16384
    buffer_load_dwordx4 v[32:35], v12, s[52:55], s9 offen offset:2048 sc1
    buffer_load_dwordx4 v[36:39], v13, s[52:55], s9 offen offset:2048 sc1
    s_waitcnt vmcnt(0)
    s_nop 0
    v_max3_u32 v2, v32, v33, v34
    v_max3_u32 v2, v2, v35, v36
    v_max3_u32 v2, v2, v37, v38
    v_max_u32 v2, v2, v39
    v_cmp_eq_u32 vcc, -1, v2
    s_cbranch_vccnz L_g1_slow18
    s_branch L_g1_back18
L_g1_slow19:
    s_add_u32 s12, s12, 1
    s_cmp_gt_u32 s12, 131072
    s_cbranch_scc1 L_g1_back19
    s_add_u32 s9, s28, 16384
    buffer_load_dwordx4 v[40:43], v12, s[52:55], s9 offen offset:3072 sc1
    buffer_load_dwordx4 v[44:47], v13, s[52:55], s9 offen offset:3072 sc1
    s_waitcnt vmcnt(0)
    s_nop 0
    v_max3_u32 v2, v40, v41, v42
    v_max3_u32 v2, v2, v43, v44
    v_max3_u32 v2, v2, v45, v46
    v_max_u32 v2, v2, v47
    v_cmp_eq_u32 vcc, -1, v2
    s_cbranch_vccnz L_g1_slow19
    s_branch L_g1_back19
L_g1_slow20:
    s_add_u32 s12, s12, 1
    s_cmp_gt_u32 s12, 131072
    s_cbranch_scc1 L_g1_back20
    s_add_u32 s9, s28, 20480
    buffer_load_dwordx4 v[48:51], v12, s[52:55], s9 offen offset:0 sc1
    buffer_load_dwordx4 v[52:55], v13, s[52:55], s9 offen offset:0 sc1
    s_waitcnt vmcnt(0)
    s_nop 0
    v_max3_u32 v2, v48, v49, v50
    v_max3_u32 v2, v2, v51, v52
    v_max3_u32 v2, v2, v53, v54
    v_max_u32 v2, v2, v55
    v_cmp_eq_u32 vcc, -1, v2
    s_cbranch_vccnz L_g1_slow20
    s_branch L_g1_back20
L_g1_slow21:
    s_add_u32 s12, s12, 1
    s_cmp_gt_u32 s12, 131072
    s_cbranch_scc1 L_g1_back21
    s_add_u32 s9, s28, 20480
    buffer_load_dwordx4 v[56:59], v12, s[52:55], s9 offen offset:1024 sc1
    buffer_load_dwordx4 v[60:63], v13, s[52:55], s9 offen offset:1024 sc1
    s_waitcnt vmcnt(0)
    s_nop 0
    v_max3_u32 v2, v56, v57, v58
    v_max3_u32 v2, v2, v59, v60
    v_max3_u32 v2, v2, v61, v62
    v_max_u32 v2, v2, v63
    v_cmp_eq_u32 vcc, -1, v2
    s_cbranch_vccnz L_g1_slow21
    s_branch L_g1_back21
L_g1_slow22:
    s_add_u32 s12, s12, 1
    s_cmp_gt_u32 s12, 131072
    s_cbranch_scc1 L_g1_back22
    s_add_u32 s9, s28, 20480
    buffer_load_dwordx4 v[64:67], v12, s[52:55], s9 offen offset:2048 sc1
    buffer_load_dwordx4 v[68:71], v13, s[52:55], s9 offen offset:2048 sc1
    s_waitcnt vmcnt(0)
    s_nop 0
    v_max3_u32 v2, v64, v65, v66
    v_max3_u32 v2, v2, v67, v68
    v_max3_u32 v2, v2, v69, v70
    v_max_u32 v2, v2, v71
    v_cmp_eq_u32 vcc, -1, v2
    s_cbranch_vccnz L_g1_slow22
    s_branch L_g1_back22
L_g1_slow23:
    s_add_u32 s12, s12, 1
    s_cmp_gt_u32 s12, 131072
    s_cbranch_scc1 L_g1_back23
    s_add_u32 s9, s28, 20480
    buffer_load_dwordx4 v[72:75], v12, s[52:55], s9 offen offset:3072 sc1
    buffer_load_dwordx4 v[76:79], v13, s[52:55], s9 offen offset:3072 sc1
    s_waitcnt vmcnt(0)
    s_nop 0
    v_max3_u32 v2, v72, v73, v74
    v_max3_u32 v2, v2, v75, v76
    v_max3_u32 v2, v2, v77, v78
    v_max_u32 v2, v2, v79
    v_cmp_eq_u32 vcc, -1, v2
    s_cbranch_vccnz L_g1_slow23
    s_branch L_g1_back23
L_g1_slow24:
    s_add_u32 s12, s12, 1
    s_cmp_gt_u32 s12, 131072
    s_cbranch_scc1 L_g1_back24
    s_add_u32 s9, s28, 24576
    buffer_load_dwordx4 v[32:35], v12, s[52:55], s9 offen offset:0 sc1
    buffer_load_dwordx4 v[36:39], v13, s[52:55], s9 offen offset:0 sc1
    s_waitcnt vmcnt(0)
    s_nop 0
    v_max3_u32 v2, v32, v33, v34
    v_max3_u32 v2, v2, v35, v36
    v_max3_u32 v2, v2, v37, v38
    v_max_u32 v2, v2, v39
    v_cmp_eq_u32 vcc, -1, v2
    s_cbranch_vccnz L_g1_slow24
    s_branch L_g1_back24
L_g1_slow25:
    s_add_u32 s12, s12, 1
    s_cmp_gt_u32 s12, 131072
    s_cbranch_scc1 L_g1_back25
    s_add_u32 s9, s28, 24576
    buffer_load_dwordx4 v[40:43], v12, s[52:55], s9 offen offset:1024 sc1
    buffer_load_dwordx4 v[44:47], v13, s[52:55], s9 offen offset:1024 sc1
    s_waitcnt vmcnt(0)
    s_nop 0
    v_max3_u32 v2, v40, v41, v42
    v_max3_u32 v2, v2, v43, v44
    v_max3_u32 v2, v2, v45, v46
    v_max_u32 v2, v2, v47
    v_cmp_eq_u32 vcc, -1, v2
    s_cbranch_vccnz L_g1_slow25
    s_branch L_g1_back25
L_g1_slow26:
    s_add_u32 s12, s12, 1
    s_cmp_gt_u32 s12, 131072
    s_cbranch_scc1 L_g1_back26
    s_add_u32 s9, s28, 24576
    buffer_load_dwordx4 v[48:51], v12, s[52:55], s9 offen offset:2048 sc1
    buffer_load_dwordx4 v[52:55], v13, s[52:55], s9 offen offset:2048 sc1
    s_waitcnt vmcnt(0)
    s_nop 0
    v_max3_u32 v2, v48, v49, v50
    v_max3_u32 v2, v2, v51, v52
    v_max3_u32 v2, v2, v53, v54
    v_max_u32 v2, v2, v55
    v_cmp_eq_u32 vcc, -1, v2
    s_cbranch_vccnz L_g1_slow26
    s_branch L_g1_back26
L_g1_slow27:
    s_add_u32 s12, s12, 1
    s_cmp_gt_u32 s12, 131072
    s_cbranch_scc1 L_g1_back27
    s_add_u32 s9, s28, 24576
    buffer_load_dwordx4 v[56:59], v12, s[52:55], s9 offen offset:3072 sc1
    buffer_load_dwordx4 v[60:63], v13, s[52:55], s9 offen offset:3072 sc1
    s_waitcnt vmcnt(0)
    s_nop 0
    v_max3_u32 v2, v56, v57, v58
    v_max3_u32 v2, v2, v59, v60
    v_max3_u32 v2, v2, v61, v62
    v_max_u32 v2, v2, v63
    v_cmp_eq_u32 vcc, -1, v2
    s_cbranch_vccnz L_g1_slow27
    s_branch L_g1_back27
L_g1_slow28:
    s_add_u32 s12, s12, 1
    s_cmp_gt_u32 s12, 131072
    s_cbranch_scc1 L_g1_back28
    s_add_u32 s9, s28, 28672
    buffer_load_dwordx4 v[64:67], v12, s[52:55], s9 offen offset:0 sc1
    buffer_load_dwordx4 v[68:71], v13, s[52:55], s9 offen offset:0 sc1
    s_waitcnt vmcnt(0)
    s_nop 0
    v_max3_u32 v2, v64, v65, v66
    v_max3_u32 v2, v2, v67, v68
    v_max3_u32 v2, v2, v69, v70
    v_max_u32 v2, v2, v71
    v_cmp_eq_u32 vcc, -1, v2
    s_cbranch_vccnz L_g1_slow28
    s_branch L_g1_back28
L_g1_slow29:
    s_add_u32 s12, s12, 1
    s_cmp_gt_u32 s12, 131072
    s_cbranch_scc1 L_g1_back29
    s_add_u32 s9, s28, 28672
    buffer_load_dwordx4 v[72:75], v12, s[52:55], s9 offen offset:1024 sc1
    buffer_load_dwordx4 v[76:79], v13, s[52:55], s9 offen offset:1024 sc1
    s_waitcnt vmcnt(0)
    s_nop 0
    v_max3_u32 v2, v72, v73, v74
    v_max3_u32 v2, v2, v75, v76
    v_max3_u32 v2, v2, v77, v78
    v_max_u32 v2, v2, v79
    v_cmp_eq_u32 vcc, -1, v2
    s_cbranch_vccnz L_g1_slow29
    s_branch L_g1_back29
L_g1_slow30:
    s_add_u32 s12, s12, 1
    s_cmp_gt_u32 s12, 131072
    s_cbranch_scc1 L_g1_back30
    s_add_u32 s9, s28, 28672
    buffer_load_dwordx4 v[32:35], v12, s[52:55], s9 offen offset:2048 sc1
    buffer_load_dwordx4 v[36:39], v13, s[52:55], s9 offen offset:2048 sc1
    s_waitcnt vmcnt(0)
    s_nop 0
    v_max3_u32 v2, v32, v33, v34
    v_max3_u32 v2, v2, v35, v36
    v_max3_u32 v2, v2, v37, v38
    v_max_u32 v2, v2, v39
    v_cmp_eq_u32 vcc, -1, v2
    s_cbranch_vccnz L_g1_slow30
    s_branch L_g1_back30
L_g1_slow31:
    s_add_u32 s12, s12, 1
    s_cmp_gt_u32 s12, 131072
    s_cbranch_scc1 L_g1_back31
    s_add_u32 s9, s28, 28672
    buffer_load_dwordx4 v[40:43], v12, s[52:55], s9 offen offset:3072 sc1
    buffer_load_dwordx4 v[44:47], v13, s[52:55], s9 offen offset:3072 sc1
    s_waitcnt vmcnt(0)
    s_nop 0
    v_max3_u32 v2, v40, v41, v42
    v_max3_u32 v2, v2, v43, v44
    v_max3_u32 v2, v2, v45, v46
    v_max_u32 v2, v2, v47
    v_cmp_eq_u32 vcc, -1, v2
    s_cbranch_vccnz L_g1_slow31
    s_branch L_g1_back31
L_g2_slow6:
    s_add_u32 s12, s12, 1
    s_cmp_gt_u32 s12, 131072
    s_cbranch_scc1 L_g2_back6
    s_add_u32 s9, s28, 4096
    buffer_load_dwordx4 v[32:35], v12, s[52:55], s9 offen offset:2048 sc1
    buffer_load_dwordx4 v[36:39], v13, s[52:55], s9 offen offset:2048 sc1
    s_waitcnt vmcnt(0)
    s_nop 0
    v_max3_u32 v2, v32, v33, v34
    v_max3_u32 v2, v2, v35, v36
    v_max3_u32 v2, v2, v37, v38
    v_max_u32 v2, v2, v39
    v_cmp_eq_u32 vcc, -1, v2
    s_cbranch_vccnz L_g2_slow6
    s_branch L_g2_back6
L_g2_slow7:
    s_add_u32 s12, s12, 1
    s_cmp_gt_u32 s12, 131072
    s_cbranch_scc1 L_g2_back7
    s_add_u32 s9, s28, 4096
    buffer_load_dwordx4 v[40:43], v12, s[52:55], s9 offen offset:3072 sc1
    buffer_load_dwordx4 v[44:47], v13, s[52:55], s9 offen offset:3072 sc1
    s_waitcnt vmcnt(0)
    s_nop 0
    v_max3_u32 v2, v40, v41, v42
    v_max3_u32 v2, v2, v43, v44
    v_max3_u32 v2, v2, v45, v46
    v_max_u32 v2, v2, v47
    v_cmp_eq_u32 vcc, -1, v2
    s_cbranch_vccnz L_g2_slow7
    s_branch L_g2_back7
L_g2_slow8:
    s_add_u32 s12, s12, 1
    s_cmp_gt_u32 s12, 131072
    s_cbranch_scc1 L_g2_back8
    s_add_u32 s9, s28, 8192
    buffer_load_dwordx4 v[48:51], v12, s[52:55], s9 offen offset:0 sc1
    buffer_load_dwordx4 v[52:55], v13, s[52:55], s9 offen offset:0 sc1
    s_waitcnt vmcnt(0)
    s_nop 0
    v_max3_u32 v2, v48, v49, v50
    v_max3_u32 v2, v2, v51, v52
    v_max3_u32 v2, v2, v53, v54
    v_max_u32 v2, v2, v55
    v_cmp_eq_u32 vcc, -1, v2
    s_cbranch_vccnz L_g2_slow8
    s_branch L_g2_back8
L_g2_slow9:
    s_add_u32 s12, s12, 1
    s_cmp_gt_u32 s12, 131072
    s_cbranch_scc1 L_g2_back9
    s_add_u32 s9, s28, 8192
    buffer_load_dwordx4 v[56:59], v12, s[52:55], s9 offen offset:1024 sc1
    buffer_load_dwordx4 v[60:63], v13, s[52:55], s9 offen offset:1024 sc1
    s_waitcnt vmcnt(0)
    s_nop 0
    v_max3_u32 v2, v56, v57, v58
    v_max3_u32 v2, v2, v59, v60
    v_max3_u32 v2, v2, v61, v62
    v_max_u32 v2, v2, v63
    v_cmp_eq_u32 vcc, -1, v2
    s_cbranch_vccnz L_g2_slow9
    s_branch L_g2_back9
L_g2_slow10:
    s_add_u32 s12, s12, 1
    s_cmp_gt_u32 s12, 131072
    s_cbranch_scc1 L_g2_back10
    s_add_u32 s9, s28, 8192
    buffer_load_dwordx4 v[64:67], v12, s[52:55], s9 offen offset:2048 sc1
    buffer_load_dwordx4 v[68:71], v13, s[52:55], s9 offen offset:2048 sc1
    s_waitcnt vmcnt(0)
    s_nop 0
    v_max3_u32 v2, v64, v65, v66
    v_max3_u32 v2, v2, v67, v68
    v_max3_u32 v2, v2, v69, v70
    v_max_u32 v2, v2, v71
    v_cmp_eq_u32 vcc, -1, v2
    s_cbranch_vccnz L_g2_slow10
    s_branch L_g2_back10
L_g2_slow11:
    s_add_u32 s12, s12, 1
    s_cmp_gt_u32 s12, 131072
    s_cbranch_scc1 L_g2_back11
    s_add_u32 s9, s28, 8192
    buffer_load_dwordx4 v[72:75], v12, s[52:55], s9 offen offset:3072 sc1
    buffer_load_dwordx4 v[76:79], v13, s[52:55], s9 offen offset:3072 sc1
    s_waitcnt vmcnt(0)
    s_nop 0
    v_max3_u32 v2, v72, v73, v74
    v_max3_u32 v2, v2, v75, v76
    v_max3_u32 v2, v2, v77, v78
    v_max_u32 v2, v2, v79
    v_cmp_eq_u32 vcc, -1, v2
    s_cbranch_vccnz L_g2_slow11
    s_branch L_g2_back11
L_g2_slow12:
    s_add_u32 s12, s12, 1
    s_cmp_gt_u32 s12, 131072
    s_cbranch_scc1 L_g2_back12
    s_add_u32 s9, s28, 12288
    buffer_load_dwordx4 v[32:35], v12, s[52:55], s9 offen offset:0 sc1
    buffer_load_dwordx4 v[36:39], v13, s[52:55], s9 offen offset:0 sc1
    s_waitcnt vmcnt(0)
    s_nop 0
    v_max3_u32 v2, v32, v33, v34
    v_max3_u32 v2, v2, v35, v36
    v_max3_u32 v2, v2, v37, v38
    v_max_u32 v2, v2, v39
    v_cmp_eq_u32 vcc, -1, v2
    s_cbranch_vccnz L_g2_slow12
    s_branch L_g2_back12
L_g2_slow13:
    s_add_u32 s12, s12, 1
    s_cmp_gt_u32 s12, 131072
    s_cbranch_scc1 L_g2_back13
    s_add_u32 s9, s28, 12288
    buffer_load_dwordx4 v[40:43], v12, s[52:55], s9 offen offset:1024 sc1
    buffer_load_dwordx4 v[44:47], v13, s[52:55], s9 offen offset:1024 sc1
    s_waitcnt vmcnt(0)
    s_nop 0
    v_max3_u32 v2, v40, v41, v42
    v_max3_u32 v2, v2, v43, v44
    v_max3_u32 v2, v2, v45, v46
    v_max_u32 v2, v2, v47
    v_cmp_eq_u32 vcc, -1, v2
    s_cbranch_vccnz L_g2_slow13
    s_branch L_g2_back13
L_g2_slow14:
    s_add_u32 s12, s12, 1
    s_cmp_gt_u32 s12, 131072
    s_cbranch_scc1 L_g2_back14
    s_add_u32 s9, s28, 12288
    buffer_load_dwordx4 v[48:51], v12, s[52:55], s9 offen offset:2048 sc1
    buffer_load_dwordx4 v[52:55], v13, s[52:55], s9 offen offset:2048 sc1
    s_waitcnt vmcnt(0)
    s_nop 0
    v_max3_u32 v2, v48, v49, v50
    v_max3_u32 v2, v2, v51, v52
    v_max3_u32 v2, v2, v53, v54
    v_max_u32 v2, v2, v55
    v_cmp_eq_u32 vcc, -1, v2
    s_cbranch_vccnz L_g2_slow14
    s_branch L_g2_back14
L_g2_slow15:
    s_add_u32 s12, s12, 1
    s_cmp_gt_u32 s12, 131072
    s_cbranch_scc1 L_g2_back15
    s_add_u32 s9, s28, 12288
    buffer_load_dwordx4 v[56:59], v12, s[52:55], s9 offen offset:3072 sc1
    buffer_load_dwordx4 v[60:63], v13, s[52:55], s9 offen offset:3072 sc1
    s_waitcnt vmcnt(0)
    s_nop 0
    v_max3_u32 v2, v56, v57, v58
    v_max3_u32 v2, v2, v59, v60
    v_max3_u32 v2, v2, v61, v62
    v_max_u32 v2, v2, v63
    v_cmp_eq_u32 vcc, -1, v2
    s_cbranch_vccnz L_g2_slow15
    s_branch L_g2_back15
L_g2_slow16:
    s_add_u32 s12, s12, 1
    s_cmp_gt_u32 s12, 131072
    s_cbranch_scc1 L_g2_back16
    s_add_u32 s9, s28, 16384
    buffer_load_dwordx4 v[64:67], v12, s[52:55], s9 offen offset:0 sc1
    buffer_load_dwordx4 v[68:71], v13, s[52:55], s9 offen offset:0 sc1
    s_waitcnt vmcnt(0)
    s_nop 0
    v_max3_u32 v2, v64, v65, v66
    v_max3_u32 v2, v2, v67, v68
    v_max3_u32 v2, v2, v69, v70
    v_max_u32 v2, v2, v71
    v_cmp_eq_u32 vcc, -1, v2
    s_cbranch_vccnz L_g2_slow16
    s_branch L_g2_back16
L_g2_slow17:
    s_add_u32 s12, s12, 1
    s_cmp_gt_u32 s12, 131072
    s_cbranch_scc1 L_g2_back17
    s_add_u32 s9, s28, 16384
    buffer_load_dwordx4 v[72:75], v12, s[52:55], s9 offen offset:1024 sc1
    buffer_load_dwordx4 v[76:79], v13, s[52:55], s9 offen offset:1024 sc1
    s_waitcnt vmcnt(0)
    s_nop 0
    v_max3_u32 v2, v72, v73, v74
    v_max3_u32 v2, v2, v75, v76
    v_max3_u32 v2, v2, v77, v78
    v_max_u32 v2, v2, v79
    v_cmp_eq_u32 vcc, -1, v2
    s_cbranch_vccnz L_g2_slow17
    s_branch L_g2_back17
L_g2_slow18:
    s_add_u32 s12, s12, 1
    s_cmp_gt_u32 s12, 131072
    s_cbranch_scc1 L_g2_back18
    s_add_u32 s9, s28, 16384
    buffer_load_dwordx4 v[32:35], v12, s[52:55], s9 offen offset:2048 sc1
    buffer_load_dwordx4 v[36:39], v13, s[52:55], s9 offen offset:2048 sc1
    s_waitcnt vmcnt(0)
    s_nop 0
    v_max3_u32 v2, v32, v33, v34
    v_max3_u32 v2, v2, v35, v36
    v_max3_u32 v2, v2, v37, v38
    v_max_u32 v2, v2, v39
    v_cmp_eq_u32 vcc, -1, v2
    s_cbranch_vccnz L_g2_slow18
    s_branch L_g2_back18
L_g2_slow19:
    s_add_u32 s12, s12, 1
    s_cmp_gt_u32 s12, 131072
    s_cbranch_scc1 L_g2_back19
    s_add_u32 s9, s28, 16384
    buffer_load_dwordx4 v[40:43], v12, s[52:55], s9 offen offset:3072 sc1
    buffer_load_dwordx4 v[44:47], v13, s[52:55], s9 offen offset:3072 sc1
    s_waitcnt vmcnt(0)
    s_nop 0
    v_max3_u32 v2, v40, v41, v42
    v_max3_u32 v2, v2, v43, v44
    v_max3_u32 v2, v2, v45, v46
    v_max_u32 v2, v2, v47
    v_cmp_eq_u32 vcc, -1, v2
    s_cbranch_vccnz L_g2_slow19
    s_branch L_g2_back19
L_g2_slow20:
    s_add_u32 s12, s12, 1
    s_cmp_gt_u32 s12, 131072
    s_cbranch_scc1 L_g2_back20
    s_add_u32 s9, s28, 20480
    buffer_load_dwordx4 v[48:51], v12, s[52:55], s9 offen offset:0 sc1
    buffer_load_dwordx4 v[52:55], v13, s[52:55], s9 offen offset:0 sc1
    s_waitcnt vmcnt(0)
    s_nop 0
    v_max3_u32 v2, v48, v49, v50
    v_max3_u32 v2, v2, v51, v52
    v_max3_u32 v2, v2, v53, v54
    v_max_u32 v2, v2, v55
    v_cmp_eq_u32 vcc, -1, v2
    s_cbranch_vccnz L_g2_slow20
    s_branch L_g2_back20
L_g2_slow21:
    s_add_u32 s12, s12, 1
    s_cmp_gt_u32 s12, 131072
    s_cbranch_scc1 L_g2_back21
    s_add_u32 s9, s28, 20480
    buffer_load_dwordx4 v[56:59], v12, s[52:55], s9 offen offset:1024 sc1
    buffer_load_dwordx4 v[60:63], v13, s[52:55], s9 offen offset:1024 sc1
    s_waitcnt vmcnt(0)
    s_nop 0
    v_max3_u32 v2, v56, v57, v58
    v_max3_u32 v2, v2, v59, v60
    v_max3_u32 v2, v2, v61, v62
    v_max_u32 v2, v2, v63
    v_cmp_eq_u32 vcc, -1, v2
    s_cbranch_vccnz L_g2_slow21
    s_branch L_g2_back21
L_g2_slow22:
    s_add_u32 s12, s12, 1
    s_cmp_gt_u32 s12, 131072
    s_cbranch_scc1 L_g2_back22
    s_add_u32 s9, s28, 20480
    buffer_load_dwordx4 v[64:67], v12, s[52:55], s9 offen offset:2048 sc1
    buffer_load_dwordx4 v[68:71], v13, s[52:55], s9 offen offset:2048 sc1
    s_waitcnt vmcnt(0)
    s_nop 0
    v_max3_u32 v2, v64, v65, v66
    v_max3_u32 v2, v2, v67, v68
    v_max3_u32 v2, v2, v69, v70
    v_max_u32 v2, v2, v71
    v_cmp_eq_u32 vcc, -1, v2
    s_cbranch_vccnz L_g2_slow22
    s_branch L_g2_back22
L_g2_slow23:
    s_add_u32 s12, s12, 1
    s_cmp_gt_u32 s12, 131072
    s_cbranch_scc1 L_g2_back23
    s_add_u32 s9, s28, 20480
    buffer_load_dwordx4 v[72:75], v12, s[52:55], s9 offen offset:3072 sc1
    buffer_load_dwordx4 v[76:79], v13, s[52:55], s9 offen offset:3072 sc1
    s_waitcnt vmcnt(0)
    s_nop 0
    v_max3_u32 v2, v72, v73, v74
    v_max3_u32 v2, v2, v75, v76
    v_max3_u32 v2, v2, v77, v78
    v_max_u32 v2, v2, v79
    v_cmp_eq_u32 vcc, -1, v2
    s_cbranch_vccnz L_g2_slow23
    s_branch L_g2_back23
L_g2_slow24:
    s_add_u32 s12, s12, 1
    s_cmp_gt_u32 s12, 131072
    s_cbranch_scc1 L_g2_back24
    s_add_u32 s9, s28, 24576
    buffer_load_dwordx4 v[32:35], v12, s[52:55], s9 offen offset:0 sc1
    buffer_load_dwordx4 v[36:39], v13, s[52:55], s9 offen offset:0 sc1
    s_waitcnt vmcnt(0)
    s_nop 0
    v_max3_u32 v2, v32, v33, v34
    v_max3_u32 v2, v2, v35, v36
    v_max3_u32 v2, v2, v37, v38
    v_max_u32 v2, v2, v39
    v_cmp_eq_u32 vcc, -1, v2
    s_cbranch_vccnz L_g2_slow24
    s_branch L_g2_back24
L_g2_slow25:
    s_add_u32 s12, s12, 1
    s_cmp_gt_u32 s12, 131072
    s_cbranch_scc1 L_g2_back25
    s_add_u32 s9, s28, 24576
    buffer_load_dwordx4 v[40:43], v12, s[52:55], s9 offen offset:1024 sc1
    buffer_load_dwordx4 v[44:47], v13, s[52:55], s9 offen offset:1024 sc1
    s_waitcnt vmcnt(0)
    s_nop 0
    v_max3_u32 v2, v40, v41, v42
    v_max3_u32 v2, v2, v43, v44
    v_max3_u32 v2, v2, v45, v46
    v_max_u32 v2, v2, v47
    v_cmp_eq_u32 vcc, -1, v2
    s_cbranch_vccnz L_g2_slow25
    s_branch L_g2_back25
L_g2_slow26:
    s_add_u32 s12, s12, 1
    s_cmp_gt_u32 s12, 131072
    s_cbranch_scc1 L_g2_back26
    s_add_u32 s9, s28, 24576
    buffer_load_dwordx4 v[48:51], v12, s[52:55], s9 offen offset:2048 sc1
    buffer_load_dwordx4 v[52:55], v13, s[52:55], s9 offen offset:2048 sc1
    s_waitcnt vmcnt(0)
    s_nop 0
    v_max3_u32 v2, v48, v49, v50
    v_max3_u32 v2, v2, v51, v52
    v_max3_u32 v2, v2, v53, v54
    v_max_u32 v2, v2, v55
    v_cmp_eq_u32 vcc, -1, v2
    s_cbranch_vccnz L_g2_slow26
    s_branch L_g2_back26
L_g2_slow27:
    s_add_u32 s12, s12, 1
    s_cmp_gt_u32 s12, 131072
    s_cbranch_scc1 L_g2_back27
    s_add_u32 s9, s28, 24576
    buffer_load_dwordx4 v[56:59], v12, s[52:55], s9 offen offset:3072 sc1
    buffer_load_dwordx4 v[60:63], v13, s[52:55], s9 offen offset:3072 sc1
    s_waitcnt vmcnt(0)
    s_nop 0
    v_max3_u32 v2, v56, v57, v58
    v_max3_u32 v2, v2, v59, v60
    v_max3_u32 v2, v2, v61, v62
    v_max_u32 v2, v2, v63
    v_cmp_eq_u32 vcc, -1, v2
    s_cbranch_vccnz L_g2_slow27
    s_branch L_g2_back27

.p2align 8
.type L_table,@object
L_table:
.long 0x01b001f8, 0x01200168, 0x009000d8, 0x00000048, 0x0d800d80, 0x0d800d80, 0x0d800d80, 0x0d800d80
.long 0x01b401fc, 0x0124016c, 0x009400dc, 0x0004004c, 0x01b001f8, 0x0d800168, 0x0d800d80, 0x0d800d80
.long 0x01b80200, 0x01280170, 0x009800e0, 0x00080050, 0x01b401fc, 0x0d80016c, 0x0d800d80, 0x0d800d80
.long 0x01bc0204, 0x012c0174, 0x009c00e4, 0x000c0054, 0x01b80200, 0x0d800170, 0x0d800d80, 0x0d800d80
.long 0x01c00208, 0x01300178, 0x00a000e8, 0x00100058, 0x01bc0204, 0x0d800174, 0x0d800d80, 0x0d800d80
.long 0x01c4020c, 0x0134017c, 0x00a400ec, 0x0014005c, 0x01c00208, 0x0d800178, 0x0d800d80, 0x0d800d80
.long 0x01c80210, 0x01380180, 0x00a800f0, 0x00180060, 0x01c4020c, 0x0d80017c, 0x0d800d80, 0x0d800d80
.long 0x01cc0214, 0x013c0184, 0x00ac00f4, 0x001c0064, 0x01c80210, 0x0d800180, 0x0d800d80, 0x0d800d80
.long 0x01d00218, 0x01400188, 0x00b000f8, 0x00200068, 0x01cc0214, 0x0d800184, 0x0d800d80, 0x0d800d80
.long 0x01d4021c, 0x0144018c, 0x00b400fc, 0x0024006c, 0x01d00218, 0x0d800188, 0x0d800d80, 0x0d800d80
.long 0x01d80220, 0x01480190, 0x00b80100, 0x00280070, 0x01d4021c, 0x0d80018c, 0x0d800d80, 0x0d800d80
.long 0x01dc0224, 0x014c0194, 0x00bc0104, 0x002c0074, 0x01d80220, 0x0d800190, 0x0d800d80, 0x0d800d80
.long 0x01e00228, 0x01500198, 0x00c00108, 0x00300078, 0x01dc0224, 0x0d800194, 0x0d800d80, 0x0d800d80
.long 0x01e4022c, 0x0154019c, 0x00c4010c, 0x0034007c, 0x01e00228, 0x0d800198, 0x0d800d80, 0x0d800d80
.long 0x01e80230, 0x015801a0, 0x00c80110, 0x00380080, 0x01e4022c, 0x0d80019c, 0x0d800d80, 0x0d800d80
.long 0x01ec0234, 0x015c01a4, 0x00cc0114, 0x003c0084, 0x01e80230, 0x0d8001a0, 0x0d800d80, 0x0d800d80
.long 0x03f00438, 0x036003a8, 0x02d00318, 0x02400288, 0x01ec0234, 0x0d8001a4, 0x0d800d80, 0x0d800d80
.long 0x03f4043c, 0x036403ac, 0x02d4031c, 0x0244028c, 0x03f00438, 0x0d8003a8, 0x0d800d80, 0x0d800d80
.long 0x03f80440, 0x036803b0, 0x02d80320, 0x02480290, 0x03f4043c, 0x0d8003ac, 0x0d800d80, 0x0d800d80
.long 0x03fc0444, 0x036c03b4, 0x02dc0324, 0x024c0294, 0x03f80440, 0x0d8003b0, 0x0d800d80, 0x0d800d80
.long 0x04000448, 0x037003b8, 0x02e00328, 0x02500298, 0x03fc0444, 0x0d8003b4, 0x0d800d80, 0x0d800d80
.long 0x0404044c, 0x037403bc, 0x02e4032c, 0x0254029c, 0x04000448, 0x0d8003b8, 0x0d800d80, 0x0d800d80
.long 0x04080450, 0x037803c0, 0x02e80330, 0x025802a0, 0x0404044c, 0x0d8003bc, 0x0d800d80, 0x0d800d80
.long 0x040c0454, 0x037c03c4, 0x02ec0334, 0x025c02a4, 0x04080450, 0x0d8003c0, 0x0d800d80, 0x0d800d80
.long 0x04100458, 0x038003c8, 0x02f00338, 0x026002a8, 0x040c0454, 0x0d8003c4, 0x0d800d80, 0x0d800d80
.long 0x0414045c, 0x038403cc, 0x02f4033c, 0x026402ac, 0x04100458, 0x0d8003c8, 0x0d800d80, 0x0d800d80
.long 0x04180460, 0x038803d0, 0x02f80340, 0x026802b0, 0x0414045c, 0x0d8003cc, 0x0d800d80, 0x0d800d80
.long 0x041c0464, 0x038c03d4, 0x02fc0344, 0x026c02b4, 0x04180460, 0x0d8003d0, 0x0d800d80, 0x0d800d80
.long 0x04200468, 0x039003d8, 0x03000348, 0x027002b8, 0x041c0464, 0x0d8003d4, 0x0d800d80, 0x0d800d80
.long 0x0424046c, 0x039403dc, 0x0304034c, 0x027402bc, 0x04200468, 0x0d8003d8, 0x0d800d80, 0x0d800d80
.long 0x04280470, 0x039803e0, 0x03080350, 0x027802c0, 0x0424046c, 0x0d8003dc, 0x0d800d80, 0x0d800d80
.long 0x042c0474, 0x039c03e4, 0x030c0354, 0x027c02c4, 0x04280470, 0x0d8003e0, 0x0d800d80, 0x0d800d80
.long 0x05580484, 0x05100510, 0x04c80510, 0x04800480, 0x042c0474, 0x0d8003e4, 0x0d800d80, 0x0d800d80
.long 0x055c0488, 0x05140514, 0x04cc0514, 0x04840484, 0x05580484, 0x0d800510, 0x0d800d80, 0x0d800d80
.long 0x0560048c, 0x05180518, 0x04d00518, 0x04880488, 0x055c0488, 0x0d800514, 0x0d800d80, 0x0d800d80
.long 0x05640490, 0x051c051c, 0x04d4051c, 0x048c048c, 0x0560048c, 0x0d800518, 0x0d800d80, 0x0d800d80
.long 0x05680494, 0x05200520, 0x04d80520, 0x04900490, 0x05640490, 0x0d80051c, 0x0d800d80, 0x0d800d80
.long 0x056c0498, 0x05240524, 0x04dc0524, 0x04940494, 0x05680494, 0x0d800520, 0x0d800d80, 0x0d800d80
.long 0x0570049c, 0x05280528, 0x04e00528, 0x04980498, 0x056c0498, 0x0d800524, 0x0d800d80, 0x0d800d80
.long 0x057404a0, 0x052c052c, 0x04e4052c, 0x049c049c, 0x0570049c, 0x0d800528, 0x0d800d80, 0x0d800d80
.long 0x057804a4, 0x05300530, 0x04e80530, 0x04a004a0, 0x057404a0, 0x0d80052c, 0x0d800d80, 0x0d800d80
.long 0x057c04a8, 0x05340534, 0x04ec0534, 0x04a404a4, 0x057804a4, 0x0d800530, 0x0d800d80, 0x0d800d80
.long 0x058004ac, 0x05380538, 0x04f00538, 0x04a804a8, 0x057c04a8, 0x0d800534, 0x0d800d80, 0x0d800d80
.long 0x058404b0, 0x053c053c, 0x04f4053c, 0x04ac04ac, 0x058004ac, 0x0d800538, 0x0d800d80, 0x0d800d80
.long 0x058804b4, 0x05400540, 0x04f80540, 0x04b004b0, 0x058404b0, 0x0d80053c, 0x0d800d80, 0x0d800d80
.long 0x058c04b8, 0x05440544, 0x04fc0544, 0x04b404b4, 0x058804b4, 0x0d800540, 0x0d800d80, 0x0d800d80
.long 0x059004bc, 0x05480548, 0x05000548, 0x04b804b8, 0x058c04b8, 0x0d800544, 0x0d800d80, 0x0d800d80
.long 0x059405a0, 0x054c054c, 0x0504054c, 0x04bc04bc, 0x059004bc, 0x0d800548, 0x0d800d80, 0x0d800d80
.long 0x067805a4, 0x06300630, 0x05e80630, 0x05a005a0, 0x059405a0, 0x0d80054c, 0x0d800d80, 0x0d800d80
.long 0x067c05a8, 0x06340634, 0x05ec0634, 0x05a405a4, 0x067805a4, 0x0d800630, 0x0d800d80, 0x0d800d80
.long 0x068005ac, 0x06380638, 0x05f00638, 0x05a805a8, 0x067c05a8, 0x0d800634, 0x0d800d80, 0x0d800d80
.long 0x068405b0, 0x063c063c, 0x05f4063c, 0x05ac05ac, 0x068005ac, 0x0d800638, 0x0d800d80, 0x0d800d80
.long 0x068805b4, 0x06400640, 0x05f80640, 0x05b005b0, 0x068405b0, 0x0d80063c, 0x0d800d80, 0x0d800d80
.long 0x068c05b8, 0x06440644, 0x05fc0644, 0x05b405b4, 0x068805b4, 0x0d800640, 0x0d800d80, 0x0d800d80
.long 0x069005bc, 0x06480648, 0x06000648, 0x05b805b8, 0x068c05b8, 0x0d800644, 0x0d800d80, 0x0d800d80
.long 0x069405c0, 0x064c064c, 0x0604064c, 0x05bc05bc, 0x069005bc, 0x0d800648, 0x0d800d80, 0x0d800d80
.long 0x069805c4, 0x06500650, 0x06080650, 0x05c005c0, 0x069405c0, 0x0d80064c, 0x0d800d80, 0x0d800d80
.long 0x069c05c8, 0x06540654, 0x060c0654, 0x05c405c4, 0x069805c4, 0x0d800650, 0x0d800d80, 0x0d800d80
.long 0x06a005cc, 0x06580658, 0x06100658, 0x05c805c8, 0x069c05c8, 0x0d800654, 0x0d800d80, 0x0d800d80
.long 0x06a405d0, 0x065c065c, 0x0614065c, 0x05cc05cc, 0x06a005cc, 0x0d800658, 0x0d800d80, 0x0d800d80
.long 0x06a805d4, 0x06600660, 0x06180660, 0x05d005d0, 0x06a405d0, 0x0d80065c, 0x0d800d80, 0x0d800d80
.long 0x06ac05d8, 0x06640664, 0x061c0664, 0x05d405d4, 0x06a805d4, 0x0d800660, 0x0d800d80, 0x0d800d80
.long 0x06b005dc, 0x06680668, 0x06200668, 0x05d805d8, 0x06ac05d8, 0x0d800664, 0x0d800d80, 0x0d800d80
.long 0x06b406c0, 0x066c066c, 0x0624066c, 0x05dc05dc, 0x06b005dc, 0x0d800668, 0x0d800d80, 0x0d800d80
.long 0x06c406c4, 0x07080708, 0x06c00708, 0x06c006c0, 0x06b406c0, 0x0d80066c, 0x0d800d80, 0x0d800d80
.long 0x06c806c8, 0x070c070c, 0x06c4070c, 0x06c406c4, 0x06c406c4, 0x0d800708, 0x0d800d80, 0x0d800d80
.long 0x06cc06cc, 0x07100710, 0x06c80710, 0x06c806c8, 0x06c806c8, 0x0d80070c, 0x0d800d80, 0x0d800d80
.long 0x06d006d0, 0x07140714, 0x06cc0714, 0x06cc06cc, 0x06cc06cc, 0x0d800710, 0x0d800d80, 0x0d800d80
.long 0x06d406d4, 0x07180718, 0x06d00718, 0x06d006d0, 0x06d006d0, 0x0d800714, 0x0d800d80, 0x0d800d80
.long 0x06d806d8, 0x071c071c, 0x06d4071c, 0x06d406d4, 0x06d406d4, 0x0d800718, 0x0d800d80, 0x0d800d80
.long 0x06dc06dc, 0x07200720, 0x06d80720, 0x06d806d8, 0x06d806d8, 0x0d80071c, 0x0d800d80, 0x0d800d80
.long 0x06e006e0, 0x07240724, 0x06dc0724, 0x06dc06dc, 0x06dc06dc, 0x0d800720, 0x0d800d80, 0x0d800d80
.long 0x06e406e4, 0x07280728, 0x06e00728, 0x06e006e0, 0x06e006e0, 0x0d800724, 0x0d800d80, 0x0d800d80
.long 0x06e806e8, 0x072c072c, 0x06e4072c, 0x06e406e4, 0x06e406e4, 0x0d800728, 0x0d800d80, 0x0d800d80
.long 0x06ec06ec, 0x07300730, 0x06e80730, 0x06e806e8, 0x06e806e8, 0x0d80072c, 0x0d800d80, 0x0d800d80
.long 0x06f006f0, 0x07340734, 0x06ec0734, 0x06ec06ec, 0x06ec06ec, 0x0d800730, 0x0d800d80, 0x0d800d80
.long 0x06f406f4, 0x07380738, 0x06f00738, 0x06f006f0, 0x06f006f0, 0x0d800734, 0x0d800d80, 0x0d800d80
.long 0x06f806f8, 0x073c073c, 0x06f4073c, 0x06f406f4, 0x06f406f4, 0x0d800738, 0x0d800d80, 0x0d800d80
.long 0x06fc06fc, 0x07400740, 0x06f80740, 0x06f806f8, 0x06f806f8, 0x0d80073c, 0x0d800d80, 0x0d800d80
.long 0x07500750, 0x07440744, 0x06fc0744, 0x06fc06fc, 0x06fc06fc, 0x0d800740, 0x0d800d80, 0x0d800d80
.long 0x07540754, 0x07980798, 0x07500798, 0x07500750, 0x07500750, 0x0d800744, 0x0d800d80, 0x0d800d80
.long 0x07580758, 0x079c079c, 0x0754079c, 0x07540754, 0x07540754, 0x0d800798, 0x0d800d80, 0x0d800d80
.long 0x075c075c, 0x07a007a0, 0x075807a0, 0x07580758, 0x07580758, 0x0d80079c, 0x0d800d80, 0x0d800d80
.long 0x07600760, 0x07a407a4, 0x075c07a4, 0x075c075c, 0x075c075c, 0x0d8007a0, 0x0d800d80, 0x0d800d80
.long 0x07640764, 0x07a807a8, 0x076007a8, 0x07600760, 0x07600760, 0x0d8007a4, 0x0d800d80, 0x0d800d80
.long 0x07680768, 0x07ac07ac, 0x076407ac, 0x07640764, 0x07640764, 0x0d8007a8, 0x0d800d80, 0x0d800d80
.long 0x076c076c, 0x07b007b0, 0x076807b0, 0x07680768, 0x07680768, 0x0d8007ac, 0x0d800d80, 0x0d800d80
.long 0x07700770, 0x07b407b4, 0x076c07b4, 0x076c076c, 0x076c076c, 0x0d8007b0, 0x0d800d80, 0x0d800d80
.long 0x07740774, 0x07b807b8, 0x077007b8, 0x07700770, 0x07700770, 0x0d8007b4, 0x0d800d80, 0x0d800d80
.long 0x07780778, 0x07bc07bc, 0x077407bc, 0x07740774, 0x07740774, 0x0d8007b8, 0x0d800d80, 0x0d800d80
.long 0x077c077c, 0x07c007c0, 0x077807c0, 0x07780778, 0x07780778, 0x0d8007bc, 0x0d800d80, 0x0d800d80
.long 0x07800780, 0x07c407c4, 0x077c07c4, 0x077c077c, 0x077c077c, 0x0d8007c0, 0x0d800d80, 0x0d800d80
.long 0x07840784, 0x07c807c8, 0x078007c8, 0x07800780, 0x07800780, 0x0d8007c4, 0x0d800d80, 0x0d800d80
.long 0x07880788, 0x07cc07cc, 0x078407cc, 0x07840784, 0x07840784, 0x0d8007c8, 0x0d800d80, 0x0d800d80
.long 0x078c078c, 0x07d007d0, 0x078807d0, 0x07880788, 0x07880788, 0x0d8007cc, 0x0d800d80, 0x0d800d80
.long 0x07e007e0, 0x07d407d4, 0x078c07d4, 0x078c078c, 0x078c078c, 0x0d8007d0, 0x0d800d80, 0x0d800d80
.long 0x07e407e4, 0x08280828, 0x07e00828, 0x07e007e0, 0x07e007e0, 0x0d8007d4, 0x0d800d80, 0x0d800d80
.long 0x07e807e8, 0x082c082c, 0x07e4082c, 0x07e407e4, 0x07e407e4, 0x0d800828, 0x0d800d80, 0x0d800d80
.long 0x07ec07ec, 0x08300830, 0x07e80830, 0x07e807e8, 0x07e807e8, 0x0d80082c, 0x0d800d80, 0x0d800d80
.long 0x07f007f0, 0x08340834, 0x07ec0834, 0x07ec07ec, 0x07ec07ec, 0x0d800830, 0x0d800d80, 0x0d800d80
.long 0x07f407f4, 0x08380838, 0x07f00838, 0x07f007f0, 0x07f007f0, 0x0d800834, 0x0d800d80, 0x0d800d80
.long 0x07f807f8, 0x083c083c, 0x07f4083c, 0x07f407f4, 0x07f407f4, 0x0d800838, 0x0d800d80, 0x0d800d80
.long 0x07fc07fc, 0x08400840, 0x07f80840, 0x07f807f8, 0x07f807f8, 0x0d80083c, 0x0d800d80, 0x0d800d80
.long 0x08000800, 0x08440844, 0x07fc0844, 0x07fc07fc, 0x07fc07fc, 0x0d800840, 0x0d800d80, 0x0d800d80
.long 0x08040804, 0x08480848, 0x08000848, 0x08000800, 0x08000800, 0x0d800844, 0x0d800d80, 0x0d800d80
.long 0x08080808, 0x084c084c, 0x0804084c, 0x08040804, 0x08040804, 0x0d800848, 0x0d800d80, 0x0d800d80
.long 0x080c080c, 0x08500850, 0x08080850, 0x08080808, 0x08080808, 0x0d80084c, 0x0d800d80, 0x0d800d80
.long 0x08100810, 0x08540854, 0x080c0854, 0x080c080c, 0x080c080c, 0x0d800850, 0x0d800d80, 0x0d800d80
.long 0x08140814, 0x08580858, 0x08100858, 0x08100810, 0x08100810, 0x0d800854, 0x0d800d80, 0x0d800d80
.long 0x08180818, 0x085c085c, 0x0814085c, 0x08140814, 0x08140814, 0x0d800858, 0x0d800d80, 0x0d800d80
.long 0x081c081c, 0x08600860, 0x08180860, 0x08180818, 0x08180818, 0x0d80085c, 0x0d800d80, 0x0d800d80
.long 0x08700870, 0x08640864, 0x081c0864, 0x081c081c, 0x081c081c, 0x0d800860, 0x0d800d80, 0x0d800d80
.long 0x08740874, 0x08b808b8, 0x087008b8, 0x08700870, 0x08700870, 0x0d800864, 0x0d800d80, 0x0d800d80
.long 0x08780878, 0x08bc08bc, 0x087408bc, 0x08740874, 0x08740874, 0x0d8008b8, 0x0d800d80, 0x0d800d80
.long 0x087c087c, 0x08c008c0, 0x087808c0, 0x08780878, 0x08780878, 0x0d8008bc, 0x0d800d80, 0x0d800d80
.long 0x08800880, 0x08c408c4, 0x087c08c4, 0x087c087c, 0x087c087c, 0x0d8008c0, 0x0d800d80, 0x0d800d80
.long 0x08840884, 0x08c808c8, 0x088008c8, 0x08800880, 0x08800880, 0x0d8008c4, 0x0d800d80, 0x0d800d80
.long 0x08880888, 0x08cc08cc, 0x088408cc, 0x08840884, 0x08840884, 0x0d8008c8, 0x0d800d80, 0x0d800d80
.long 0x088c088c, 0x08d008d0, 0x088808d0, 0x08880888, 0x08880888, 0x0d8008cc, 0x0d800d80, 0x0d800d80
.long 0x08900890, 0x08d408d4, 0x088c08d4, 0x088c088c, 0x088c088c, 0x0d8008d0, 0x0d800d80, 0x0d800d80
.long 0x08940894, 0x08d808d8, 0x089008d8, 0x08900890, 0x08900890, 0x0d8008d4, 0x0d800d80, 0x0d800d80
.long 0x08980898, 0x08dc08dc, 0x089408dc, 0x08940894, 0x08940894, 0x0d8008d8, 0x0d800d80, 0x0d800d80
.long 0x089c089c, 0x08e008e0, 0x089808e0, 0x08980898, 0x08980898, 0x0d8008dc, 0x0d800d80, 0x0d800d80
.long 0x08a008a0, 0x08e408e4, 0x089c08e4, 0x089c089c, 0x089c089c, 0x0d8008e0, 0x0d800d80, 0x0d800d80
.long 0x08a408a4, 0x08e808e8, 0x08a008e8, 0x08a008a0, 0x08a008a0, 0x0d8008e4, 0x0d800d80, 0x0d800d80
.long 0x08a808a8, 0x08ec08ec, 0x08a408ec, 0x08a408a4, 0x08a408a4, 0x0d8008e8, 0x0d800d80, 0x0d800d80
.long 0x08ac08ac, 0x08f008f0, 0x08a808f0, 0x08a808a8, 0x08a808a8, 0x0d8008ec, 0x0d800d80, 0x0d800d80
.long 0x09000900, 0x08f408f4, 0x08ac08f4, 0x08ac08ac, 0x08ac08ac, 0x0d8008f0, 0x0d800d80, 0x0d800d80
.long 0x09040904, 0x09000904, 0x09000900, 0x09000900, 0x09000900, 0x0d8008f4, 0x0d800d80, 0x0d800d80
.long 0x09080908, 0x09080908, 0x09040904, 0x09040904, 0x09040904, 0x0d800904, 0x0d800d80, 0x0d800d80
.long 0x090c090c, 0x0908090c, 0x09080908, 0x09080908, 0x09080908, 0x0d800908, 0x0d800d80, 0x0d800d80
.long 0x09100910, 0x09100910, 0x090c090c, 0x090c090c, 0x090c090c, 0x0d80090c, 0x0d800d80, 0x0d800d80
.long 0x09140914, 0x09100914, 0x09100910, 0x09100910, 0x09100910, 0x0d800910, 0x0d800d80, 0x0d800d80
.long 0x09180918, 0x09180918, 0x09140914, 0x09140914, 0x09140914, 0x0d800914, 0x0d800d80, 0x0d800d80
.long 0x091c091c, 0x0918091c, 0x09180918, 0x09180918, 0x09180918, 0x0d800918, 0x0d800d80, 0x0d800d80
.long 0x09200920, 0x09200920, 0x091c091c, 0x091c091c, 0x091c091c, 0x0d80091c, 0x0d800d80, 0x0d800d80
.long 0x09240924, 0x09200924, 0x09200920, 0x09200920, 0x09200920, 0x0d800920, 0x0d800d80, 0x0d800d80
.long 0x09280928, 0x09280928, 0x09240924, 0x09240924, 0x09240924, 0x0d800924, 0x0d800d80, 0x0d800d80
.long 0x092c092c, 0x0928092c, 0x09280928, 0x09280928, 0x09280928, 0x0d800928, 0x0d800d80, 0x0d800d80
.long 0x09300930, 0x09300930, 0x092c092c, 0x092c092c, 0x092c092c, 0x0d80092c, 0x0d800d80, 0x0d800d80
.long 0x09340934, 0x09300934, 0x09300930, 0x09300930, 0x09300930, 0x0d800930, 0x0d800d80, 0x0d800d80
.long 0x09380938, 0x09380938, 0x09340934, 0x09340934, 0x09340934, 0x0d800934, 0x0d800d80, 0x0d800d80
.long 0x093c093c, 0x0938093c, 0x09380938, 0x09380938, 0x09380938, 0x0d800938, 0x0d800d80, 0x0d800d80
.long 0x09480948, 0x09480948, 0x093c093c, 0x093c093c, 0x093c093c, 0x0d80093c, 0x0d800d80, 0x0d800d80
.long 0x094c094c, 0x0948094c, 0x09480948, 0x09480948, 0x09480948, 0x0d800948, 0x0d800d80, 0x0d800d80
.long 0x09500950, 0x09500950, 0x094c094c, 0x094c094c, 0x094c094c, 0x0d80094c, 0x0d800d80, 0x0d800d80
.long 0x09540954, 0x09500954, 0x09500950, 0x09500950, 0x09500950, 0x0d800950, 0x0d800d80, 0x0d800d80
.long 0x09580958, 0x09580958, 0x09540954, 0x09540954, 0x09540954, 0x0d800954, 0x0d800d80, 0x0d800d80
.long 0x095c095c, 0x0958095c, 0x09580958, 0x09580958, 0x09580958, 0x0d800958, 0x0d800d80, 0x0d800d80
.long 0x09600960, 0x09600960, 0x095c095c, 0x095c095c, 0x095c095c, 0x0d80095c, 0x0d800d80, 0x0d800d80
.long 0x09640964, 0x09600964, 0x09600960, 0x09600960, 0x09600960, 0x0d800960, 0x0d800d80, 0x0d800d80
.long 0x09680968, 0x09680968, 0x09640964, 0x09640964, 0x09640964, 0x0d800964, 0x0d800d80, 0x0d800d80
.long 0x096c096c, 0x0968096c, 0x09680968, 0x09680968, 0x09680968, 0x0d800968, 0x0d800d80, 0x0d800d80
.long 0x09700970, 0x09700970, 0x096c096c, 0x096c096c, 0x096c096c, 0x0d80096c, 0x0d800d80, 0x0d800d80
.long 0x09740974, 0x09700974, 0x09700970, 0x09700970, 0x09700970, 0x0d800970, 0x0d800d80, 0x0d800d80
.long 0x09780978, 0x09780978, 0x09740974, 0x09740974, 0x09740974, 0x0d800974, 0x0d800d80, 0x0d800d80
.long 0x097c097c, 0x0978097c, 0x09780978, 0x09780978, 0x09780978, 0x0d800978, 0x0d800d80, 0x0d800d80
.long 0x09800980, 0x09800980, 0x097c097c, 0x097c097c, 0x097c097c, 0x0d80097c, 0x0d800d80, 0x0d800d80
.long 0x09840984, 0x09800984, 0x09800980, 0x09800980, 0x09800980, 0x0d800980, 0x0d800d80, 0x0d800d80
.long 0x09900990, 0x09900990, 0x09840984, 0x09840984, 0x09840984, 0x0d800984, 0x0d800d80, 0x0d800d80
.long 0x09940994, 0x09900994, 0x09900990, 0x09900990, 0x09900990, 0x0d800990, 0x0d800d80, 0x0d800d80
.long 0x09980998, 0x09980998, 0x09940994, 0x09940994, 0x09940994, 0x0d800994, 0x0d800d80, 0x0d800d80
.long 0x099c099c, 0x0998099c, 0x09980998, 0x09980998, 0x09980998, 0x0d800998, 0x0d800d80, 0x0d800d80
.long 0x09a009a0, 0x09a009a0, 0x099c099c, 0x099c099c, 0x099c099c, 0x0d80099c, 0x0d800d80, 0x0d800d80
.long 0x09a409a4, 0x09a009a4, 0x09a009a0, 0x09a009a0, 0x09a009a0, 0x0d8009a0, 0x0d800d80, 0x0d800d80
.long 0x09a809a8, 0x09a809a8, 0x09a409a4, 0x09a409a4, 0x09a409a4, 0x0d8009a4, 0x0d800d80, 0x0d800d80
.long 0x09ac09ac, 0x09a809ac, 0x09a809a8, 0x09a809a8, 0x09a809a8, 0x0d8009a8, 0x0d800d80, 0x0d800d80
.long 0x09b009b0, 0x09b009b0, 0x09ac09ac, 0x09ac09ac, 0x09ac09ac, 0x0d8009ac, 0x0d800d80, 0x0d800d80
.long 0x09b409b4, 0x09b009b4, 0x09b009b0, 0x09b009b0, 0x09b009b0, 0x0d8009b0, 0x0d800d80, 0x0d800d80
.long 0x09b809b8, 0x09b809b8, 0x09b409b4, 0x09b409b4, 0x09b409b4, 0x0d8009b4, 0x0d800d80, 0x0d800d80
.long 0x09bc09bc, 0x09b809bc, 0x09b809b8, 0x09b809b8, 0x09b809b8, 0x0d8009b8, 0x0d800d80, 0x0d800d80
.long 0x09c009c0, 0x09c009c0, 0x09bc09bc, 0x09bc09bc, 0x09bc09bc, 0x0d8009bc, 0x0d800d80, 0x0d800d80
.long 0x09c409c4, 0x09c009c4, 0x09c009c0, 0x09c009c0, 0x09c009c0, 0x0d8009c0, 0x0d800d80, 0x0d800d80
.long 0x09c809c8, 0x09c809c8, 0x09c409c4, 0x09c409c4, 0x09c409c4, 0x0d8009c4, 0x0d800d80, 0x0d800d80
.long 0x09cc09cc, 0x09c809cc, 0x09c809c8, 0x09c809c8, 0x09c809c8, 0x0d8009c8, 0x0d800d80, 0x0d800d80
.long 0x09d809d8, 0x09d809d8, 0x09cc09cc, 0x09cc09cc, 0x09cc09cc, 0x0d8009cc, 0x0d800d80, 0x0d800d80
.long 0x09dc09dc, 0x09d809dc, 0x09d809d8, 0x09d809d8, 0x09d809d8, 0x0d8009d8, 0x0d800d80, 0x0d800d80
.long 0x09e009e0, 0x09e009e0, 0x09dc09dc, 0x09dc09dc, 0x09dc09dc, 0x0d8009dc, 0x0d800d80, 0x0d800d80
.long 0x09e409e4, 0x09e009e4, 0x09e009e0, 0x09e009e0, 0x09e009e0, 0x0d8009e0, 0x0d800d80, 0x0d800d80
.long 0x09e809e8, 0x09e809e8, 0x09e409e4, 0x09e409e4, 0x09e409e4, 0x0d8009e4, 0x0d800d80, 0x0d800d80
.long 0x09ec09ec, 0x09e809ec, 0x09e809e8, 0x09e809e8, 0x09e809e8, 0x0d8009e8, 0x0d800d80, 0x0d800d80
.long 0x09f009f0, 0x09f009f0, 0x09ec09ec, 0x09ec09ec, 0x09ec09ec, 0x0d8009ec, 0x0d800d80, 0x0d800d80
.long 0x09f409f4, 0x09f009f4, 0x09f009f0, 0x09f009f0, 0x09f009f0, 0x0d8009f0, 0x0d800d80, 0x0d800d80
.long 0x09f809f8, 0x09f809f8, 0x09f409f4, 0x09f409f4, 0x09f409f4, 0x0d8009f4, 0x0d800d80, 0x0d800d80
.long 0x09fc09fc, 0x09f809fc, 0x09f809f8, 0x09f809f8, 0x09f809f8, 0x0d8009f8, 0x0d800d80, 0x0d800d80
.long 0x0a000a00, 0x0a000a00, 0x09fc09fc, 0x09fc09fc, 0x09fc09fc, 0x0d8009fc, 0x0d800d80, 0x0d800d80
.long 0x0a040a04, 0x0a000a04, 0x0a000a00, 0x0a000a00, 0x0a000a00, 0x0d800a00, 0x0d800d80, 0x0d800d80
.long 0x0a080a08, 0x0a080a08, 0x0a040a04, 0x0a040a04, 0x0a040a04, 0x0d800a04, 0x0d800d80, 0x0d800d80
.long 0x0a0c0a0c, 0x0a080a0c, 0x0a080a08, 0x0a080a08, 0x0a080a08, 0x0d800a08, 0x0d800d80, 0x0d800d80
.long 0x0a100a10, 0x0a100a10, 0x0a0c0a0c, 0x0a0c0a0c, 0x0a0c0a0c, 0x0d800a0c, 0x0d800d80, 0x0d800d80
.long 0x0a140a14, 0x0a100a14, 0x0a100a10, 0x0a100a10, 0x0a100a10, 0x0d800a10, 0x0d800d80, 0x0d800d80
.long 0x0a200a20, 0x0a200a20, 0x0a140a14, 0x0a140a14, 0x0a140a14, 0x0d800a14, 0x0d800d80, 0x0d800d80
.long 0x0a240a24, 0x0a200a24, 0x0a200a20, 0x0a200a20, 0x0a200a20, 0x0d800a20, 0x0d800d80, 0x0d800d80
.long 0x0a280a28, 0x0a280a28, 0x0a240a24, 0x0a240a24, 0x0a240a24, 0x0d800a24, 0x0d800d80, 0x0d800d80
.long 0x0a2c0a2c, 0x0a280a2c, 0x0a280a28, 0x0a280a28, 0x0a280a28, 0x0d800a28, 0x0d800d80, 0x0d800d80
.long 0x0a300a30, 0x0a300a30, 0x0a2c0a2c, 0x0a2c0a2c, 0x0a2c0a2c, 0x0d800a2c, 0x0d800d80, 0x0d800d80
.long 0x0a340a34, 0x0a300a34, 0x0a300a30, 0x0a300a30, 0x0a300a30, 0x0d800a30, 0x0d800d80, 0x0d800d80
.long 0x0a380a38, 0x0a380a38, 0x0a340a34, 0x0a340a34, 0x0a340a34, 0x0d800a34, 0x0d800d80, 0x0d800d80
.long 0x0a3c0a3c, 0x0a380a3c, 0x0a380a38, 0x0a380a38, 0x0a380a38, 0x0d800a38, 0x0d800d80, 0x0d800d80
.long 0x0a400a40, 0x0a400a40, 0x0a3c0a3c, 0x0a3c0a3c, 0x0a3c0a3c, 0x0d800a3c, 0x0d800d80, 0x0d800d80
.long 0x0a440a44, 0x0a400a44, 0x0a400a40, 0x0a400a40, 0x0a400a40, 0x0d800a40, 0x0d800d80, 0x0d800d80
.long 0x0a480a48, 0x0a480a48, 0x0a440a44, 0x0a440a44, 0x0a440a44, 0x0d800a44, 0x0d800d80, 0x0d800d80
.long 0x0a4c0a4c, 0x0a480a4c, 0x0a480a48, 0x0a480a48, 0x0a480a48, 0x0d800a48, 0x0d800d80, 0x0d800d80
.long 0x0a500a50, 0x0a500a50, 0x0a4c0a4c, 0x0a4c0a4c, 0x0a4c0a4c, 0x0d800a4c, 0x0d800d80, 0x0d800d80
.long 0x0a540a54, 0x0a500a54, 0x0a500a50, 0x0a500a50, 0x0a500a50, 0x0d800a50, 0x0d800d80, 0x0d800d80
.long 0x0a580a58, 0x0a580a58, 0x0a540a54, 0x0a540a54, 0x0a540a54, 0x0d800a54, 0x0d800d80, 0x0d800d80
.long 0x0a5c0a5c, 0x0a580a5c, 0x0a580a58, 0x0a580a58, 0x0a580a58, 0x0d800a58, 0x0d800d80, 0x0d800d80
.long 0x0a680a68, 0x0a680a68, 0x0a5c0a5c, 0x0a5c0a5c, 0x0a5c0a5c, 0x0d800a5c, 0x0d800d80, 0x0d800d80
.long 0x0a6c0a6c, 0x0a680a6c, 0x0a680a68, 0x0a680a68, 0x0a680a68, 0x0d800a68, 0x0d800d80, 0x0d800d80
.long 0x0a700a70, 0x0a700a70, 0x0a6c0a6c, 0x0a6c0a6c, 0x0a6c0a6c, 0x0d800a6c, 0x0d800d80, 0x0d800d80
.long 0x0a740a74, 0x0a700a74, 0x0a700a70, 0x0a700a70, 0x0a700a70, 0x0d800a70, 0x0d800d80, 0x0d800d80
.long 0x0a780a78, 0x0a780a78, 0x0a740a74, 0x0a740a74, 0x0a740a74, 0x0d800a74, 0x0d800d80, 0x0d800d80
.long 0x0a7c0a7c, 0x0a780a7c, 0x0a780a78, 0x0a780a78, 0x0a780a78, 0x0d800a78, 0x0d800d80, 0x0d800d80
.long 0x0a800a80, 0x0a800a80, 0x0a7c0a7c, 0x0a7c0a7c, 0x0a7c0a7c, 0x0d800a7c, 0x0d800d80, 0x0d800d80
.long 0x0a840a84, 0x0a800a84, 0x0a800a80, 0x0a800a80, 0x0a800a80, 0x0d800a80, 0x0d800d80, 0x0d800d80
.long 0x0a880a88, 0x0a880a88, 0x0a840a84, 0x0a840a84, 0x0a840a84, 0x0d800a84, 0x0d800d80, 0x0d800d80
.long 0x0a8c0a8c, 0x0a880a8c, 0x0a880a88, 0x0a880a88, 0x0a880a88, 0x0d800a88, 0x0d800d80, 0x0d800d80
.long 0x0a900a90, 0x0a900a90, 0x0a8c0a8c, 0x0a8c0a8c, 0x0a8c0a8c, 0x0d800a8c, 0x0d800d80, 0x0d800d80
.long 0x0a940a94, 0x0a900a94, 0x0a900a90, 0x0a900a90, 0x0a900a90, 0x0d800a90, 0x0d800d80, 0x0d800d80
.long 0x0a980a98, 0x0a980a98, 0x0a940a94, 0x0a940a94, 0x0a940a94, 0x0d800a94, 0x0d800d80, 0x0d800d80
.long 0x0a9c0a9c, 0x0a980a9c, 0x0a980a98, 0x0a980a98, 0x0a980a98, 0x0d800a98, 0x0d800d80, 0x0d800d80
.long 0x0aa00aa0, 0x0aa00aa0, 0x0a9c0a9c, 0x0a9c0a9c, 0x0a9c0a9c, 0x0d800a9c, 0x0d800d80, 0x0d800d80
.long 0x0aa40aa4, 0x0aa00aa4, 0x0aa00aa0, 0x0aa00aa0, 0x0aa00aa0, 0x0d800aa0, 0x0d800d80, 0x0d800d80
.long 0x0ab00ab0, 0x0ab00ab0, 0x0aa40aa4, 0x0aa40aa4, 0x0aa40aa4, 0x0d800aa4, 0x0d800d80, 0x0d800d80
.long 0x0ab40ab4, 0x0ab00ab4, 0x0ab00ab0, 0x0ab00ab0, 0x0ab00ab0, 0x0d800ab0, 0x0d800d80, 0x0d800d80
.long 0x0ab80ab8, 0x0ab80ab8, 0x0ab40ab4, 0x0ab40ab4, 0x0ab40ab4, 0x0d800ab4, 0x0d800d80, 0x0d800d80
.long 0x0abc0abc, 0x0ab80abc, 0x0ab80ab8, 0x0ab80ab8, 0x0ab80ab8, 0x0d800ab8, 0x0d800d80, 0x0d800d80
.long 0x0ac00ac0, 0x0ac00ac0, 0x0abc0abc, 0x0abc0abc, 0x0abc0abc, 0x0d800abc, 0x0d800d80, 0x0d800d80
.long 0x0ac40ac4, 0x0ac00ac4, 0x0ac00ac0, 0x0ac00ac0, 0x0ac00ac0, 0x0d800ac0, 0x0d800d80, 0x0d800d80
.long 0x0ac80ac8, 0x0ac80ac8, 0x0ac40ac4, 0x0ac40ac4, 0x0ac40ac4, 0x0d800ac4, 0x0d800d80, 0x0d800d80
.long 0x0acc0acc, 0x0ac80acc, 0x0ac80ac8, 0x0ac80ac8, 0x0ac80ac8, 0x0d800ac8, 0x0d800d80, 0x0d800d80
.long 0x0ad00ad0, 0x0ad00ad0, 0x0acc0acc, 0x0acc0acc, 0x0acc0acc, 0x0d800acc, 0x0d800d80, 0x0d800d80
.long 0x0ad40ad4, 0x0ad00ad4, 0x0ad00ad0, 0x0ad00ad0, 0x0ad00ad0, 0x0d800ad0, 0x0d800d80, 0x0d800d80
.long 0x0ad80ad8, 0x0ad80ad8, 0x0ad40ad4, 0x0ad40ad4, 0x0ad40ad4, 0x0d800ad4, 0x0d800d80, 0x0d800d80
.long 0x0adc0adc, 0x0ad80adc, 0x0ad80ad8, 0x0ad80ad8, 0x0ad80ad8, 0x0d800ad8, 0x0d800d80, 0x0d800d80
.long 0x0ae00ae0, 0x0ae00ae0, 0x0adc0adc, 0x0adc0adc, 0x0adc0adc, 0x0d800adc, 0x0d800d80, 0x0d800d80
.long 0x0ae40ae4, 0x0ae00ae4, 0x0ae00ae0, 0x0ae00ae0, 0x0ae00ae0, 0x0d800ae0, 0x0d800d80, 0x0d800d80
.long 0x0ae80ae8, 0x0ae80ae8, 0x0ae40ae4, 0x0ae40ae4, 0x0ae40ae4, 0x0d800ae4, 0x0d800d80, 0x0d800d80
.long 0x0aec0aec, 0x0ae80aec, 0x0ae80ae8, 0x0ae80ae8, 0x0ae80ae8, 0x0d800ae8, 0x0d800d80, 0x0d800d80
.long 0x0af80af8, 0x0af80af8, 0x0aec0aec, 0x0aec0aec, 0x0aec0aec, 0x0d800aec, 0x0d800d80, 0x0d800d80
.long 0x0afc0afc, 0x0af80afc, 0x0af80af8, 0x0af80af8, 0x0af80af8, 0x0d800af8, 0x0d800d80, 0x0d800d80
.long 0x0b000b00, 0x0b000b00, 0x0afc0afc, 0x0afc0afc, 0x0afc0afc, 0x0d800afc, 0x0d800d80, 0x0d800d80
.long 0x0b040b04, 0x0b000b04, 0x0b000b00, 0x0b000b00, 0x0b000b00, 0x0d800b00, 0x0d800d80, 0x0d800d80
.long 0x0b080b08, 0x0b080b08, 0x0b040b04, 0x0b040b04, 0x0b040b04, 0x0d800b04, 0x0d800d80, 0x0d800d80
.long 0x0b0c0b0c, 0x0b080b0c, 0x0b080b08, 0x0b080b08, 0x0b080b08, 0x0d800b08, 0x0d800d80, 0x0d800d80
.long 0x0b100b10, 0x0b100b10, 0x0b0c0b0c, 0x0b0c0b0c, 0x0b0c0b0c, 0x0d800b0c, 0x0d800d80, 0x0d800d80
.long 0x0b140b14, 0x0b100b14, 0x0b100b10, 0x0b100b10, 0x0b100b10, 0x0d800b10, 0x0d800d80, 0x0d800d80
.long 0x0b180b18, 0x0b180b18, 0x0b140b14, 0x0b140b14, 0x0b140b14, 0x0d800b14, 0x0d800d80, 0x0d800d80
.long 0x0b1c0b1c, 0x0b180b1c, 0x0b180b18, 0x0b180b18, 0x0b180b18, 0x0d800b18, 0x0d800d80, 0x0d800d80
.long 0x0b200b20, 0x0b200b20, 0x0b1c0b1c, 0x0b1c0b1c, 0x0b1c0b1c, 0x0d800b1c, 0x0d800d80, 0x0d800d80
.long 0x0b240b24, 0x0b200b24, 0x0b200b20, 0x0b200b20, 0x0b200b20, 0x0d800b20, 0x0d800d80, 0x0d800d80
.long 0x0b280b28, 0x0b280b28, 0x0b240b24, 0x0b240b24, 0x0b240b24, 0x0d800b24, 0x0d800d80, 0x0d800d80
.long 0x0b2c0b2c, 0x0b280b2c, 0x0b280b28, 0x0b280b28, 0x0b280b28, 0x0d800b28, 0x0d800d80, 0x0d800d80
.long 0x0b300b30, 0x0b300b30, 0x0b2c0b2c, 0x0b2c0b2c, 0x0b2c0b2c, 0x0d800b2c, 0x0d800d80, 0x0d800d80
.long 0x0b340b34, 0x0b300b34, 0x0b300b30, 0x0b300b30, 0x0b300b30, 0x0d800b30, 0x0d800d80, 0x0d800d80
.long 0x0b400b40, 0x0b400b40, 0x0b340b34, 0x0b340b34, 0x0b340b34, 0x0d800b34, 0x0d800d80, 0x0d800d80
.size L_table, 8192
.section .rodata,"a"
.p2align 6
.amdhsa_kernel sequential_preLN__ssm_conv_s4d__mixer_token_mlp__prompt_kernel
  .amdhsa_next_free_vgpr 512
  .amdhsa_next_free_sgpr 102
  .amdhsa_accum_offset 256
  .amdhsa_group_segment_fixed_size 0
  .amdhsa_kernarg_size 120
  .amdhsa_user_sgpr_count 2
  .amdhsa_user_sgpr_kernarg_segment_ptr 1
  .amdhsa_system_sgpr_workgroup_id_x 1
  .amdhsa_float_denorm_mode_32 3
.end_amdhsa_kernel
```
